```python
import torch

def _softmax(x, axis=-1):
    return torch.softmax(x, dim=axis)
def _gelu(x):
    return torch.nn.functional.gelu(x, approximate="tanh")
def _silu(x):
    return torch.nn.functional.silu(x)
def _sigmoid(x):
    return torch.sigmoid(x)
def _layernorm(x, axis=-1, eps=1e-5):
    m = x.mean(dim=axis, keepdim=True)
    v = x.var(dim=axis, keepdim=True, unbiased=False)
    return (x - m) / torch.sqrt(v + eps)
def _scatter_add(tgt, idx, src, axis=0):
    return tgt.clone().index_add_(axis, idx, src)
def _segment_sum(src, seg, n):
    out = torch.zeros((n,) + src.shape[1:], dtype=src.dtype)
    return out.index_add_(0, seg, src)
def _pad(x, pw):
    flat = tuple(v for pair in reversed(pw) for v in pair)
    return torch.nn.functional.pad(x, flat)

kernel_name = 'interleave_layers__ssm_conv_s5__ssm_conv_h3__prompt'

def setup_inputs():

    _w = (lambda a: (lambda t: t.to(torch.bfloat16) if t.is_floating_point() else t)(torch.as_tensor(a)))
    def _A_setup():
        B, S, D = 1, 2048, 576
        P = D
        Lambda_re = -0.5 * (lambda _x: torch.exp(torch.as_tensor(_x)))((lambda *s: torch.randn(*s, dtype=torch.bfloat16) * 0.2)(P))
        Lambda_im = (lambda *s: torch.randn(*s, dtype=torch.bfloat16) * 0.4)(P) * 1.0
        B_re = (lambda *s: torch.randn(*s, dtype=torch.bfloat16) * 0.2)(P, D) * (D ** -0.5)
        B_im = (lambda *s: torch.randn(*s, dtype=torch.bfloat16) * 0.2)(P, D) * (D ** -0.5)
        C_re = (lambda *s: torch.randn(*s, dtype=torch.bfloat16) * 0.2)(D, P) * (P ** -0.5)
        C_im = (lambda *s: torch.randn(*s, dtype=torch.bfloat16) * 0.2)(D, P) * (P ** -0.5)
        log_dt = (lambda *s: torch.randn(*s, dtype=torch.bfloat16) * 0.2)(P) * 0.3 - 2.0
        Dskip = (lambda *s: torch.randn(*s, dtype=torch.bfloat16) * 0.05)(D)
        return {
            "x": _w((lambda *s: torch.randn(*s, dtype=torch.bfloat16) * 0.05)(B, S, D)),
            "Lambda_re": _w(Lambda_re),
            "Lambda_im": _w(Lambda_im),
            "B_re": _w(B_re),
            "B_im": _w(B_im),
            "C_re": _w(C_re),
            "C_im": _w(C_im),
            "log_dt": _w(log_dt),
            "Dskip": _w(Dskip),
        }
    _A_in = _A_setup()

    def _B_setup():
        B, S, D = 1, 2048, 576
        ks = 4
        return {
            "q": _w((lambda *s: torch.randn(*s, dtype=torch.bfloat16) * 0.05)(B, S, D)),
            "k": _w((lambda *s: torch.randn(*s, dtype=torch.bfloat16) * 0.4)(B, S, D)),
            "v": _w((lambda *s: torch.randn(*s, dtype=torch.bfloat16) * 0.4)(B, S, D)),
            "shift_k": _w((lambda *s: torch.randn(*s, dtype=torch.bfloat16) * 0.4)(D, ks) * 0.5),
            "ssm_k": _w((lambda *s: torch.randn(*s, dtype=torch.bfloat16) * 0.4)(D, S) * (1.0 / S ** 0.5)),
            "ssm_D": _w((lambda *s: torch.randn(*s, dtype=torch.bfloat16) * 0.4)(D)),
        }
    _B_in = _B_setup()

    return {
        "A_x": _A_in["x"],
        "A_Lambda_re": _A_in["Lambda_re"],
        "A_Lambda_im": _A_in["Lambda_im"],
        "A_B_re": _A_in["B_re"],
        "A_B_im": _A_in["B_im"],
        "A_C_re": _A_in["C_re"],
        "A_C_im": _A_in["C_im"],
        "A_log_dt": _A_in["log_dt"],
        "A_Dskip": _A_in["Dskip"],
        "B_q": _B_in["q"],
        "B_k": _B_in["k"],
        "B_v": _B_in["v"],
        "B_shift_k": _B_in["shift_k"],
        "B_ssm_k": _B_in["ssm_k"],
        "B_ssm_D": _B_in["ssm_D"],
    }

def reference(A_x, A_Lambda_re, A_Lambda_im, A_B_re, A_B_im, A_C_re, A_C_im, A_log_dt, A_Dskip, B_q, B_k, B_v, B_shift_k, B_ssm_k, B_ssm_D):
    def _A_ref(x, Lambda_re, Lambda_im, B_re, B_im, C_re, C_im, log_dt, Dskip):
        Bsz, L, H = x.shape
        Lam = Lambda_re + 1j * Lambda_im
        Bmat = B_re + 1j * B_im
        Cmat = C_re + 1j * C_im
        dt = torch.exp(log_dt)
        Lam_bar = torch.exp(dt * Lam)
        B_bar = ((Lam_bar - 1.0) / Lam)[:, None] * Bmat
        Bu = torch.einsum("bld,pd->blp", x + 0j, B_bar)
        h = torch.zeros_like(Bu[:, 0, :])
        hs = []
        for t in range(L):
            h = Lam_bar[None, :] * h + Bu[:, t, :]
            hs.append(h)
        hseq = torch.stack(hs, 1)
        y = 2.0 * torch.einsum("blp,dp->bld", hseq, Cmat).real + x * Dskip[None, None, :]
        return y

    def _B_ref(q, k, v, shift_k, ssm_k, ssm_D):
        B, S, D = q.shape
        ks = shift_k.shape[-1]
        k_pad = _pad(k, ((0, 0), (ks - 1, 0), (0, 0)))
        k_shift = torch.zeros_like(k)
        for t in range(ks):
            k_shift = k_shift + k_pad[:, t:t + S, :] * shift_k[:, ks - 1 - t][None, None, :]
        kv = k_shift * v
        L = 2 * S
        kv_pad = _pad(kv, ((0, 0), (0, S), (0, 0)))
        kf_pad = _pad(ssm_k, ((0, 0), (0, S)))
        kv_f = (lambda x, axes=(-2,-1): torch.fft.rfft2(x.float(), dim=axes))(kv_pad[:, None, :, :], axes=(1, 2))
        kf_f = (lambda x, axes=(-2,-1): torch.fft.rfft2(x.float(), dim=axes))(kf_pad[:, None, :], axes=(1, 2))
        kf_f = (lambda x, *d: x.permute(*d))(kf_f, 1, 2, 0)
        y_f = kv_f * kf_f[None, :, :, :]
        y = (lambda x, s, axes=(-2,-1): torch.fft.irfft2(x, s=s, dim=axes).to(torch.bfloat16))(y_f, (1, L), axes=(1, 2))[:, 0, :S, :]
        y = y + kv * ssm_D[None, None, :]
        return q * y

    x = A_x
    x = x + _A_ref(_layernorm(x, axis=-1), A_Lambda_re, A_Lambda_im, A_B_re, A_B_im, A_C_re, A_C_im, A_log_dt, A_Dskip)
    x = x + _B_ref(_layernorm(x, axis=-1), B_k, B_v, B_shift_k, B_ssm_k, B_ssm_D)
    x = x + _A_ref(_layernorm(x, axis=-1), A_Lambda_re, A_Lambda_im, A_B_re, A_B_im, A_C_re, A_C_im, A_log_dt, A_Dskip)
    x = x + _B_ref(_layernorm(x, axis=-1), B_k, B_v, B_shift_k, B_ssm_k, B_ssm_D)
    return x
```

```asm
; @launch grid=(256,1,1) block=(256,1,1) lds=163840
.amdgcn_target "amdgcn-amd-amdhsa--gfx950"
.text
.globl interleave_layers__ssm_conv_s5__ssm_conv_h3__prompt_kernel
.p2align 8
.type interleave_layers__ssm_conv_s5__ssm_conv_h3__prompt_kernel,@function
interleave_layers__ssm_conv_s5__ssm_conv_h3__prompt_kernel:
  s_cmp_ge_u32 s2, 256
  s_cbranch_scc1 L_end
  s_load_dwordx16 s[8:23], s[0:1], 0
  s_load_dwordx16 s[24:39], s[0:1], 64
  s_load_dwordx4 s[40:43], s[0:1], 128
  s_getpc_b64 s[6:7]
L_pc:
  s_lshr_b32 s93, s2, 3
  s_lshl_b32 s94, s93, 12
  v_lshl_add_u32 v2, v0, 4, s94
  s_mov_b32 s94, L_end-L_pc-16
  v_min_u32 v2, s94, v2
  global_load_dwordx4 v[12:15], v2, s[6:7]
  v_and_b32 v1, 63, v0
  v_lshrrev_b32 v6, 6, v0
  v_lshlrev_b32 v4, 4, v1
  v_readfirstlane_b32 s79, v6
  v_and_b32 v5, 15, v1
  v_lshrrev_b32 v6, 4, v1
  v_mov_b32 v10, 0
  v_mov_b32 v11, 0
  v_mov_b32 v7, 0x7fff0000
  s_and_b32 s94, s2, 7
  s_mul_i32 s95, s94, 27
  s_add_u32 s95, s95, s93
  s_mul_i32 s96, s94, 5
  s_add_u32 s96, s96, s93
  s_add_u32 s96, s96, 189
  s_cmp_lt_u32 s93, 27
  s_cselect_b32 s81, s95, s96
  s_mul_i32 s76, s81, 57
  s_lshr_b32 s76, s76, 9
  s_mul_i32 s93, s76, 9
  s_sub_u32 s77, s81, s93
  s_mov_b32 s82, s81
  s_and_b32 s3, s79, 1
  s_lshr_b32 s4, s79, 1
  s_cmp_ge_u32 s81, 198
  s_cbranch_scc1 L_aux
  v_lshrrev_b32 v75, 3, v1
  v_and_b32 v128, 7, v1
  s_lshl2_add_u32 s99, s77, s79
  s_lshl_b32 s97, s79, 10
  s_mul_i32 s98, s79, 12288
  s_add_u32 s98, s98, 110592
  v_xor_b32 v131, v128, v6
  v_lshlrev_b32 v131, 4, v131
  v_lshrrev_b32 v127, 5, v1
  v_mul_u32_u24 v127, 24, v127
  v_and_b32 v128, 1, v75
  v_mad_u32_u24 v127, v128, 12, v127
  v_and_b32 v128, 1, v6
  s_mul_i32 s93, s3, 48
  s_mul_i32 s94, s76, 96
  s_add_u32 s93, s93, s94
  s_lshl1_add_u32 s93, s4, s93
  v_add3_u32 v127, v127, v128, s93
  v_mul_u32_u24 v127, 1152, v127
  s_lshl_b32 s93, s3, 6
  v_xor_b32 v124, s93, v131
  v_add_u32 v124, v124, v127
  v_add_u32 v125, 4608, v124
  v_add_u32 v126, 9216, v124
  s_lshl_b32 s93, s99, 4
  v_add_u32 v127, s93, v75
  v_mul_u32_u24 v127, 1152, v127
  v_add_u32 v136, v127, v131
  v_xor_b32 v137, 64, v131
  v_add_u32 v137, v137, v127
  v_add_u32 v137, 9216, v137
  v_and_b32 v75, 1, v6
  v_mul_u32_u24 v9, 12, v75
  v_lshrrev_b32 v127, 1, v6
  v_add_u32 v9, v9, v127
  s_lshl2_add_u32 s93, s76, s79
  s_mul_i32 s93, s93, 24
  v_add_u32 v128, s93, v9
  v_mul_u32_u24 v131, 1152, v128
  s_lshl_b32 s93, s77, 7
  v_lshl_add_u32 v130, v5, 3, s93
  v_add_u32 v131, v131, v130
  s_mov_b32 s50, 0x240000
  s_mov_b32 s51, 0x20000
  s_mov_b32 s54, 0xa2000
  s_mov_b32 s55, 0x20000
  s_mov_b32 s58, 0xa2000
  s_mov_b32 s59, 0x20000
  s_waitcnt lgkmcnt(0)
  s_mov_b64 s[48:49], s[8:9]
  s_mov_b64 s[52:53], s[14:15]
  s_mov_b64 s[56:57], s[16:17]
  s_add_u32 m0, s97, 0
  s_nop 0
  buffer_load_dwordx4 v124, s[48:51], 0 offen offset:0 lds
  s_add_u32 m0, s97, 4096
  s_nop 0
  buffer_load_dwordx4 v125, s[48:51], 0 offen offset:0 lds
  s_add_u32 m0, s97, 8192
  s_nop 0
  buffer_load_dwordx4 v126, s[48:51], 0 offen offset:0 lds
  s_add_u32 m0, s98, 0
  s_nop 0
  buffer_load_dwordx4 v136, s[52:55], 0 offen offset:0 lds
  s_add_u32 m0, s98, 1024
  s_nop 0
  buffer_load_dwordx4 v137, s[52:55], 0 offen offset:0 lds
  s_add_u32 m0, s98, 2048
  s_nop 0
  buffer_load_dwordx4 v136, s[56:59], 0 offen offset:0 lds
  s_add_u32 m0, s98, 3072
  s_nop 0
  buffer_load_dwordx4 v137, s[56:59], 0 offen offset:0 lds
  s_load_dword s80, s[42:43], 0
  s_movk_i32 s93, 0
  buffer_load_dwordx2 v[138:139], v131, s[48:51], s93 offen
  s_movk_i32 s93, 2304
  buffer_load_dwordx2 v[140:141], v131, s[48:51], s93 offen
  s_movk_i32 s93, 4608
  buffer_load_dwordx2 v[142:143], v131, s[48:51], s93 offen
  s_movk_i32 s93, 6912
  buffer_load_dwordx2 v[144:145], v131, s[48:51], s93 offen
  s_movk_i32 s93, 9216
  buffer_load_dwordx2 v[146:147], v131, s[48:51], s93 offen
  s_movk_i32 s93, 11520
  buffer_load_dwordx2 v[148:149], v131, s[48:51], s93 offen
  s_mov_b64 s[44:45], s[42:43]
  s_mov_b32 s46, 0x10000000
  s_mov_b32 s47, 0x20000
  s_add_u32 m0, s97, 12160
  v_lshrrev_b32 v75, 1, v5
  v_xor_b32 v75, v75, v6
  v_lshlrev_b32 v75, 4, v75
  buffer_load_dwordx4 v124, s[48:51], 0 offen offset:128 lds
  v_lshl_add_u32 v44, v5, 7, v75
  v_xor_b32 v45, 64, v44
  v_add_u32 v46, 49152, v44
  s_add_u32 m0, s97, 16256
  v_add_u32 v47, 49152, v45
  v_add_u32 v150, s98, v44
  buffer_load_dwordx4 v125, s[48:51], 0 offen offset:128 lds
  v_add_u32 v151, s98, v45
  s_mov_b64 s[68:69], s[38:39]
  s_mov_b32 s70, 0x480000
  s_add_u32 m0, s97, 20352
  s_mov_b32 s71, 0x20000
  s_mov_b32 s26, 0x02020202
  s_mov_b32 s27, 0x02020202
  s_mov_b32 s40, 0x13131313
  s_mov_b32 s41, 0x13131313
  buffer_load_dwordx4 v126, s[48:51], 0 offen offset:128 lds
  s_getreg_b32 s20, hwreg(HW_REG_XCC_ID, 0, 4)
  v_and_b32 v75, 1, v6
  s_add_u32 m0, s98, 3968
  v_lshrrev_b32 v127, 1, v6
  v_lshlrev_b32 v64, 1, v131
  v_lshrrev_b32 v152, 3, v5
  buffer_load_dwordx4 v136, s[52:55], 0 offen offset:128 lds
  v_mul_u32_u24 v152, 3, v152
  v_bfe_u32 v128, v5, 2, 1
  v_cndmask_b32 v128, v128, 2, s[26:27]
  s_add_u32 m0, s98, 4992
  v_add_u32 v152, v152, v128
  v_lshl_add_u32 v128, v152, 1, v127
  buffer_load_dwordx4 v137, s[52:55], 0 offen offset:128 lds
  v_lshlrev_b32 v128, 4, v128
  v_lshl_add_u32 v68, v75, 2, v128
  s_mul_i32 s93, s79, 192
  s_add_u32 s93, s93, 159744
  v_add_u32 v68, s93, v68
  s_add_u32 m0, s98, 6016
  v_mul_u32_u24 v73, 192, v6
  v_add_u32 v73, 159744, v73
  s_mul_i32 s93, s76, 96
  s_lshl2_add_u32 s93, s79, s93
  v_add_u32 v75, s93, v6
  buffer_load_dwordx4 v136, s[56:59], 0 offen offset:128 lds
  v_lshlrev_b32 v75, 8, v75
  v_lshl_add_u32 v66, v5, 4, v75
  s_add_u32 m0, s98, 7040
  v_cmp_gt_u32 vcc, 9, v5
  s_nop 1
  v_cndmask_b32 v66, v7, v66, vcc
  v_lshl_add_u32 v65, v152, 12, v75
  s_lshl_b32 s93, s77, 4
  v_add_u32 v65, s93, v65
  buffer_load_dwordx4 v137, s[56:59], 0 offen offset:128 lds
  v_cndmask_b32 v65, v7, v65, s[40:41]
  s_lshl_b32 s93, s79, 2
  v_add_u32 v74, s93, v6
  v_xor_b32 v75, v74, v5
  s_add_u32 m0, s97, 24320
  v_lshrrev_b32 v75, 1, v75
  v_lshlrev_b32 v75, 4, v75
  buffer_load_dwordx4 v124, s[48:51], 0 offen offset:256 lds
  v_lshl_add_u32 v74, v74, 7, v75
  v_and_b32 v75, 1, v5
  v_lshl_add_u32 v74, v75, 3, v74
  s_add_u32 m0, s97, 28416
  s_lshl_b32 s93, s76, 8
  v_lshl_add_u32 v69, v5, 4, s93
  v_lshlrev_b32 v75, 8, v6
  v_sub_u32 v70, v69, v75
  buffer_load_dwordx4 v125, s[48:51], 0 offen offset:256 lds
  v_subrev_u32 v70, 256, v70
  v_cmp_gt_u32 vcc, 16, v1
  s_nop 1
  v_cndmask_b32 v69, v7, v69, vcc
  s_add_u32 m0, s97, 32512
  v_lshl_add_u32 v75, v5, 2, v75
  s_mul_i32 s93, s79, 6144
  s_add_u32 s93, s93, 0
  v_add_u32 v71, s93, v75
  v_lshlrev_b32 v75, 4, v6
  buffer_load_dwordx4 v126, s[48:51], 0 offen offset:256 lds
  v_lshl_add_u32 v75, v5, 6, v75
  s_mul_i32 s93, s79, 6144
  s_add_u32 s93, s93, 0
  v_add_u32 v72, s93, v75
  s_lshl_b32 s94, s99, 5
  v_lshl_add_u32 v129, v5, 1, s94
  s_mov_b32 s95, 655360
  buffer_load_dword v8, v65, s[44:47], s95 offen sc1
  s_waitcnt lgkmcnt(0)
  s_mul_i32 s80, s80, 0x9E3779B1
  s_add_u32 s80, s80, 0x7F4A7C15
  v_mov_b32 v2, s80
  v_cmp_gt_u32 vcc, 9, v5
  s_nop 1
  v_cndmask_b32 v67, 0, v2, vcc
  v_mov_b32 v108, 0x3f803f80
  v_mov_b32 v109, 0x3f803f80
  v_mov_b32 v110, 0x3f803f80
  v_mov_b32 v111, 0x3f803f80
  global_load_ushort v132, v129, s[10:11]
  global_load_ushort v133, v129, s[12:13]
  global_load_ushort v134, v129, s[22:23]
  global_load_dwordx2 v[40:41], v130, s[24:25]
  s_waitcnt vmcnt(21)
  ds_read_b128 a[0:3], v150 offset:0
  ds_read_b128 a[4:7], v150 offset:2048
  ds_read_b128 a[8:11], v151 offset:0
  ds_read_b128 a[12:15], v151 offset:2048
  s_barrier
  ds_read_b128 v[160:163], v44 offset:0
  s_waitcnt vmcnt(8)
  ds_read_b128 v[164:167], v44 offset:2048
  ds_read_b128 v[168:171], v44 offset:4096
  ds_read_b128 v[172:175], v44 offset:6144
  ds_read_b128 v[176:179], v44 offset:8192
  ds_read_b128 v[180:183], v44 offset:10240
  s_waitcnt lgkmcnt(9)
  v_mfma_f32_16x16x32_bf16 v[112:115], v[108:111], a[0:3], 0
  s_add_u32 m0, s98, 7936
  s_nop 0
  buffer_load_dwordx4 v136, s[52:55], 0 offen offset:256 lds
  s_waitcnt lgkmcnt(8)
  v_mfma_f32_16x16x32_bf16 v[116:119], v[108:111], a[4:7], 0
  ds_read_b128 v[184:187], v45 offset:0
  s_add_u32 m0, s98, 8960
  v_lshlrev_b32 v16, 16, v138
  ds_read_b128 v[188:191], v45 offset:2048
  v_and_b32 v17, 0xffff0000, v138
  v_lshlrev_b32 v18, 16, v139
  ds_read_b128 v[192:195], v45 offset:4096
  v_and_b32 v19, 0xffff0000, v139
  buffer_load_dwordx4 v137, s[52:55], 0 offen offset:256 lds
  ds_read_b128 v[196:199], v45 offset:6144
  s_add_u32 m0, s98, 9984
  s_waitcnt lgkmcnt(7)
  v_mfma_f32_16x16x32_bf16 v[208:211], v[160:163], a[0:3], 0
  ds_read_b128 v[200:203], v45 offset:8192
  v_lshlrev_b32 v20, 16, v140
  v_and_b32 v21, 0xffff0000, v140
  v_mfma_f32_16x16x32_bf16 v[232:235], v[160:163], a[4:7], 0
  ds_read_b128 v[204:207], v45 offset:10240
  v_lshlrev_b32 v22, 16, v141
  v_and_b32 v23, 0xffff0000, v141
  v_mfma_f32_16x16x32_bf16 v[212:215], v[164:167], a[0:3], 0
  buffer_load_dwordx4 v136, s[56:59], 0 offen offset:256 lds
  v_mfma_f32_16x16x32_bf16 v[236:239], v[164:167], a[4:7], 0
  ds_read_b128 a[16:19], v150 offset:4096
  s_add_u32 m0, s98, 11008
  v_lshlrev_b32 v24, 16, v142
  v_mfma_f32_16x16x32_bf16 v[216:219], v[168:171], a[0:3], 0
  ds_read_b128 a[20:23], v150 offset:6144
  v_and_b32 v25, 0xffff0000, v142
  v_lshlrev_b32 v26, 16, v143
  v_mfma_f32_16x16x32_bf16 v[240:243], v[168:171], a[4:7], 0
  s_waitcnt lgkmcnt(8)
  ds_read_b128 a[24:27], v151 offset:4096
  v_and_b32 v27, 0xffff0000, v143
  v_mfma_f32_16x16x32_bf16 v[220:223], v[172:175], a[0:3], 0
  buffer_load_dwordx4 v137, s[56:59], 0 offen offset:256 lds
  v_mfma_f32_16x16x32_bf16 v[244:247], v[172:175], a[4:7], 0
  ds_read_b128 a[28:31], v151 offset:6144
  s_add_u32 m0, s97, 36480
  v_lshlrev_b32 v28, 16, v144
  v_mfma_f32_16x16x32_bf16 v[224:227], v[176:179], a[0:3], 0
  v_and_b32 v29, 0xffff0000, v144
  v_lshlrev_b32 v30, 16, v145
  v_mfma_f32_16x16x32_bf16 v[248:251], v[176:179], a[4:7], 0
  v_and_b32 v31, 0xffff0000, v145
  v_lshlrev_b32 v32, 16, v146
  v_mfma_f32_16x16x32_bf16 v[228:231], v[180:183], a[0:3], 0
  buffer_load_dwordx4 v124, s[48:51], 0 offen offset:384 lds
  v_mfma_f32_16x16x32_bf16 v[252:255], v[180:183], a[4:7], 0
  s_barrier
  ds_read_b128 v[160:163], v44 offset:12288
  v_mfma_f32_16x16x32_bf16 v[112:115], v[108:111], a[8:11], v[112:115]
  s_add_u32 m0, s97, 40576
  ds_read_b128 v[164:167], v44 offset:14336
  v_mfma_f32_16x16x32_bf16 v[116:119], v[108:111], a[12:15], v[116:119]
  s_waitcnt lgkmcnt(9)
  ds_read_b128 v[168:171], v44 offset:16384
  v_mfma_f32_16x16x32_bf16 v[208:211], v[184:187], a[8:11], v[208:211]
  buffer_load_dwordx4 v125, s[48:51], 0 offen offset:384 lds
  v_mfma_f32_16x16x32_bf16 v[232:235], v[184:187], a[12:15], v[232:235]
  ds_read_b128 v[172:175], v44 offset:18432
  s_add_u32 m0, s97, 44672
  v_and_b32 v33, 0xffff0000, v146
  v_mfma_f32_16x16x32_bf16 v[212:215], v[188:191], a[8:11], v[212:215]
  ds_read_b128 v[176:179], v44 offset:20480
  v_lshlrev_b32 v34, 16, v147
  v_and_b32 v35, 0xffff0000, v147
  v_mfma_f32_16x16x32_bf16 v[236:239], v[188:191], a[12:15], v[236:239]
  ds_read_b128 v[180:183], v44 offset:22528
  v_lshlrev_b32 v36, 16, v148
  v_and_b32 v37, 0xffff0000, v148
  v_mfma_f32_16x16x32_bf16 v[216:219], v[192:195], a[8:11], v[216:219]
  buffer_load_dwordx4 v126, s[48:51], 0 offen offset:384 lds
  v_mfma_f32_16x16x32_bf16 v[240:243], v[192:195], a[12:15], v[240:243]
  s_waitcnt lgkmcnt(10)
  s_add_u32 m0, s98, -384
  v_mfma_f32_16x16x32_bf16 v[220:223], v[196:199], a[8:11], v[220:223]
  v_lshlrev_b32 v38, 16, v149
  v_and_b32 v39, 0xffff0000, v149
  v_mfma_f32_16x16x32_bf16 v[244:247], v[196:199], a[12:15], v[244:247]
  v_add_f32 v75, v16, v17
  v_mul_f32 v81, v16, v16
  v_mfma_f32_16x16x32_bf16 v[224:227], v[200:203], a[8:11], v[224:227]
  buffer_load_dwordx4 v136, s[52:55], 0 offen offset:384 lds
  v_mfma_f32_16x16x32_bf16 v[248:251], v[200:203], a[12:15], v[248:251]
  s_add_u32 m0, s98, 640
  v_add_f32 v75, v75, v18
  v_fmac_f32 v81, v17, v17
  v_mfma_f32_16x16x32_bf16 v[228:231], v[204:207], a[8:11], v[228:231]
  v_add_f32 v75, v75, v19
  v_fmac_f32 v81, v18, v18
  v_mfma_f32_16x16x32_bf16 v[252:255], v[204:207], a[12:15], v[252:255]
  ds_read_b128 v[184:187], v45 offset:12288
  v_fmac_f32 v81, v19, v19
  v_add_f32 v76, v20, v21
  s_waitcnt lgkmcnt(10)
  v_mfma_f32_16x16x32_bf16 v[112:115], v[108:111], a[16:19], v[112:115]
  buffer_load_dwordx4 v137, s[52:55], 0 offen offset:384 lds
  s_waitcnt lgkmcnt(9)
  v_mfma_f32_16x16x32_bf16 v[116:119], v[108:111], a[20:23], v[116:119]
  s_waitcnt lgkmcnt(4)
  ds_read_b128 v[188:191], v45 offset:14336
  s_add_u32 m0, s98, 1664
  v_mfma_f32_16x16x32_bf16 v[208:211], v[160:163], a[16:19], v[208:211]
  ds_read_b128 v[192:195], v45 offset:16384
  v_mul_f32 v82, v20, v20
  v_mfma_f32_16x16x32_bf16 v[232:235], v[160:163], a[20:23], v[232:235]
  ds_read_b128 v[196:199], v45 offset:18432
  v_add_f32 v76, v76, v22
  v_mfma_f32_16x16x32_bf16 v[212:215], v[164:167], a[16:19], v[212:215]
  buffer_load_dwordx4 v136, s[56:59], 0 offen offset:384 lds
  v_mfma_f32_16x16x32_bf16 v[236:239], v[164:167], a[20:23], v[236:239]
  ds_read_b128 v[200:203], v45 offset:20480
  s_add_u32 m0, s98, 2688
  v_fmac_f32 v82, v21, v21
  v_mfma_f32_16x16x32_bf16 v[216:219], v[168:171], a[16:19], v[216:219]
  ds_read_b128 v[204:207], v45 offset:22528
  v_add_f32 v76, v76, v23
  v_fmac_f32 v82, v22, v22
  v_mfma_f32_16x16x32_bf16 v[240:243], v[168:171], a[20:23], v[240:243]
  s_waitcnt lgkmcnt(6)
  v_fmac_f32 v82, v23, v23
  v_add_f32 v77, v24, v25
  v_mfma_f32_16x16x32_bf16 v[220:223], v[172:175], a[16:19], v[220:223]
  buffer_load_dwordx4 v137, s[56:59], 0 offen offset:384 lds
  v_mfma_f32_16x16x32_bf16 v[244:247], v[172:175], a[20:23], v[244:247]
  s_add_u32 m0, s97, 48640
  v_mul_f32 v83, v24, v24
  v_add_f32 v77, v77, v26
  v_mfma_f32_16x16x32_bf16 v[224:227], v[176:179], a[16:19], v[224:227]
  v_fmac_f32 v83, v25, v25
  v_add_f32 v77, v77, v27
  v_mfma_f32_16x16x32_bf16 v[248:251], v[176:179], a[20:23], v[248:251]
  v_fmac_f32 v83, v26, v26
  v_fmac_f32 v83, v27, v27
  v_mfma_f32_16x16x32_bf16 v[228:231], v[180:183], a[16:19], v[228:231]
  buffer_load_dwordx4 v124, s[48:51], 0 offen offset:512 lds
  v_mfma_f32_16x16x32_bf16 v[252:255], v[180:183], a[20:23], v[252:255]
  s_waitcnt vmcnt(17)
  s_barrier
  ds_read_b128 v[160:163], v44 offset:24576
  v_mfma_f32_16x16x32_bf16 v[112:115], v[108:111], a[24:27], v[112:115]
  s_add_u32 m0, s97, 52736
  ds_read_b128 v[164:167], v44 offset:26624
  v_mfma_f32_16x16x32_bf16 v[116:119], v[108:111], a[28:31], v[116:119]
  s_waitcnt lgkmcnt(5)
  ds_read_b128 v[168:171], v44 offset:28672
  v_mfma_f32_16x16x32_bf16 v[208:211], v[184:187], a[24:27], v[208:211]
  buffer_load_dwordx4 v125, s[48:51], 0 offen offset:512 lds
  v_mfma_f32_16x16x32_bf16 v[232:235], v[184:187], a[28:31], v[232:235]
  ds_read_b128 v[172:175], v44 offset:30720
  s_add_u32 m0, s97, 56832
  v_add_f32 v78, v28, v29
  v_mfma_f32_16x16x32_bf16 v[212:215], v[188:191], a[24:27], v[212:215]
  ds_read_b128 v[176:179], v44 offset:32768
  v_mul_f32 v84, v28, v28
  v_add_f32 v78, v78, v30
  v_mfma_f32_16x16x32_bf16 v[236:239], v[188:191], a[28:31], v[236:239]
  ds_read_b128 v[180:183], v44 offset:34816
  v_fmac_f32 v84, v29, v29
  v_add_f32 v78, v78, v31
  v_mfma_f32_16x16x32_bf16 v[216:219], v[192:195], a[24:27], v[216:219]
  buffer_load_dwordx4 v126, s[48:51], 0 offen offset:512 lds
  v_mfma_f32_16x16x32_bf16 v[240:243], v[192:195], a[28:31], v[240:243]
  s_waitcnt lgkmcnt(6)
  s_add_u32 m0, s98, 3584
  v_mfma_f32_16x16x32_bf16 v[220:223], v[196:199], a[24:27], v[220:223]
  v_fmac_f32 v84, v30, v30
  v_fmac_f32 v84, v31, v31
  v_mfma_f32_16x16x32_bf16 v[244:247], v[196:199], a[28:31], v[244:247]
  v_add_f32 v79, v32, v33
  v_mul_f32 v85, v32, v32
  v_mfma_f32_16x16x32_bf16 v[224:227], v[200:203], a[24:27], v[224:227]
  buffer_load_dwordx4 v136, s[52:55], 0 offen offset:512 lds
  v_mfma_f32_16x16x32_bf16 v[248:251], v[200:203], a[28:31], v[248:251]
  s_add_u32 m0, s98, 4608
  v_add_f32 v79, v79, v34
  v_fmac_f32 v85, v33, v33
  v_mfma_f32_16x16x32_bf16 v[228:231], v[204:207], a[24:27], v[228:231]
  v_add_f32 v79, v79, v35
  v_fmac_f32 v85, v34, v34
  v_mfma_f32_16x16x32_bf16 v[252:255], v[204:207], a[28:31], v[252:255]
  v_fmac_f32 v85, v35, v35
  buffer_load_dwordx4 v137, s[52:55], 0 offen offset:512 lds
  s_add_u32 m0, s98, 5632
  v_add_f32 v80, v36, v37
  v_mul_f32 v86, v36, v36
  v_add_f32 v80, v80, v38
  v_fmac_f32 v86, v37, v37
  v_add_f32 v80, v80, v39
  v_fmac_f32 v86, v38, v38
  v_fmac_f32 v86, v39, v39
  v_add_u32 v121, 0, v2
  v_add_u32 v123, s20, v2
  v_add_f32_dpp v75, v75, v75 row_ror:8 row_mask:0xf bank_mask:0x3
  buffer_load_dwordx4 v136, s[56:59], 0 offen offset:512 lds
  s_add_u32 m0, s98, 6656
  v_add_f32_dpp v76, v76, v76 row_ror:8 row_mask:0xf bank_mask:0x3
  v_add_f32_dpp v77, v77, v77 row_ror:8 row_mask:0xf bank_mask:0x3
  v_add_f32_dpp v81, v81, v81 row_ror:8 row_mask:0xf bank_mask:0x3
  v_add_f32_dpp v82, v82, v82 row_ror:8 row_mask:0xf bank_mask:0x3
  v_add_f32_dpp v83, v83, v83 row_ror:8 row_mask:0xf bank_mask:0x3
  v_add_f32_dpp v75, v78, v78 row_ror:8 row_mask:0xf bank_mask:0xc
  v_add_f32_dpp v76, v79, v79 row_ror:8 row_mask:0xf bank_mask:0xc
  v_add_f32_dpp v77, v80, v80 row_ror:8 row_mask:0xf bank_mask:0xc
  v_add_f32_dpp v81, v84, v84 row_ror:8 row_mask:0xf bank_mask:0xc
  v_add_f32_dpp v82, v85, v85 row_ror:8 row_mask:0xf bank_mask:0xc
  buffer_load_dwordx4 v137, s[56:59], 0 offen offset:512 lds
  s_waitcnt vmcnt(14)
  ds_read_b128 a[32:35], v150 offset:8192
  s_add_u32 m0, s97, 60800
  v_add_f32_dpp v83, v86, v86 row_ror:8 row_mask:0xf bank_mask:0xc
  v_add_f32_dpp v75, v75, v75 row_half_mirror row_mask:0xf bank_mask:0x5
  ds_read_b128 a[36:39], v150 offset:10240
  v_add_f32_dpp v77, v77, v77 row_half_mirror row_mask:0xf bank_mask:0xf
  v_add_f32_dpp v81, v81, v81 row_half_mirror row_mask:0xf bank_mask:0x5
  v_add_f32_dpp v83, v83, v83 row_half_mirror row_mask:0xf bank_mask:0xf
  ds_read_b128 a[40:43], v151 offset:8192
  v_add_f32_dpp v75, v76, v76 row_half_mirror row_mask:0xf bank_mask:0xa
  buffer_load_dwordx4 v124, s[48:51], 0 offen offset:640 lds
  ds_read_b128 a[44:47], v151 offset:10240
  s_add_u32 m0, s97, 64896
  v_add_f32_dpp v81, v82, v82 row_half_mirror row_mask:0xf bank_mask:0xa
  ds_read_b128 v[184:187], v45 offset:24576
  v_add_f32_dpp v77, v77, v77 quad_perm:[1,0,3,2] row_mask:0xf bank_mask:0xf
  v_add_f32_dpp v83, v83, v83 quad_perm:[1,0,3,2] row_mask:0xf bank_mask:0xf
  ds_read_b128 v[188:191], v45 offset:26624
  v_add_f32_dpp v75, v75, v75 quad_perm:[1,0,3,2] row_mask:0xf bank_mask:0xf
  v_add_f32_dpp v81, v81, v81 quad_perm:[1,0,3,2] row_mask:0xf bank_mask:0xf
  buffer_load_dwordx4 v125, s[48:51], 0 offen offset:640 lds
  ds_read_b128 v[192:195], v45 offset:28672
  s_add_u32 m0, s97, 68992
  v_add_f32_dpp v77, v77, v77 quad_perm:[2,3,0,1] row_mask:0xf bank_mask:0xf
  ds_read_b128 v[196:199], v45 offset:30720
  v_add_f32_dpp v83, v83, v83 quad_perm:[2,3,0,1] row_mask:0xf bank_mask:0xf
  s_waitcnt lgkmcnt(7)
  v_mfma_f32_16x16x32_bf16 v[112:115], v[108:111], a[32:35], v[112:115]
  ds_read_b128 v[200:203], v45 offset:32768
  v_add_f32_dpp v75, v75, v75 quad_perm:[2,3,0,1] row_mask:0xf bank_mask:0xf
  s_waitcnt lgkmcnt(7)
  v_mfma_f32_16x16x32_bf16 v[116:119], v[108:111], a[36:39], v[116:119]
  buffer_load_dwordx4 v126, s[48:51], 0 offen offset:640 lds
  v_mfma_f32_16x16x32_bf16 v[208:211], v[160:163], a[32:35], v[208:211]
  ds_read_b128 v[204:207], v45 offset:34816
  v_add_f32_dpp v81, v81, v81 quad_perm:[2,3,0,1] row_mask:0xf bank_mask:0xf
  v_cndmask_b32 v120, v75, v77, s[26:27]
  v_mfma_f32_16x16x32_bf16 v[232:235], v[160:163], a[36:39], v[232:235]
  s_waitcnt lgkmcnt(6)
  s_add_u32 m0, s98, 7552
  v_cndmask_b32 v122, v81, v83, s[26:27]
  v_mfma_f32_16x16x32_bf16 v[212:215], v[164:167], a[32:35], v[212:215]
  v_mfma_f32_16x16x32_bf16 v[236:239], v[164:167], a[36:39], v[236:239]
  s_mov_b32 s93, 655360
  buffer_store_dwordx4 v[120:123], v65, s[44:47], s93 offen
  s_nop 1
  v_mfma_f32_16x16x32_bf16 v[216:219], v[168:171], a[32:35], v[216:219]
  s_mul_i32 s94, s77, 43
  s_lshr_b32 s94, s94, 5
  s_mul_i32 s94, s94, 288
  s_add_u32 s94, s94, 49152
  v_lshl_add_u32 v159, v1, 4, s94
  v_mfma_f32_16x16x32_bf16 v[240:243], v[168:171], a[36:39], v[240:243]
  v_cmp_gt_u32 vcc, 36, v1
  s_nop 1
  v_cndmask_b32 v159, v7, v159, vcc
  v_cndmask_b32 v158, 0, v2, vcc
  v_mfma_f32_16x16x32_bf16 v[220:223], v[172:175], a[32:35], v[220:223]
  buffer_load_dwordx4 v136, s[52:55], 0 offen offset:640 lds
  v_mfma_f32_16x16x32_bf16 v[244:247], v[172:175], a[36:39], v[244:247]
  s_add_u32 m0, s98, 8576
  s_mul_i32 s93, s99, 37888
  s_add_u32 s21, s93, 5505024
  v_mfma_f32_16x16x32_bf16 v[224:227], v[176:179], a[32:35], v[224:227]
  v_mul_u32_u24 v156, 4160, v6
  v_min_u32 v13, 1, v6
  v_mfma_f32_16x16x32_bf16 v[248:251], v[176:179], a[36:39], v[248:251]
  v_lshl_add_u32 v156, v13, 4, v156
  v_lshl_add_u32 v156, v5, 2, v156
  v_mfma_f32_16x16x32_bf16 v[228:231], v[180:183], a[32:35], v[228:231]
  buffer_load_dwordx4 v137, s[52:55], 0 offen offset:640 lds
  v_mfma_f32_16x16x32_bf16 v[252:255], v[180:183], a[36:39], v[252:255]
  s_waitcnt vmcnt(17)
  s_barrier
  ds_read_b128 v[160:163], v44 offset:36864
  v_mfma_f32_16x16x32_bf16 v[112:115], v[108:111], a[40:43], v[112:115]
  s_add_u32 m0, s98, 9600
  ds_read_b128 v[164:167], v44 offset:38912
  v_mfma_f32_16x16x32_bf16 v[116:119], v[108:111], a[44:47], v[116:119]
  s_waitcnt lgkmcnt(5)
  ds_read_b128 v[168:171], v44 offset:40960
  v_mfma_f32_16x16x32_bf16 v[208:211], v[184:187], a[40:43], v[208:211]
  buffer_load_dwordx4 v136, s[56:59], 0 offen offset:640 lds
  v_mfma_f32_16x16x32_bf16 v[232:235], v[184:187], a[44:47], v[232:235]
  ds_read_b128 v[172:175], v44 offset:43008
  s_waitcnt vmcnt(14)
  s_add_u32 m0, s98, 10624
  v_mfma_f32_16x16x32_bf16 v[212:215], v[188:191], a[40:43], v[212:215]
  ds_read_b128 v[176:179], v44 offset:45056
  s_mul_i32 s95, s4, 16656
  s_add_u32 s96, s95, 110592
  v_add_u32 v156, s96, v156
  v_mfma_f32_16x16x32_bf16 v[236:239], v[188:191], a[44:47], v[236:239]
  ds_read_b128 v[180:183], v44 offset:47104
  buffer_load_dwordx4 v137, s[56:59], 0 offen offset:640 lds
  v_mfma_f32_16x16x32_bf16 v[216:219], v[192:195], a[40:43], v[216:219]
  ds_read_b128 a[48:51], v150 offset:0
  s_add_u32 m0, s97, 72960
  s_mul_i32 s95, s4, 9280
  s_mul_i32 s96, s3, 4640
  s_add_u32 s96, s96, s95
  v_lshl_add_u32 v155, v1, 3, s96
  v_mfma_f32_16x16x32_bf16 v[240:243], v[192:195], a[44:47], v[240:243]
  s_waitcnt lgkmcnt(7)
  ds_read_b128 a[52:55], v150 offset:2048
  v_mul_u32_u24 v154, 12, v1
  v_mfma_f32_16x16x32_bf16 v[220:223], v[196:199], a[40:43], v[220:223]
  buffer_load_dwordx4 v124, s[48:51], 0 offen offset:768 lds
  v_mfma_f32_16x16x32_bf16 v[244:247], v[196:199], a[44:47], v[244:247]
  ds_read_b128 a[56:59], v151 offset:0
  s_add_u32 m0, s97, 77056
  s_mul_i32 s95, s4, 9280
  s_mul_i32 s96, s3, 2052
  s_add_u32 s96, s96, s95
  v_add_u32 v154, s96, v154
  v_mfma_f32_16x16x32_bf16 v[224:227], v[200:203], a[40:43], v[224:227]
  ds_read_b128 a[60:63], v151 offset:2048
  v_add_u32 v12, 1, v5
  v_and_b32 v13, 3, v12
  v_mfma_f32_16x16x32_bf16 v[248:251], v[200:203], a[44:47], v[248:251]
  buffer_load_dwordx4 v125, s[48:51], 0 offen offset:768 lds
  v_mfma_f32_16x16x32_bf16 v[228:231], v[204:207], a[40:43], v[228:231]
  s_add_u32 m0, s97, 81152
  v_mul_u32_u24 v153, 4160, v13
  v_min_u32 v13, 1, v13
  v_mfma_f32_16x16x32_bf16 v[252:255], v[204:207], a[44:47], v[252:255]
  ds_read_b128 v[184:187], v45 offset:36864
  v_lshrrev_b32 v12, 2, v12
  v_add3_u32 v12, v12, v13, v6
  s_waitcnt lgkmcnt(4)
  v_mfma_f32_16x16x32_bf16 v[112:115], v[108:111], a[48:51], v[112:115]
  ds_read_b128 v[188:191], v45 offset:38912
  v_lshl_add_u32 v153, v12, 4, v153
  buffer_load_dwordx4 v126, s[48:51], 0 offen offset:768 lds
  s_waitcnt lgkmcnt(4)
  v_mfma_f32_16x16x32_bf16 v[116:119], v[108:111], a[52:55], v[116:119]
  ds_read_b128 v[192:195], v45 offset:40960
  s_mul_i32 s96, s4, 16656
  s_lshl_b32 s94, s3, 8
  s_add_u32 s96, s96, s94
  s_add_u32 s96, s96, 110592
  v_add_u32 v153, s96, v153
  v_mfma_f32_16x16x32_bf16 v[208:211], v[160:163], a[48:51], v[208:211]
  ds_read_b128 v[196:199], v45 offset:43008
  v_and_b32 v12, 1, v5
  v_sub_u32 v12, 1, v12
  v_mfma_f32_16x16x32_bf16 v[232:235], v[160:163], a[52:55], v[232:235]
  ds_read_b128 v[200:203], v45 offset:45056
  s_waitcnt lgkmcnt(5)
  s_add_u32 m0, s98, -768
  v_mfma_f32_16x16x32_bf16 v[212:215], v[164:167], a[48:51], v[212:215]
  buffer_load_dwordx4 v136, s[52:55], 0 offen offset:768 lds
  v_mfma_f32_16x16x32_bf16 v[236:239], v[164:167], a[52:55], v[236:239]
  ds_read_b128 v[204:207], v45 offset:47104
  s_add_u32 m0, s98, 256
  v_mul_u32_u24 v152, 4640, v12
  v_mfma_f32_16x16x32_bf16 v[216:219], v[168:171], a[48:51], v[216:219]
  v_lshrrev_b32 v12, 1, v5
  v_lshlrev_b32 v12, 6, v12
  v_mfma_f32_16x16x32_bf16 v[240:243], v[168:171], a[52:55], v[240:243]
  v_sub_u32 v152, v152, v12
  v_lshl_add_u32 v152, v6, 4, v152
  v_mfma_f32_16x16x32_bf16 v[220:223], v[172:175], a[48:51], v[220:223]
  buffer_load_dwordx4 v137, s[52:55], 0 offen offset:768 lds
  v_mfma_f32_16x16x32_bf16 v[244:247], v[172:175], a[52:55], v[244:247]
  s_add_u32 m0, s98, 1280
  s_mul_i32 s95, s4, 9280
  s_lshl_b32 s94, s3, 8
  s_add_u32 s96, s95, s94
  s_add_u32 s96, s96, 464
  v_add_u32 v152, s96, v152
  v_mfma_f32_16x16x32_bf16 v[224:227], v[176:179], a[48:51], v[224:227]
  v_add_u32 v14, s20, v2
  v_cmp_gt_u32 vcc, 9, v5
  s_nop 1
  v_cndmask_b32 v14, 0, v14, vcc
  v_mfma_f32_16x16x32_bf16 v[248:251], v[176:179], a[52:55], v[248:251]
  buffer_load_dwordx4 v136, s[56:59], 0 offen offset:768 lds
  v_mfma_f32_16x16x32_bf16 v[228:231], v[180:183], a[48:51], v[228:231]
  s_waitcnt vmcnt(14)
  ds_read_b128 a[64:67], v150 offset:4096
  s_add_u32 m0, s98, 2304
  v_mfma_f32_16x16x32_bf16 v[252:255], v[180:183], a[52:55], v[252:255]
  s_barrier
  ds_read_b128 v[160:163], v46 offset:0
  v_mfma_f32_16x16x32_bf16 v[112:115], v[108:111], a[56:59], v[112:115]
  v_lshlrev_b32 v132, 16, v132
  ds_read_b128 v[164:167], v46 offset:2048
  v_mfma_f32_16x16x32_bf16 v[116:119], v[108:111], a[60:63], v[116:119]
  s_waitcnt lgkmcnt(6)
  buffer_load_dwordx4 v137, s[56:59], 0 offen offset:768 lds
  v_mfma_f32_16x16x32_bf16 v[208:211], v[184:187], a[56:59], v[208:211]
  ds_read_b128 v[168:171], v46 offset:4096
  s_add_u32 m0, s97, 85120
  v_lshlrev_b32 v133, 16, v133
  v_mfma_f32_16x16x32_bf16 v[232:235], v[184:187], a[60:63], v[232:235]
  ds_read_b128 v[172:175], v46 offset:6144
  v_lshlrev_b32 v134, 16, v134
  v_mul_f32 v134, 0x3fb8aa3b, v134
  v_mfma_f32_16x16x32_bf16 v[212:215], v[188:191], a[56:59], v[212:215]
  ds_read_b128 v[176:179], v46 offset:8192
  v_exp_f32 v134, v134
  s_nop 0
  v_cvt_pk_bf16_f32 v134, v134, v134
  v_mfma_f32_16x16x32_bf16 v[236:239], v[188:191], a[60:63], v[236:239]
  buffer_load_dwordx4 v124, s[48:51], 0 offen offset:896 lds
  v_mfma_f32_16x16x32_bf16 v[216:219], v[192:195], a[56:59], v[216:219]
  ds_read_b128 v[180:183], v46 offset:10240
  s_add_u32 m0, s97, 89216
  v_lshlrev_b32 v134, 16, v134
  v_mfma_f32_16x16x32_bf16 v[240:243], v[192:195], a[60:63], v[240:243]
  s_waitcnt lgkmcnt(7)
  ds_read_b128 a[68:71], v150 offset:6144
  v_mul_f32 v76, v134, v132
  v_mfma_f32_16x16x32_bf16 v[220:223], v[196:199], a[56:59], v[220:223]
  ds_read_b128 a[72:75], v151 offset:4096
  v_mul_f32 v77, v134, v133
  v_mfma_f32_16x16x32_bf16 v[244:247], v[196:199], a[60:63], v[244:247]
  buffer_load_dwordx4 v125, s[48:51], 0 offen offset:896 lds
  v_mfma_f32_16x16x32_bf16 v[224:227], v[200:203], a[56:59], v[224:227]
  ds_read_b128 a[76:79], v151 offset:6144
  s_add_u32 m0, s97, 93312
  v_mul_f32 v76, 0x3fb8aa3b, v76
  v_mfma_f32_16x16x32_bf16 v[248:251], v[200:203], a[60:63], v[248:251]
  v_exp_f32 v76, v76
  v_mul_f32 v77, 0.15915494, v77
  v_mfma_f32_16x16x32_bf16 v[228:231], v[204:207], a[56:59], v[228:231]
  v_rndne_f32 v78, v77
  v_sub_f32 v77, v77, v78
  v_mfma_f32_16x16x32_bf16 v[252:255], v[204:207], a[60:63], v[252:255]
  buffer_load_dwordx4 v126, s[48:51], 0 offen offset:896 lds
  s_waitcnt lgkmcnt(9)
  v_mfma_f32_16x16x32_bf16 v[112:115], v[108:111], a[64:67], v[112:115]
  ds_read_b128 v[184:187], v47 offset:0
  v_cos_f32 v78, v77
  v_sin_f32 v79, v77
  ds_read_b128 v[188:191], v47 offset:2048
  v_mul_f32 v48, v76, v78
  v_mul_f32 v49, v76, v79
  v_mul_f32 v76, v48, v48
  s_waitcnt lgkmcnt(4)
  v_mfma_f32_16x16x32_bf16 v[116:119], v[108:111], a[68:71], v[116:119]
  ds_read_b128 v[192:195], v47 offset:4096
  v_mul_f32 v77, v49, v48
  v_mfma_f32_16x16x32_bf16 v[208:211], v[160:163], a[64:67], v[208:211]
  ds_read_b128 v[196:199], v47 offset:6144
  v_fma_f32 v76, -v49, v49, v76
  v_mfma_f32_16x16x32_bf16 v[232:235], v[160:163], a[68:71], v[232:235]
  ds_read_b128 v[200:203], v47 offset:8192
  s_waitcnt lgkmcnt(5)
  v_mfma_f32_16x16x32_bf16 v[212:215], v[164:167], a[64:67], v[212:215]
  ds_read_b128 v[204:207], v47 offset:10240
  s_add_u32 m0, s98, 3200
  v_mfma_f32_16x16x32_bf16 v[236:239], v[164:167], a[68:71], v[236:239]
  buffer_load_dwordx4 v136, s[52:55], 0 offen offset:896 lds
  v_mfma_f32_16x16x32_bf16 v[216:219], v[168:171], a[64:67], v[216:219]
  s_add_u32 m0, s98, 4224
  v_fmac_f32 v77, v48, v49
  v_mul_f32 v78, v76, v76
  v_mfma_f32_16x16x32_bf16 v[240:243], v[168:171], a[68:71], v[240:243]
  v_mul_f32 v79, v77, v76
  v_fma_f32 v78, -v77, v77, v78
  v_mfma_f32_16x16x32_bf16 v[220:223], v[172:175], a[64:67], v[220:223]
  v_fmac_f32 v79, v76, v77
  v_mul_f32 v80, v78, v78
  v_mfma_f32_16x16x32_bf16 v[244:247], v[172:175], a[68:71], v[244:247]
  buffer_load_dwordx4 v137, s[52:55], 0 offen offset:896 lds
  v_mfma_f32_16x16x32_bf16 v[224:227], v[176:179], a[64:67], v[224:227]
  s_add_u32 m0, s98, 5248
  v_mul_f32 v81, v79, v78
  v_fma_f32 v80, -v79, v79, v80
  v_mfma_f32_16x16x32_bf16 v[248:251], v[176:179], a[68:71], v[248:251]
  v_fmac_f32 v81, v78, v79
  v_mul_f32 v50, v80, v78
  v_mfma_f32_16x16x32_bf16 v[228:231], v[180:183], a[64:67], v[228:231]
  v_mul_f32 v51, v81, v78
  v_fma_f32 v50, -v81, v79, v50
  v_mfma_f32_16x16x32_bf16 v[252:255], v[180:183], a[68:71], v[252:255]
  s_waitcnt vmcnt(17)
  s_barrier
  buffer_load_dwordx4 v136, s[56:59], 0 offen offset:896 lds
  v_mfma_f32_16x16x32_bf16 v[112:115], v[108:111], a[72:75], v[112:115]
  ds_read_b128 v[160:163], v46 offset:12288
  s_waitcnt vmcnt(13)
  s_add_u32 m0, s98, 6272
  v_mfma_f32_16x16x32_bf16 v[116:119], v[108:111], a[76:79], v[116:119]
  s_waitcnt lgkmcnt(4)
  ds_read_b128 v[164:167], v46 offset:14336
  v_fmac_f32 v51, v80, v79
  v_mfma_f32_16x16x32_bf16 v[208:211], v[184:187], a[72:75], v[208:211]
  ds_read_b128 v[168:171], v46 offset:16384
  v_mul_f32 v52, v50, v50
  v_mfma_f32_16x16x32_bf16 v[232:235], v[184:187], a[76:79], v[232:235]
  buffer_load_dwordx4 v137, s[56:59], 0 offen offset:896 lds
  v_mfma_f32_16x16x32_bf16 v[212:215], v[188:191], a[72:75], v[212:215]
  ds_read_b128 v[172:175], v46 offset:18432
  s_add_u32 m0, s97, 97280
  v_mul_f32 v53, v51, v50
  v_mfma_f32_16x16x32_bf16 v[236:239], v[188:191], a[76:79], v[236:239]
  ds_read_b128 v[176:179], v46 offset:20480
  v_fma_f32 v52, -v51, v51, v52
  v_fmac_f32 v53, v50, v51
  v_mfma_f32_16x16x32_bf16 v[216:219], v[192:195], a[72:75], v[216:219]
  ds_read_b128 v[180:183], v46 offset:22528
  v_mul_f32 v82, v52, v52
  v_mul_f32 v83, v53, v52
  v_mfma_f32_16x16x32_bf16 v[240:243], v[192:195], a[76:79], v[240:243]
  s_waitcnt lgkmcnt(6)
  buffer_load_dwordx4 v124, s[48:51], 0 offen offset:1024 lds
  v_mfma_f32_16x16x32_bf16 v[220:223], v[196:199], a[72:75], v[220:223]
  ds_read_b128 a[80:83], v150 offset:8192
  s_add_u32 m0, s97, 101376
  v_fma_f32 v82, -v53, v53, v82
  v_mfma_f32_16x16x32_bf16 v[244:247], v[196:199], a[76:79], v[244:247]
  ds_read_b128 a[84:87], v150 offset:10240
  v_fmac_f32 v83, v52, v53
  v_mul_f32 v84, v82, v52
  v_mfma_f32_16x16x32_bf16 v[224:227], v[200:203], a[72:75], v[224:227]
  ds_read_b128 a[88:91], v151 offset:8192
  v_mul_f32 v85, v83, v52
  v_fma_f32 v84, -v83, v53, v84
  v_mfma_f32_16x16x32_bf16 v[248:251], v[200:203], a[76:79], v[248:251]
  buffer_load_dwordx4 v125, s[48:51], 0 offen offset:1024 lds
  v_mfma_f32_16x16x32_bf16 v[228:231], v[204:207], a[72:75], v[228:231]
  ds_read_b128 a[92:95], v151 offset:10240
  s_add_u32 m0, s97, 105472
  v_fmac_f32 v85, v82, v53
  v_mfma_f32_16x16x32_bf16 v[252:255], v[204:207], a[76:79], v[252:255]
  ds_read_b128 v[184:187], v47 offset:12288
  v_mul_f32 v86, v82, v82
  v_mul_f32 v87, v83, v82
  ds_read_b128 v[188:191], v47 offset:14336
  v_fma_f32 v86, -v83, v83, v86
  buffer_load_dwordx4 v126, s[48:51], 0 offen offset:1024 lds
  ds_read_b128 v[192:195], v47 offset:16384
  v_fmac_f32 v87, v82, v83
  v_mul_f32 v88, v86, v86
  ds_read_b128 v[196:199], v47 offset:18432
  s_waitcnt lgkmcnt(7)
  v_mfma_f32_16x16x32_bf16 v[112:115], v[108:111], a[80:83], v[112:115]
  v_mul_f32 v89, v87, v86
  ds_read_b128 v[200:203], v47 offset:20480
  s_waitcnt lgkmcnt(7)
  v_mfma_f32_16x16x32_bf16 v[116:119], v[108:111], a[84:87], v[116:119]
  ds_read_b128 v[204:207], v47 offset:22528
  v_mfma_f32_16x16x32_bf16 v[208:211], v[160:163], a[80:83], v[208:211]
  v_fma_f32 v88, -v87, v87, v88
  v_fmac_f32 v89, v86, v87
  v_mfma_f32_16x16x32_bf16 v[232:235], v[160:163], a[84:87], v[232:235]
  v_mul_f32 v90, v88, v86
  v_mul_f32 v91, v89, v86
  v_mfma_f32_16x16x32_bf16 v[212:215], v[164:167], a[80:83], v[212:215]
  s_waitcnt lgkmcnt(6)
  s_add_u32 m0, s98, 7168
  s_nop 0
  buffer_load_dwordx4 v136, s[52:55], 0 offen offset:1024 lds
  v_mfma_f32_16x16x32_bf16 v[236:239], v[164:167], a[84:87], v[236:239]
  s_add_u32 m0, s98, 8192
  v_fma_f32 v90, -v89, v87, v90
  v_fmac_f32 v91, v88, v87
  v_mfma_f32_16x16x32_bf16 v[216:219], v[168:171], a[80:83], v[216:219]
  v_mul_f32 v54, v88, v88
  v_mul_f32 v55, v89, v88
  v_mfma_f32_16x16x32_bf16 v[240:243], v[168:171], a[84:87], v[240:243]
  v_fma_f32 v54, -v89, v89, v54
  v_fmac_f32 v55, v88, v89
  v_mfma_f32_16x16x32_bf16 v[220:223], v[172:175], a[80:83], v[220:223]
  buffer_load_dwordx4 v137, s[52:55], 0 offen offset:1024 lds
  v_mfma_f32_16x16x32_bf16 v[244:247], v[172:175], a[84:87], v[244:247]
  s_add_u32 m0, s98, 9216
  v_mov_b32 v56, 1.0
  v_mov_b32 v57, 0
  v_mfma_f32_16x16x32_bf16 v[224:227], v[176:179], a[80:83], v[224:227]
  s_waitcnt vmcnt(12)
  ds_read_b128 a[96:99], v150 offset:0
  v_cmp_eq_u32 vcc, 1, v6
  s_nop 1
  v_cndmask_b32 v56, v56, v86, vcc
  v_cndmask_b32 v57, v57, v87, vcc
  v_mfma_f32_16x16x32_bf16 v[248:251], v[176:179], a[84:87], v[248:251]
  buffer_load_dwordx4 v136, s[56:59], 0 offen offset:1024 lds
  v_mfma_f32_16x16x32_bf16 v[228:231], v[180:183], a[80:83], v[228:231]
  ds_read_b128 a[100:103], v150 offset:2048
  s_add_u32 m0, s98, 10240
  v_cmp_eq_u32 vcc, 2, v6
  s_nop 1
  v_cndmask_b32 v56, v56, v88, vcc
  v_cndmask_b32 v57, v57, v89, vcc
  v_mfma_f32_16x16x32_bf16 v[252:255], v[180:183], a[84:87], v[252:255]
  v_cmp_eq_u32 vcc, 3, v6
  s_nop 1
  v_cndmask_b32 v56, v56, v90, vcc
  v_cndmask_b32 v57, v57, v91, vcc
  v_mov_b32 v58, 1.0
  v_mov_b32 v59, 0
  v_cmp_eq_u32 vcc, 1, v6
  s_nop 1
  v_cndmask_b32 v58, v58, v52, vcc
  v_cndmask_b32 v59, v59, v53, vcc
  v_cmp_eq_u32 vcc, 2, v6
  s_nop 1
  v_cndmask_b32 v58, v58, v82, vcc
  v_cndmask_b32 v59, v59, v83, vcc
  v_cmp_eq_u32 vcc, 3, v6
  s_nop 1
  v_cndmask_b32 v58, v58, v84, vcc
  v_cndmask_b32 v59, v59, v85, vcc
  v_and_b32 v43, 0xffff0000, v41
  v_lshlrev_b32 v42, 16, v41
  v_and_b32 v41, 0xffff0000, v40
  v_lshlrev_b32 v40, 16, v40
  s_barrier
  v_mfma_f32_16x16x32_bf16 v[112:115], v[108:111], a[88:91], v[112:115]
  buffer_load_dwordx4 v137, s[56:59], 0 offen offset:1024 lds
  v_mfma_f32_16x16x32_bf16 v[116:119], v[108:111], a[92:95], v[116:119]
  s_waitcnt lgkmcnt(5)
  ds_read_b128 v[160:163], v46 offset:24576
  v_mfma_f32_16x16x32_bf16 v[208:211], v[184:187], a[88:91], v[208:211]
  ds_read_b128 v[164:167], v46 offset:26624
  v_mfma_f32_16x16x32_bf16 v[232:235], v[184:187], a[92:95], v[232:235]
  ds_read_b128 v[168:171], v46 offset:28672
  v_mfma_f32_16x16x32_bf16 v[212:215], v[188:191], a[88:91], v[212:215]
  s_mov_b32 s93, 655360
  buffer_load_dwordx4 v[76:79], v66, s[44:47], s93 offen sc1
  v_mfma_f32_16x16x32_bf16 v[236:239], v[188:191], a[92:95], v[236:239]
  ds_read_b128 v[172:175], v46 offset:30720
  v_mfma_f32_16x16x32_bf16 v[216:219], v[192:195], a[88:91], v[216:219]
  ds_read_b128 v[176:179], v46 offset:32768
  v_mfma_f32_16x16x32_bf16 v[240:243], v[192:195], a[92:95], v[240:243]
  s_waitcnt lgkmcnt(7)
  ds_read_b128 v[180:183], v46 offset:34816
  v_mfma_f32_16x16x32_bf16 v[220:223], v[196:199], a[88:91], v[220:223]
  s_mov_b32 s93, 659456
  buffer_load_dwordx4 v[80:83], v66, s[44:47], s93 offen sc1
  v_mfma_f32_16x16x32_bf16 v[244:247], v[196:199], a[92:95], v[244:247]
  ds_read_b128 a[104:107], v151 offset:0
  v_mfma_f32_16x16x32_bf16 v[224:227], v[200:203], a[88:91], v[224:227]
  ds_read_b128 a[108:111], v151 offset:2048
  v_mfma_f32_16x16x32_bf16 v[248:251], v[200:203], a[92:95], v[248:251]
  v_mfma_f32_16x16x32_bf16 v[228:231], v[204:207], a[88:91], v[228:231]
  s_mov_b32 s93, 663552
  buffer_load_dwordx4 v[84:87], v66, s[44:47], s93 offen sc1
  v_mfma_f32_16x16x32_bf16 v[252:255], v[204:207], a[92:95], v[252:255]
  ds_read_b128 v[184:187], v47 offset:24576
  s_waitcnt lgkmcnt(10)
  v_mfma_f32_16x16x32_bf16 v[112:115], v[108:111], a[96:99], v[112:115]
  ds_read_b128 v[188:191], v47 offset:26624
  s_waitcnt lgkmcnt(10)
  v_mfma_f32_16x16x32_bf16 v[116:119], v[108:111], a[100:103], v[116:119]
  s_waitcnt lgkmcnt(7)
  ds_read_b128 v[192:195], v47 offset:28672
  v_mfma_f32_16x16x32_bf16 v[208:211], v[160:163], a[96:99], v[208:211]
  s_mov_b32 s93, 667648
  buffer_load_dwordx4 v[88:91], v66, s[44:47], s93 offen sc1
  v_mfma_f32_16x16x32_bf16 v[232:235], v[160:163], a[100:103], v[232:235]
  ds_read_b128 v[196:199], v47 offset:30720
  v_mfma_f32_16x16x32_bf16 v[212:215], v[164:167], a[96:99], v[212:215]
  ds_read_b128 v[200:203], v47 offset:32768
  v_mfma_f32_16x16x32_bf16 v[236:239], v[164:167], a[100:103], v[236:239]
  ds_read_b128 v[204:207], v47 offset:34816
  v_mfma_f32_16x16x32_bf16 v[216:219], v[168:171], a[96:99], v[216:219]
  s_mov_b32 s93, 671744
  buffer_load_dwordx4 v[92:95], v66, s[44:47], s93 offen sc1
  v_mfma_f32_16x16x32_bf16 v[240:243], v[168:171], a[100:103], v[240:243]
  s_waitcnt lgkmcnt(8)
  s_waitcnt vmcnt(12)
  ds_read_b128 a[112:115], v150 offset:4096
  v_mfma_f32_16x16x32_bf16 v[220:223], v[172:175], a[96:99], v[220:223]
  v_mfma_f32_16x16x32_bf16 v[244:247], v[172:175], a[100:103], v[244:247]
  ds_read_b128 a[116:119], v150 offset:6144
  v_mfma_f32_16x16x32_bf16 v[224:227], v[176:179], a[96:99], v[224:227]
  s_mov_b32 s93, 675840
  buffer_load_dwordx4 v[96:99], v66, s[44:47], s93 offen sc1
  v_mfma_f32_16x16x32_bf16 v[248:251], v[176:179], a[100:103], v[248:251]
  ds_read_b128 a[120:123], v151 offset:4096
  s_cmp_lt_u32 s77, 6
  s_cselect_b32 s62, 2359296, 0
  s_mov_b32 s66, s62
  s_mov_b32 s60, s28
  s_and_b32 s61, s29, 0xffff
  s_mov_b32 s63, 0x20000
  v_mfma_f32_16x16x32_bf16 v[228:231], v[180:183], a[96:99], v[228:231]
  ds_read_b128 a[124:127], v151 offset:6144
  s_mov_b32 s64, s30
  s_and_b32 s65, s31, 0xffff
  s_mov_b32 s67, 0x20000
  v_mfma_f32_16x16x32_bf16 v[252:255], v[180:183], a[100:103], v[252:255]
  s_barrier
  ds_read_b128 v[160:163], v46 offset:36864
  s_waitcnt lgkmcnt(12)
  v_mfma_f32_16x16x32_bf16 v[112:115], v[108:111], a[104:107], v[112:115]
  v_lshrrev_b32 v15, 3, v1
  ds_read_b128 v[164:167], v46 offset:38912
  s_waitcnt lgkmcnt(12)
  v_mfma_f32_16x16x32_bf16 v[116:119], v[108:111], a[108:111], v[116:119]
  s_waitcnt lgkmcnt(9)
  ds_read_b128 v[168:171], v46 offset:40960
  v_mfma_f32_16x16x32_bf16 v[208:211], v[184:187], a[104:107], v[208:211]
  v_mul_u32_u24 v75, 1152, v15
  ds_read_b128 v[172:175], v46 offset:43008
  v_mfma_f32_16x16x32_bf16 v[232:235], v[184:187], a[108:111], v[232:235]
  v_and_b32 v15, 7, v1
  ds_read_b128 v[176:179], v46 offset:45056
  v_mfma_f32_16x16x32_bf16 v[212:215], v[188:191], a[104:107], v[212:215]
  v_lshl_add_u32 v75, v15, 4, v75
  ds_read_b128 v[180:183], v46 offset:47104
  v_mfma_f32_16x16x32_bf16 v[236:239], v[188:191], a[108:111], v[236:239]
  v_and_b32 v15, 31, v1
  s_lshl_b32 s94, s77, 9
  v_lshl_add_u32 v15, v15, 4, s94
  global_load_dwordx4 v[132:135], v15, s[32:33]
  v_mfma_f32_16x16x32_bf16 v[216:219], v[192:195], a[104:107], v[216:219]
  s_lshl2_add_u32 s93, s76, s79
  s_mul_i32 s93, s93, 27648
  s_lshl_b32 s94, s77, 7
  s_add_u32 s93, s93, s94
  v_add_u32 v75, s93, v75
  v_subrev_u32 v100, 9216, v75
  v_mfma_f32_16x16x32_bf16 v[240:243], v[192:195], a[108:111], v[240:243]
  s_waitcnt lgkmcnt(10)
  s_mul_i32 s5, s79, 7168
  s_mov_b32 m0, s5
  v_mfma_f32_16x16x32_bf16 v[220:223], v[196:199], a[104:107], v[220:223]
  buffer_load_dwordx4 v100, s[60:63], 0 offen lds
  v_mfma_f32_16x16x32_bf16 v[244:247], v[196:199], a[108:111], v[244:247]
  s_add_u32 m0, s5, 1024
  v_mfma_f32_16x16x32_bf16 v[224:227], v[200:203], a[104:107], v[224:227]
  v_mfma_f32_16x16x32_bf16 v[248:251], v[200:203], a[108:111], v[248:251]
  v_mfma_f32_16x16x32_bf16 v[228:231], v[204:207], a[104:107], v[228:231]
  s_mov_b32 s95, 0
  buffer_load_dwordx4 v75, s[60:63], s95 offen lds
  v_mfma_f32_16x16x32_bf16 v[252:255], v[204:207], a[108:111], v[252:255]
  ds_read_b128 v[184:187], v47 offset:36864
  s_add_u32 m0, s5, 4096
  s_waitcnt lgkmcnt(10)
  v_mfma_f32_16x16x32_bf16 v[112:115], v[108:111], a[112:115], v[112:115]
  ds_read_b128 v[188:191], v47 offset:38912
  s_waitcnt lgkmcnt(10)
  v_mfma_f32_16x16x32_bf16 v[116:119], v[108:111], a[116:119], v[116:119]
  s_waitcnt lgkmcnt(5)
  ds_read_b128 v[192:195], v47 offset:40960
  v_mfma_f32_16x16x32_bf16 v[208:211], v[160:163], a[112:115], v[208:211]
  s_mov_b32 s95, 0
  buffer_load_dwordx4 v75, s[64:67], s95 offen lds
  v_mfma_f32_16x16x32_bf16 v[232:235], v[160:163], a[116:119], v[232:235]
  ds_read_b128 v[196:199], v47 offset:43008
  s_add_u32 m0, s5, 2048
  v_mfma_f32_16x16x32_bf16 v[212:215], v[164:167], a[112:115], v[212:215]
  ds_read_b128 v[200:203], v47 offset:45056
  v_mfma_f32_16x16x32_bf16 v[236:239], v[164:167], a[116:119], v[236:239]
  ds_read_b128 v[204:207], v47 offset:47104
  v_mfma_f32_16x16x32_bf16 v[216:219], v[168:171], a[112:115], v[216:219]
  s_mov_b32 s95, 9216
  buffer_load_dwordx4 v75, s[60:63], s95 offen lds
  v_mfma_f32_16x16x32_bf16 v[240:243], v[168:171], a[116:119], v[240:243]
  s_waitcnt lgkmcnt(6)
  s_add_u32 m0, s5, 5120
  v_mfma_f32_16x16x32_bf16 v[220:223], v[172:175], a[112:115], v[220:223]
  v_mfma_f32_16x16x32_bf16 v[244:247], v[172:175], a[116:119], v[244:247]
  s_waitcnt vmcnt(11)
  ds_read_b128 a[128:131], v150 offset:8192
  v_mfma_f32_16x16x32_bf16 v[224:227], v[176:179], a[112:115], v[224:227]
  s_mov_b32 s95, 9216
  buffer_load_dwordx4 v75, s[64:67], s95 offen lds
  v_mfma_f32_16x16x32_bf16 v[248:251], v[176:179], a[116:119], v[248:251]
  ds_read_b128 a[132:135], v150 offset:10240
  s_add_u32 m0, s5, 3072
  v_mfma_f32_16x16x32_bf16 v[228:231], v[180:183], a[112:115], v[228:231]
  ds_read_b128 a[136:139], v151 offset:8192
  v_mfma_f32_16x16x32_bf16 v[252:255], v[180:183], a[116:119], v[252:255]
  ds_read_b128 a[140:143], v151 offset:10240
  s_waitcnt lgkmcnt(0)
  s_barrier
  v_mfma_f32_16x16x32_bf16 v[112:115], v[108:111], a[120:123], v[112:115]
  s_mov_b32 s95, 18432
  buffer_load_dwordx4 v75, s[60:63], s95 offen lds
  v_mfma_f32_16x16x32_bf16 v[116:119], v[108:111], a[124:127], v[116:119]
  ds_read_b128 v[160:163], v46 offset:49152
  s_add_u32 m0, s5, 6144
  v_mfma_f32_16x16x32_bf16 v[208:211], v[184:187], a[120:123], v[208:211]
  ds_read_b128 v[164:167], v46 offset:51200
  v_mfma_f32_16x16x32_bf16 v[232:235], v[184:187], a[124:127], v[232:235]
  ds_read_b128 v[168:171], v46 offset:53248
  v_mfma_f32_16x16x32_bf16 v[212:215], v[188:191], a[120:123], v[212:215]
  s_mov_b32 s95, 18432
  buffer_load_dwordx4 v75, s[64:67], s95 offen lds
  v_mfma_f32_16x16x32_bf16 v[236:239], v[188:191], a[124:127], v[236:239]
  ds_read_b128 v[172:175], v46 offset:55296
  v_mfma_f32_16x16x32_bf16 v[216:219], v[192:195], a[120:123], v[216:219]
  ds_read_b128 v[176:179], v46 offset:57344
  v_mfma_f32_16x16x32_bf16 v[240:243], v[192:195], a[124:127], v[240:243]
  ds_read_b128 v[180:183], v46 offset:59392
  v_mfma_f32_16x16x32_bf16 v[220:223], v[196:199], a[120:123], v[220:223]
  buffer_load_dword v157, v159, s[44:47], 0 offen sc1
  v_mfma_f32_16x16x32_bf16 v[244:247], v[196:199], a[124:127], v[244:247]
  v_lshrrev_b32 v12, 3, v1
  v_mul_u32_u24 v12, 35840, v12
  v_lshl_add_u32 v12, v1, 7, v12
  v_cmp_gt_u32 vcc, 48, v1
  s_nop 1
  v_cndmask_b32 v12, v7, v12, vcc
  v_mfma_f32_16x16x32_bf16 v[224:227], v[200:203], a[120:123], v[224:227]
  s_waitcnt vmcnt(9)
  v_xor_b32 v127, v77, v67
  v_bitop3_b32 v127, v127, v79, v14 bitop3:0xf6
  v_bitop3_b32 v127, v127, v81, v67 bitop3:0xf6
  v_bitop3_b32 v127, v127, v83, v14 bitop3:0xf6
  v_bitop3_b32 v127, v127, v85, v67 bitop3:0xf6
  v_bitop3_b32 v127, v127, v87, v14 bitop3:0xf6
  v_bitop3_b32 v127, v127, v89, v67 bitop3:0xf6
  v_bitop3_b32 v127, v127, v91, v14 bitop3:0xf6
  v_bitop3_b32 v127, v127, v93, v67 bitop3:0xf6
  v_bitop3_b32 v127, v127, v95, v14 bitop3:0xf6
  v_bitop3_b32 v127, v127, v97, v67 bitop3:0xf6
  v_bitop3_b32 v127, v127, v99, v14 bitop3:0xf6
  v_cmp_ne_u32 vcc, 0, v127
  s_mov_b32 s78, 1
  s_cmp_lg_u64 vcc, 0
  s_cbranch_scc1 L_poll_1
L_pollc_2:
  v_mfma_f32_16x16x32_bf16 v[248:251], v[200:203], a[124:127], v[248:251]
  s_mul_i32 s95, s76, 216
  s_add_u32 s95, s95, s99
  s_lshl_b32 s95, s95, 10
  s_add_u32 s95, s95, 7077888
  buffer_load_dword v8, v12, s[44:47], s95 offen sc1
  v_mfma_f32_16x16x32_bf16 v[228:231], v[204:207], a[120:123], v[228:231]
  v_add_f32_dpp v76, v76, v76 row_ror:8 row_mask:0xf bank_mask:0x3
  v_add_f32_dpp v80, v80, v80 row_ror:8 row_mask:0xf bank_mask:0x3
  v_mfma_f32_16x16x32_bf16 v[252:255], v[204:207], a[124:127], v[252:255]
  ds_read_b128 v[184:187], v47 offset:49152
  v_add_f32_dpp v84, v84, v84 row_ror:8 row_mask:0xf bank_mask:0x3
  v_add_f32_dpp v78, v78, v78 row_ror:8 row_mask:0xf bank_mask:0x3
  v_mfma_f32_16x16x32_bf16 v[112:115], v[108:111], a[128:131], v[112:115]
  ds_read_b128 v[188:191], v47 offset:51200
  v_add_f32_dpp v82, v82, v82 row_ror:8 row_mask:0xf bank_mask:0x3
  v_add_f32_dpp v86, v86, v86 row_ror:8 row_mask:0xf bank_mask:0x3
  v_mfma_f32_16x16x32_bf16 v[116:119], v[108:111], a[132:135], v[116:119]
  s_waitcnt lgkmcnt(5)
  s_mov_b32 s95, 1196032
  buffer_load_dword v8, v65, s[44:47], s95 offen sc1
  v_mfma_f32_16x16x32_bf16 v[208:211], v[160:163], a[128:131], v[208:211]
  ds_read_b128 v[192:195], v47 offset:53248
  v_add_f32_dpp v76, v88, v88 row_ror:8 row_mask:0xf bank_mask:0xc
  v_add_f32_dpp v80, v92, v92 row_ror:8 row_mask:0xf bank_mask:0xc
  v_mfma_f32_16x16x32_bf16 v[232:235], v[160:163], a[132:135], v[232:235]
  ds_read_b128 v[196:199], v47 offset:55296
  v_add_f32_dpp v84, v96, v96 row_ror:8 row_mask:0xf bank_mask:0xc
  v_add_f32_dpp v78, v90, v90 row_ror:8 row_mask:0xf bank_mask:0xc
  v_mfma_f32_16x16x32_bf16 v[212:215], v[164:167], a[128:131], v[212:215]
  ds_read_b128 v[200:203], v47 offset:57344
  v_add_f32_dpp v82, v94, v94 row_ror:8 row_mask:0xf bank_mask:0xc
  v_add_f32_dpp v86, v98, v98 row_ror:8 row_mask:0xf bank_mask:0xc
  v_mfma_f32_16x16x32_bf16 v[236:239], v[164:167], a[132:135], v[236:239]
  v_lshrrev_b32 v12, 1, v1
  v_min_u32 v12, 4, v12
  v_mul_u32_u24 v12, 5632, v12
  v_and_b32 v13, 1, v1
  v_lshl_add_u32 v12, v13, 7, v12
  s_lshl_b32 s95, s76, 8
  s_add_u32 s95, s95, 16384
  buffer_load_dword v8, v12, s[44:47], s95 offen sc1
  v_mfma_f32_16x16x32_bf16 v[216:219], v[168:171], a[128:131], v[216:219]
  ds_read_b128 v[204:207], v47 offset:59392
  v_add_f32_dpp v76, v76, v76 row_half_mirror row_mask:0xf bank_mask:0x5
  v_add_f32_dpp v84, v84, v84 row_half_mirror row_mask:0xf bank_mask:0xf
  v_mfma_f32_16x16x32_bf16 v[240:243], v[168:171], a[132:135], v[240:243]
  s_waitcnt lgkmcnt(6)
  v_add_f32_dpp v78, v78, v78 row_half_mirror row_mask:0xf bank_mask:0x5
  v_add_f32_dpp v86, v86, v86 row_half_mirror row_mask:0xf bank_mask:0xf
  v_mfma_f32_16x16x32_bf16 v[220:223], v[172:175], a[128:131], v[220:223]
  v_add_f32_dpp v76, v80, v80 row_half_mirror row_mask:0xf bank_mask:0xa
  v_add_f32_dpp v78, v82, v82 row_half_mirror row_mask:0xf bank_mask:0xa
  v_mfma_f32_16x16x32_bf16 v[244:247], v[172:175], a[132:135], v[244:247]
  v_add_f32_dpp v84, v84, v84 quad_perm:[1,0,3,2] row_mask:0xf bank_mask:0xf
  v_add_f32_dpp v86, v86, v86 quad_perm:[1,0,3,2] row_mask:0xf bank_mask:0xf
  v_mfma_f32_16x16x32_bf16 v[224:227], v[176:179], a[128:131], v[224:227]
  v_add_f32_dpp v76, v76, v76 quad_perm:[1,0,3,2] row_mask:0xf bank_mask:0xf
  v_add_f32_dpp v78, v78, v78 quad_perm:[1,0,3,2] row_mask:0xf bank_mask:0xf
  v_mfma_f32_16x16x32_bf16 v[248:251], v[176:179], a[132:135], v[248:251]
  v_add_f32_dpp v84, v84, v84 quad_perm:[2,3,0,1] row_mask:0xf bank_mask:0xf
  v_add_f32_dpp v86, v86, v86 quad_perm:[2,3,0,1] row_mask:0xf bank_mask:0xf
  v_mfma_f32_16x16x32_bf16 v[228:231], v[180:183], a[128:131], v[228:231]
  v_add_f32_dpp v76, v76, v76 quad_perm:[2,3,0,1] row_mask:0xf bank_mask:0xf
  v_add_f32_dpp v78, v78, v78 quad_perm:[2,3,0,1] row_mask:0xf bank_mask:0xf
  v_mfma_f32_16x16x32_bf16 v[252:255], v[180:183], a[132:135], v[252:255]
  v_mul_f32 v128, 0x3ae38e39, v76
  v_mul_f32 v129, 0x3ae38e39, v78
  v_mfma_f32_16x16x32_bf16 v[112:115], v[108:111], a[136:139], v[112:115]
  v_mul_f32 v130, 0x3ae38e39, v84
  v_mul_f32 v131, 0x3ae38e39, v86
  v_mfma_f32_16x16x32_bf16 v[116:119], v[108:111], a[140:143], v[116:119]
  s_waitcnt lgkmcnt(3)
  v_fma_f32 v129, -v128, v128, v129
  v_fma_f32 v131, -v130, v130, v131
  v_mfma_f32_16x16x32_bf16 v[208:211], v[184:187], a[136:139], v[208:211]
  v_max_f32 v129, 0, v129
  v_max_f32 v131, 0, v131
  v_mfma_f32_16x16x32_bf16 v[232:235], v[184:187], a[140:143], v[232:235]
  v_cvt_pk_bf16_f32 v128, v128, v128
  v_cvt_pk_bf16_f32 v130, v130, v130
  v_mfma_f32_16x16x32_bf16 v[212:215], v[188:191], a[136:139], v[212:215]
  v_cvt_pk_bf16_f32 v129, v129, v129
  v_cvt_pk_bf16_f32 v131, v131, v131
  v_mfma_f32_16x16x32_bf16 v[236:239], v[188:191], a[140:143], v[236:239]
  v_lshlrev_b32 v128, 16, v128
  v_lshlrev_b32 v130, 16, v130
  v_mfma_f32_16x16x32_bf16 v[216:219], v[192:195], a[136:139], v[216:219]
  v_lshlrev_b32 v129, 16, v129
  v_lshlrev_b32 v131, 16, v131
  v_mfma_f32_16x16x32_bf16 v[240:243], v[192:195], a[140:143], v[240:243]
  s_waitcnt lgkmcnt(0)
  v_add_f32 v129, 0x3727c5ac, v129
  v_add_f32 v131, 0x3727c5ac, v131
  v_mfma_f32_16x16x32_bf16 v[220:223], v[196:199], a[136:139], v[220:223]
  v_cvt_pk_bf16_f32 v129, v129, v129
  v_cvt_pk_bf16_f32 v131, v131, v131
  v_mfma_f32_16x16x32_bf16 v[244:247], v[196:199], a[140:143], v[244:247]
  v_lshlrev_b32 v129, 16, v129
  v_lshlrev_b32 v131, 16, v131
  v_mfma_f32_16x16x32_bf16 v[224:227], v[200:203], a[136:139], v[224:227]
  v_sqrt_f32 v129, v129
  v_sqrt_f32 v131, v131
  v_mfma_f32_16x16x32_bf16 v[248:251], v[200:203], a[140:143], v[248:251]
  v_cvt_pk_bf16_f32 v129, v129, v129
  v_cvt_pk_bf16_f32 v131, v131, v131
  v_mfma_f32_16x16x32_bf16 v[228:231], v[204:207], a[136:139], v[228:231]
  v_lshlrev_b32 v129, 16, v129
  v_lshlrev_b32 v131, 16, v131
  v_mfma_f32_16x16x32_bf16 v[252:255], v[204:207], a[140:143], v[252:255]
  v_rcp_f32 v129, v129
  v_rcp_f32 v131, v131
  v_mov_b32 v62, v128
  v_mov_b32 v63, v130
  v_cndmask_b32 v76, v129, v131, s[26:27]
  v_cndmask_b32 v77, v128, v130, s[26:27]
  v_mul_f32 v77, v77, v76
  s_mov_b64 exec, s[40:41]
  ds_write2_b32 v68, v76, v77 offset0:0 offset1:2
  s_mov_b64 exec, -1
  s_waitcnt lgkmcnt(0)
  s_barrier
  v_mov_b32 v60, v112
  v_mov_b32 v61, v116
  ds_read_b128 v[160:163], v73 offset:0
  ds_read_b128 v[164:167], v73 offset:16
  ds_read_b128 v[168:171], v73 offset:32
  ds_read_b128 v[172:175], v73 offset:48
  ds_read_b128 v[176:179], v73 offset:64
  ds_read_b128 v[180:183], v73 offset:80
  ds_read_b128 v[184:187], v73 offset:96
  ds_read_b128 v[188:191], v73 offset:112
  ds_read_b128 v[192:195], v73 offset:128
  ds_read_b128 v[196:199], v73 offset:144
  ds_read_b128 v[200:203], v73 offset:160
  ds_read_b128 v[204:207], v73 offset:176
  s_waitcnt lgkmcnt(11)
  v_pk_mul_f32 v[208:209], v[208:209], v[160:161]
  v_pk_mul_f32 v[232:233], v[232:233], v[160:161]
  v_pk_fma_f32 v[208:209], v[162:163], v[60:61], v[208:209] op_sel:[0,0,0] op_sel_hi:[1,0,1] neg_lo:[1,0,0] neg_hi:[1,0,0]
  v_pk_fma_f32 v[232:233], v[162:163], v[60:61], v[232:233] op_sel:[0,1,0] op_sel_hi:[1,1,1] neg_lo:[1,0,0] neg_hi:[1,0,0]
  s_waitcnt lgkmcnt(10)
  v_pk_mul_f32 v[210:211], v[210:211], v[164:165]
  v_pk_mul_f32 v[234:235], v[234:235], v[164:165]
  v_pk_fma_f32 v[210:211], v[166:167], v[60:61], v[210:211] op_sel:[0,0,0] op_sel_hi:[1,0,1] neg_lo:[1,0,0] neg_hi:[1,0,0]
  v_pk_fma_f32 v[234:235], v[166:167], v[60:61], v[234:235] op_sel:[0,1,0] op_sel_hi:[1,1,1] neg_lo:[1,0,0] neg_hi:[1,0,0]
  v_pk_fma_f32 v[80:81], v[208:209], v[48:49], v[210:211] op_sel:[0,0,0] op_sel_hi:[1,0,1]
  v_pk_fma_f32 v[82:83], v[232:233], v[48:49], v[234:235] op_sel:[0,0,0] op_sel_hi:[1,0,1]
  v_pk_fma_f32 v[80:81], v[232:233], v[48:49], v[80:81] op_sel:[0,1,0] op_sel_hi:[1,1,1] neg_lo:[1,0,0] neg_hi:[1,0,0]
  v_pk_fma_f32 v[82:83], v[208:209], v[48:49], v[82:83] op_sel:[0,1,0] op_sel_hi:[1,1,1]
  s_waitcnt lgkmcnt(9)
  v_pk_mul_f32 v[212:213], v[212:213], v[168:169]
  v_pk_mul_f32 v[236:237], v[236:237], v[168:169]
  v_pk_fma_f32 v[212:213], v[170:171], v[60:61], v[212:213] op_sel:[0,0,0] op_sel_hi:[1,0,1] neg_lo:[1,0,0] neg_hi:[1,0,0]
  v_pk_fma_f32 v[236:237], v[170:171], v[60:61], v[236:237] op_sel:[0,1,0] op_sel_hi:[1,1,1] neg_lo:[1,0,0] neg_hi:[1,0,0]
  v_pk_fma_f32 v[76:77], v[80:81], v[48:49], v[212:213] op_sel:[0,0,0] op_sel_hi:[1,0,1]
  v_pk_fma_f32 v[78:79], v[82:83], v[48:49], v[236:237] op_sel:[0,0,0] op_sel_hi:[1,0,1]
  v_pk_fma_f32 v[76:77], v[82:83], v[48:49], v[76:77] op_sel:[0,1,0] op_sel_hi:[1,1,1] neg_lo:[1,0,0] neg_hi:[1,0,0]
  v_pk_fma_f32 v[78:79], v[80:81], v[48:49], v[78:79] op_sel:[0,1,0] op_sel_hi:[1,1,1]
  s_waitcnt lgkmcnt(8)
  v_pk_mul_f32 v[214:215], v[214:215], v[172:173]
  v_pk_mul_f32 v[238:239], v[238:239], v[172:173]
  v_pk_fma_f32 v[214:215], v[174:175], v[60:61], v[214:215] op_sel:[0,0,0] op_sel_hi:[1,0,1] neg_lo:[1,0,0] neg_hi:[1,0,0]
  v_pk_fma_f32 v[238:239], v[174:175], v[60:61], v[238:239] op_sel:[0,1,0] op_sel_hi:[1,1,1] neg_lo:[1,0,0] neg_hi:[1,0,0]
  v_pk_fma_f32 v[80:81], v[76:77], v[48:49], v[214:215] op_sel:[0,0,0] op_sel_hi:[1,0,1]
  v_pk_fma_f32 v[82:83], v[78:79], v[48:49], v[238:239] op_sel:[0,0,0] op_sel_hi:[1,0,1]
  v_pk_fma_f32 v[80:81], v[78:79], v[48:49], v[80:81] op_sel:[0,1,0] op_sel_hi:[1,1,1] neg_lo:[1,0,0] neg_hi:[1,0,0]
  v_pk_fma_f32 v[82:83], v[76:77], v[48:49], v[82:83] op_sel:[0,1,0] op_sel_hi:[1,1,1]
  s_waitcnt lgkmcnt(7)
  v_pk_mul_f32 v[216:217], v[216:217], v[176:177]
  v_pk_mul_f32 v[240:241], v[240:241], v[176:177]
  v_pk_fma_f32 v[216:217], v[178:179], v[60:61], v[216:217] op_sel:[0,0,0] op_sel_hi:[1,0,1] neg_lo:[1,0,0] neg_hi:[1,0,0]
  v_pk_fma_f32 v[240:241], v[178:179], v[60:61], v[240:241] op_sel:[0,1,0] op_sel_hi:[1,1,1] neg_lo:[1,0,0] neg_hi:[1,0,0]
  v_pk_fma_f32 v[76:77], v[80:81], v[48:49], v[216:217] op_sel:[0,0,0] op_sel_hi:[1,0,1]
  v_pk_fma_f32 v[78:79], v[82:83], v[48:49], v[240:241] op_sel:[0,0,0] op_sel_hi:[1,0,1]
  v_pk_fma_f32 v[76:77], v[82:83], v[48:49], v[76:77] op_sel:[0,1,0] op_sel_hi:[1,1,1] neg_lo:[1,0,0] neg_hi:[1,0,0]
  v_pk_fma_f32 v[78:79], v[80:81], v[48:49], v[78:79] op_sel:[0,1,0] op_sel_hi:[1,1,1]
  s_waitcnt lgkmcnt(6)
  v_pk_mul_f32 v[218:219], v[218:219], v[180:181]
  v_pk_mul_f32 v[242:243], v[242:243], v[180:181]
  v_pk_fma_f32 v[218:219], v[182:183], v[60:61], v[218:219] op_sel:[0,0,0] op_sel_hi:[1,0,1] neg_lo:[1,0,0] neg_hi:[1,0,0]
  v_pk_fma_f32 v[242:243], v[182:183], v[60:61], v[242:243] op_sel:[0,1,0] op_sel_hi:[1,1,1] neg_lo:[1,0,0] neg_hi:[1,0,0]
  v_pk_fma_f32 v[80:81], v[76:77], v[48:49], v[218:219] op_sel:[0,0,0] op_sel_hi:[1,0,1]
  v_pk_fma_f32 v[82:83], v[78:79], v[48:49], v[242:243] op_sel:[0,0,0] op_sel_hi:[1,0,1]
  v_pk_fma_f32 v[80:81], v[78:79], v[48:49], v[80:81] op_sel:[0,1,0] op_sel_hi:[1,1,1] neg_lo:[1,0,0] neg_hi:[1,0,0]
  v_pk_fma_f32 v[82:83], v[76:77], v[48:49], v[82:83] op_sel:[0,1,0] op_sel_hi:[1,1,1]
  s_waitcnt lgkmcnt(5)
  v_pk_mul_f32 v[220:221], v[220:221], v[184:185]
  v_pk_mul_f32 v[244:245], v[244:245], v[184:185]
  v_pk_fma_f32 v[220:221], v[186:187], v[60:61], v[220:221] op_sel:[0,0,0] op_sel_hi:[1,0,1] neg_lo:[1,0,0] neg_hi:[1,0,0]
  v_pk_fma_f32 v[244:245], v[186:187], v[60:61], v[244:245] op_sel:[0,1,0] op_sel_hi:[1,1,1] neg_lo:[1,0,0] neg_hi:[1,0,0]
  v_pk_fma_f32 v[76:77], v[80:81], v[48:49], v[220:221] op_sel:[0,0,0] op_sel_hi:[1,0,1]
  v_pk_fma_f32 v[78:79], v[82:83], v[48:49], v[244:245] op_sel:[0,0,0] op_sel_hi:[1,0,1]
  v_pk_fma_f32 v[76:77], v[82:83], v[48:49], v[76:77] op_sel:[0,1,0] op_sel_hi:[1,1,1] neg_lo:[1,0,0] neg_hi:[1,0,0]
  v_pk_fma_f32 v[78:79], v[80:81], v[48:49], v[78:79] op_sel:[0,1,0] op_sel_hi:[1,1,1]
  s_waitcnt lgkmcnt(4)
  v_pk_mul_f32 v[222:223], v[222:223], v[188:189]
  v_pk_mul_f32 v[246:247], v[246:247], v[188:189]
  v_pk_fma_f32 v[222:223], v[190:191], v[60:61], v[222:223] op_sel:[0,0,0] op_sel_hi:[1,0,1] neg_lo:[1,0,0] neg_hi:[1,0,0]
  v_pk_fma_f32 v[246:247], v[190:191], v[60:61], v[246:247] op_sel:[0,1,0] op_sel_hi:[1,1,1] neg_lo:[1,0,0] neg_hi:[1,0,0]
  v_pk_fma_f32 v[80:81], v[76:77], v[48:49], v[222:223] op_sel:[0,0,0] op_sel_hi:[1,0,1]
  v_pk_fma_f32 v[82:83], v[78:79], v[48:49], v[246:247] op_sel:[0,0,0] op_sel_hi:[1,0,1]
  v_pk_fma_f32 v[80:81], v[78:79], v[48:49], v[80:81] op_sel:[0,1,0] op_sel_hi:[1,1,1] neg_lo:[1,0,0] neg_hi:[1,0,0]
  v_pk_fma_f32 v[82:83], v[76:77], v[48:49], v[82:83] op_sel:[0,1,0] op_sel_hi:[1,1,1]
  s_waitcnt lgkmcnt(3)
  v_pk_mul_f32 v[224:225], v[224:225], v[192:193]
  v_pk_mul_f32 v[248:249], v[248:249], v[192:193]
  v_pk_fma_f32 v[224:225], v[194:195], v[60:61], v[224:225] op_sel:[0,0,0] op_sel_hi:[1,0,1] neg_lo:[1,0,0] neg_hi:[1,0,0]
  v_pk_fma_f32 v[248:249], v[194:195], v[60:61], v[248:249] op_sel:[0,1,0] op_sel_hi:[1,1,1] neg_lo:[1,0,0] neg_hi:[1,0,0]
  v_pk_fma_f32 v[76:77], v[80:81], v[48:49], v[224:225] op_sel:[0,0,0] op_sel_hi:[1,0,1]
  v_pk_fma_f32 v[78:79], v[82:83], v[48:49], v[248:249] op_sel:[0,0,0] op_sel_hi:[1,0,1]
  v_pk_fma_f32 v[76:77], v[82:83], v[48:49], v[76:77] op_sel:[0,1,0] op_sel_hi:[1,1,1] neg_lo:[1,0,0] neg_hi:[1,0,0]
  v_pk_fma_f32 v[78:79], v[80:81], v[48:49], v[78:79] op_sel:[0,1,0] op_sel_hi:[1,1,1]
  s_waitcnt lgkmcnt(2)
  v_pk_mul_f32 v[226:227], v[226:227], v[196:197]
  v_pk_mul_f32 v[250:251], v[250:251], v[196:197]
  v_pk_fma_f32 v[226:227], v[198:199], v[60:61], v[226:227] op_sel:[0,0,0] op_sel_hi:[1,0,1] neg_lo:[1,0,0] neg_hi:[1,0,0]
  v_pk_fma_f32 v[250:251], v[198:199], v[60:61], v[250:251] op_sel:[0,1,0] op_sel_hi:[1,1,1] neg_lo:[1,0,0] neg_hi:[1,0,0]
  v_pk_fma_f32 v[80:81], v[76:77], v[48:49], v[226:227] op_sel:[0,0,0] op_sel_hi:[1,0,1]
  v_pk_fma_f32 v[82:83], v[78:79], v[48:49], v[250:251] op_sel:[0,0,0] op_sel_hi:[1,0,1]
  v_pk_fma_f32 v[80:81], v[78:79], v[48:49], v[80:81] op_sel:[0,1,0] op_sel_hi:[1,1,1] neg_lo:[1,0,0] neg_hi:[1,0,0]
  v_pk_fma_f32 v[82:83], v[76:77], v[48:49], v[82:83] op_sel:[0,1,0] op_sel_hi:[1,1,1]
  s_waitcnt lgkmcnt(1)
  v_pk_mul_f32 v[228:229], v[228:229], v[200:201]
  v_pk_mul_f32 v[252:253], v[252:253], v[200:201]
  v_pk_fma_f32 v[228:229], v[202:203], v[60:61], v[228:229] op_sel:[0,0,0] op_sel_hi:[1,0,1] neg_lo:[1,0,0] neg_hi:[1,0,0]
  v_pk_fma_f32 v[252:253], v[202:203], v[60:61], v[252:253] op_sel:[0,1,0] op_sel_hi:[1,1,1] neg_lo:[1,0,0] neg_hi:[1,0,0]
  v_pk_fma_f32 v[76:77], v[80:81], v[48:49], v[228:229] op_sel:[0,0,0] op_sel_hi:[1,0,1]
  v_pk_fma_f32 v[78:79], v[82:83], v[48:49], v[252:253] op_sel:[0,0,0] op_sel_hi:[1,0,1]
  v_pk_fma_f32 v[76:77], v[82:83], v[48:49], v[76:77] op_sel:[0,1,0] op_sel_hi:[1,1,1] neg_lo:[1,0,0] neg_hi:[1,0,0]
  v_pk_fma_f32 v[78:79], v[80:81], v[48:49], v[78:79] op_sel:[0,1,0] op_sel_hi:[1,1,1]
  s_waitcnt lgkmcnt(0)
  v_pk_mul_f32 v[230:231], v[230:231], v[204:205]
  v_pk_mul_f32 v[254:255], v[254:255], v[204:205]
  v_pk_fma_f32 v[230:231], v[206:207], v[60:61], v[230:231] op_sel:[0,0,0] op_sel_hi:[1,0,1] neg_lo:[1,0,0] neg_hi:[1,0,0]
  v_pk_fma_f32 v[254:255], v[206:207], v[60:61], v[254:255] op_sel:[0,1,0] op_sel_hi:[1,1,1] neg_lo:[1,0,0] neg_hi:[1,0,0]
  v_pk_fma_f32 v[80:81], v[76:77], v[48:49], v[230:231] op_sel:[0,0,0] op_sel_hi:[1,0,1]
  v_pk_fma_f32 v[82:83], v[78:79], v[48:49], v[254:255] op_sel:[0,0,0] op_sel_hi:[1,0,1]
  v_pk_fma_f32 v[80:81], v[78:79], v[48:49], v[80:81] op_sel:[0,1,0] op_sel_hi:[1,1,1] neg_lo:[1,0,0] neg_hi:[1,0,0]
  v_pk_fma_f32 v[82:83], v[76:77], v[48:49], v[82:83] op_sel:[0,1,0] op_sel_hi:[1,1,1]
  v_mov_b32 v124, v80
  v_mov_b32 v125, v82
  v_mov_b32 v150, v81
  v_mov_b32 v151, v83
  v_pk_fma_f32 v[76:77], v[124:125], v[50:51], v[150:151] op_sel:[0,0,0] op_sel_hi:[1,0,1]
  v_pk_fma_f32 v[76:77], v[124:125], v[50:51], v[76:77] op_sel:[1,1,0] op_sel_hi:[0,1,1] neg_lo:[1,0,0]
  v_mov_b64 v[78:79], v[76:77]
  v_mov_b32 v13, v2
  v_mov_b32 v15, v2
  v_permlane16_swap_b32 v76, v78
  v_permlane16_swap_b32 v77, v79
  s_lshl_b32 s93, s99, 13
  v_mov_b64 v[80:81], v[76:77]
  v_mov_b64 v[82:83], v[78:79]
  s_add_u32 s93, s93, 65536
  v_permlane32_swap_b32 v76, v80
  v_permlane32_swap_b32 v77, v81
  v_permlane32_swap_b32 v78, v82
  v_permlane32_swap_b32 v79, v83
  v_pk_fma_f32 v[78:79], v[76:77], v[52:53], v[78:79] op_sel:[0,0,0] op_sel_hi:[1,0,1]
  v_pk_fma_f32 v[78:79], v[76:77], v[52:53], v[78:79] op_sel:[1,1,0] op_sel_hi:[0,1,1] neg_lo:[1,0,0]
  v_pk_fma_f32 v[80:81], v[78:79], v[52:53], v[80:81] op_sel:[0,0,0] op_sel_hi:[1,0,1]
  v_pk_fma_f32 v[80:81], v[78:79], v[52:53], v[80:81] op_sel:[1,1,0] op_sel_hi:[0,1,1] neg_lo:[1,0,0]
  v_pk_fma_f32 v[82:83], v[80:81], v[52:53], v[82:83] op_sel:[0,0,0] op_sel_hi:[1,0,1]
  v_pk_fma_f32 v[82:83], v[80:81], v[52:53], v[82:83] op_sel:[1,1,0] op_sel_hi:[0,1,1] neg_lo:[1,0,0]
  v_mov_b32 v12, v82
  v_mov_b32 v14, v83
  buffer_store_dwordx4 v[12:15], v69, s[44:47], s93 offen sc1
  v_mov_b32 v150, 0
  v_mov_b32 v151, 0
  v_cmp_eq_u32 vcc, 1, v6
  s_nop 1
  v_cndmask_b32 v150, v150, v76, vcc
  v_cndmask_b32 v151, v151, v77, vcc
  v_cmp_eq_u32 vcc, 2, v6
  s_nop 1
  v_cndmask_b32 v150, v150, v78, vcc
  v_cndmask_b32 v151, v151, v79, vcc
  v_cmp_eq_u32 vcc, 3, v6
  s_nop 1
  v_cndmask_b32 v150, v150, v80, vcc
  v_cndmask_b32 v151, v151, v81, vcc
  v_lshrrev_b32 v38, 5, v1
  v_and_b32 v39, 31, v1
  v_mul_u32_u24 v36, 1536, v38
  v_lshl_add_u32 v36, v39, 2, v36
  s_mul_i32 s93, s79, 7168
  s_add_u32 s93, s93, 512
  v_add_u32 v36, s93, v36
  v_add_u32 v37, 128, v36
  s_waitcnt vmcnt(5)
  ds_read2st64_b32 v[76:77], v36 offset0:0 offset1:1
  ds_read2st64_b32 v[78:79], v37 offset0:0 offset1:1
  ds_read2st64_b32 v[80:81], v36 offset0:2 offset1:3
  ds_read2st64_b32 v[82:83], v37 offset0:2 offset1:3
  ds_read2st64_b32 v[92:93], v36 offset0:14 offset1:15
  ds_read2st64_b32 v[94:95], v37 offset0:14 offset1:15
  ds_read2st64_b32 v[84:85], v36 offset0:4 offset1:5
  ds_read2st64_b32 v[86:87], v37 offset0:4 offset1:5
  ds_read2st64_b32 v[96:97], v36 offset0:16 offset1:17
  ds_read2st64_b32 v[98:99], v37 offset0:16 offset1:17
  ds_read2st64_b32 v[88:89], v36 offset0:6 offset1:7
  ds_read2st64_b32 v[90:91], v37 offset0:6 offset1:7
  ds_read2st64_b32 v[100:101], v36 offset0:18 offset1:19
  ds_read2st64_b32 v[102:103], v37 offset0:18 offset1:19
  v_sub_u32 v38, 1, v38
  v_lshlrev_b32 v38, 5, v38
  v_mul_u32_u24 v39, 528, v39
  s_lshl_b32 s93, s79, 6
  s_sub_u32 s93, 192, s93
  v_add3_u32 v38, v38, v39, s93
  s_mul_i32 s93, s79, 4224
  v_lshrrev_b32 v39, 5, v1
  v_lshlrev_b32 v39, 4, v39
  v_add3_u32 v39, v39, v4, s93
  v_mov_b32 v75, 0x3f803f80
  v_mov_b32 v195, v2
  v_mov_b32 v199, v2
  v_lshlrev_b32 v104, 16, v132
  v_lshlrev_b32 v105, 16, v134
  v_and_b32 v106, 0xffff0000, v132
  v_and_b32 v107, 0xffff0000, v134
  v_lshlrev_b32 v108, 16, v133
  v_lshlrev_b32 v109, 16, v135
  v_and_b32 v110, 0xffff0000, v133
  v_and_b32 v111, 0xffff0000, v135
  s_waitcnt lgkmcnt(12)
  v_lshlrev_b32 v112, 16, v78
  v_and_b32 v113, 0xffff0000, v78
  v_lshlrev_b32 v114, 16, v77
  v_and_b32 v115, 0xffff0000, v77
  v_lshlrev_b32 v116, 16, v79
  v_and_b32 v117, 0xffff0000, v79
  s_waitcnt lgkmcnt(11)
  v_lshlrev_b32 v118, 16, v80
  v_and_b32 v119, 0xffff0000, v80
  s_waitcnt lgkmcnt(10)
  v_lshlrev_b32 v120, 16, v82
  v_and_b32 v121, 0xffff0000, v82
  v_pk_mul_f32 v[172:173], v[118:119], v[104:105]
  v_pk_mul_f32 v[174:175], v[116:117], v[106:107]
  v_pk_mul_f32 v[176:177], v[114:115], v[108:109]
  v_pk_mul_f32 v[178:179], v[112:113], v[110:111]
  v_pk_mul_f32 v[180:181], v[120:121], v[104:105]
  v_pk_mul_f32 v[182:183], v[118:119], v[106:107]
  v_pk_mul_f32 v[184:185], v[116:117], v[108:109]
  v_pk_mul_f32 v[186:187], v[114:115], v[110:111]
  v_cvt_pk_bf16_f32 v188, v178, v176
  v_cvt_pk_bf16_f32 v189, v179, v177
  v_cvt_pk_bf16_f32 v190, v186, v184
  v_cvt_pk_bf16_f32 v191, v187, v185
  v_dot2_f32_bf16 v188, v188, v75, 0
  v_dot2_f32_bf16 v189, v189, v75, 0
  v_dot2_f32_bf16 v190, v190, v75, 0
  v_dot2_f32_bf16 v191, v191, v75, 0
  v_cvt_pk_bf16_f32 v188, v188, v174
  v_cvt_pk_bf16_f32 v189, v189, v175
  v_cvt_pk_bf16_f32 v190, v190, v182
  v_cvt_pk_bf16_f32 v191, v191, v183
  v_dot2_f32_bf16 v188, v188, v75, 0
  v_dot2_f32_bf16 v189, v189, v75, 0
  v_dot2_f32_bf16 v190, v190, v75, 0
  v_dot2_f32_bf16 v191, v191, v75, 0
  v_cvt_pk_bf16_f32 v188, v188, v172
  v_cvt_pk_bf16_f32 v189, v189, v173
  v_cvt_pk_bf16_f32 v190, v190, v180
  v_cvt_pk_bf16_f32 v191, v191, v181
  v_dot2_f32_bf16 v188, v188, v75, 0
  v_dot2_f32_bf16 v189, v189, v75, 0
  v_dot2_f32_bf16 v190, v190, v75, 0
  v_dot2_f32_bf16 v191, v191, v75, 0
  v_cvt_pk_bf16_f32 v188, v188, 0
  v_cvt_pk_bf16_f32 v189, 0, v189
  v_cvt_pk_bf16_f32 v190, v190, 0
  v_cvt_pk_bf16_f32 v191, 0, v191
  s_waitcnt lgkmcnt(9)
  v_dot2_f32_bf16 v188, v188, v92, 0
  v_dot2_f32_bf16 v189, v189, v92, 0
  s_waitcnt lgkmcnt(8)
  v_dot2_f32_bf16 v190, v190, v94, 0
  v_dot2_f32_bf16 v191, v191, v94, 0
  s_nop 1
  v_cvt_pk_bf16_f32 v194, v190, v188
  v_cvt_pk_bf16_f32 v198, v191, v189
  v_lshlrev_b32 v122, 16, v81
  v_and_b32 v123, 0xffff0000, v81
  v_lshlrev_b32 v112, 16, v83
  v_and_b32 v113, 0xffff0000, v83
  v_pk_mul_f32 v[172:173], v[122:123], v[104:105]
  v_pk_mul_f32 v[174:175], v[120:121], v[106:107]
  v_pk_mul_f32 v[176:177], v[118:119], v[108:109]
  v_pk_mul_f32 v[178:179], v[116:117], v[110:111]
  v_pk_mul_f32 v[180:181], v[112:113], v[104:105]
  v_pk_mul_f32 v[182:183], v[122:123], v[106:107]
  v_pk_mul_f32 v[184:185], v[120:121], v[108:109]
  v_pk_mul_f32 v[186:187], v[118:119], v[110:111]
  v_cvt_pk_bf16_f32 v188, v178, v176
  v_cvt_pk_bf16_f32 v189, v179, v177
  v_cvt_pk_bf16_f32 v190, v186, v184
  v_cvt_pk_bf16_f32 v191, v187, v185
  v_dot2_f32_bf16 v188, v188, v75, 0
  v_dot2_f32_bf16 v189, v189, v75, 0
  v_dot2_f32_bf16 v190, v190, v75, 0
  v_dot2_f32_bf16 v191, v191, v75, 0
  v_cvt_pk_bf16_f32 v188, v188, v174
  v_cvt_pk_bf16_f32 v189, v189, v175
  v_cvt_pk_bf16_f32 v190, v190, v182
  v_cvt_pk_bf16_f32 v191, v191, v183
  v_dot2_f32_bf16 v188, v188, v75, 0
  v_dot2_f32_bf16 v189, v189, v75, 0
  v_dot2_f32_bf16 v190, v190, v75, 0
  v_dot2_f32_bf16 v191, v191, v75, 0
  v_cvt_pk_bf16_f32 v188, v188, v172
  v_cvt_pk_bf16_f32 v189, v189, v173
  v_cvt_pk_bf16_f32 v190, v190, v180
  v_cvt_pk_bf16_f32 v191, v191, v181
  v_dot2_f32_bf16 v188, v188, v75, 0
  v_dot2_f32_bf16 v189, v189, v75, 0
  v_dot2_f32_bf16 v190, v190, v75, 0
  v_dot2_f32_bf16 v191, v191, v75, 0
  v_cvt_pk_bf16_f32 v188, v188, 0
  v_cvt_pk_bf16_f32 v189, 0, v189
  v_cvt_pk_bf16_f32 v190, v190, 0
  v_cvt_pk_bf16_f32 v191, 0, v191
  v_dot2_f32_bf16 v188, v188, v93, 0
  v_dot2_f32_bf16 v189, v189, v93, 0
  v_dot2_f32_bf16 v190, v190, v95, 0
  v_dot2_f32_bf16 v191, v191, v95, 0
  s_nop 1
  v_cvt_pk_bf16_f32 v193, v190, v188
  v_cvt_pk_bf16_f32 v197, v191, v189
  s_waitcnt lgkmcnt(7)
  v_lshlrev_b32 v114, 16, v84
  v_and_b32 v115, 0xffff0000, v84
  s_waitcnt lgkmcnt(6)
  v_lshlrev_b32 v116, 16, v86
  v_and_b32 v117, 0xffff0000, v86
  v_pk_mul_f32 v[172:173], v[114:115], v[104:105]
  v_pk_mul_f32 v[174:175], v[112:113], v[106:107]
  v_pk_mul_f32 v[176:177], v[122:123], v[108:109]
  v_pk_mul_f32 v[178:179], v[120:121], v[110:111]
  v_pk_mul_f32 v[180:181], v[116:117], v[104:105]
  v_pk_mul_f32 v[182:183], v[114:115], v[106:107]
  v_pk_mul_f32 v[184:185], v[112:113], v[108:109]
  v_pk_mul_f32 v[186:187], v[122:123], v[110:111]
  s_lshl_b32 s93, s99, 13
  s_add_u32 s93, s93, 65536
  v_add_u32 v166, s93, v70
  v_cvt_pk_bf16_f32 v188, v178, v176
  v_cvt_pk_bf16_f32 v189, v179, v177
  v_cvt_pk_bf16_f32 v190, v186, v184
  v_cvt_pk_bf16_f32 v191, v187, v185
  v_subrev_u32 v165, 5120, v166
  v_cmp_le_i32 vcc, 5120, v70
  s_nop 1
  v_cndmask_b32 v165, v7, v165, vcc
  v_cndmask_b32 v171, 0, v2, vcc
  v_dot2_f32_bf16 v188, v188, v75, 0
  v_dot2_f32_bf16 v189, v189, v75, 0
  v_dot2_f32_bf16 v190, v190, v75, 0
  v_dot2_f32_bf16 v191, v191, v75, 0
  v_subrev_u32 v164, 4096, v166
  v_cmp_le_i32 vcc, 4096, v70
  s_nop 1
  v_cndmask_b32 v164, v7, v164, vcc
  v_cndmask_b32 v170, 0, v2, vcc
  v_cvt_pk_bf16_f32 v188, v188, v174
  v_cvt_pk_bf16_f32 v189, v189, v175
  v_cvt_pk_bf16_f32 v190, v190, v182
  v_cvt_pk_bf16_f32 v191, v191, v183
  v_subrev_u32 v163, 3072, v166
  v_cmp_le_i32 vcc, 3072, v70
  s_nop 1
  v_cndmask_b32 v163, v7, v163, vcc
  v_cndmask_b32 v169, 0, v2, vcc
  v_dot2_f32_bf16 v188, v188, v75, 0
  v_dot2_f32_bf16 v189, v189, v75, 0
  v_dot2_f32_bf16 v190, v190, v75, 0
  v_dot2_f32_bf16 v191, v191, v75, 0
  v_subrev_u32 v162, 2048, v166
  v_cmp_le_i32 vcc, 2048, v70
  s_nop 1
  v_cndmask_b32 v162, v7, v162, vcc
  v_cndmask_b32 v168, 0, v2, vcc
  v_cvt_pk_bf16_f32 v188, v188, v172
  v_cvt_pk_bf16_f32 v189, v189, v173
  v_cvt_pk_bf16_f32 v190, v190, v180
  v_subrev_u32 v161, 1024, v166
  v_cmp_le_i32 vcc, 1024, v70
  s_nop 1
  v_cndmask_b32 v161, v7, v161, vcc
  v_cndmask_b32 v167, 0, v2, vcc
  v_cvt_pk_bf16_f32 v191, v191, v181
  v_dot2_f32_bf16 v188, v188, v75, 0
  v_dot2_f32_bf16 v189, v189, v75, 0
  v_dot2_f32_bf16 v190, v190, v75, 0
  v_subrev_u32 v160, 0, v166
  v_cmp_le_i32 vcc, 0, v70
  s_nop 1
  v_cndmask_b32 v160, v7, v160, vcc
  v_cndmask_b32 v166, 0, v2, vcc
  v_dot2_f32_bf16 v191, v191, v75, 0
  v_cvt_pk_bf16_f32 v188, v188, 0
  v_cvt_pk_bf16_f32 v189, 0, v189
  v_cvt_pk_bf16_f32 v190, v190, 0
  buffer_load_dwordx4 v[12:15], v160, s[44:47], 0 offen sc1
  v_cvt_pk_bf16_f32 v191, 0, v191
  s_waitcnt lgkmcnt(5)
  v_dot2_f32_bf16 v188, v188, v96, 0
  v_dot2_f32_bf16 v189, v189, v96, 0
  s_waitcnt lgkmcnt(4)
  v_dot2_f32_bf16 v190, v190, v98, 0
  buffer_load_dwordx4 v[16:19], v161, s[44:47], 0 offen sc1
  v_dot2_f32_bf16 v191, v191, v98, 0
  s_nop 0
  v_cvt_pk_bf16_f32 v192, v190, v188
  s_nop 0
  v_cvt_pk_bf16_f32 v196, v191, v189
  buffer_load_dwordx4 v[20:23], v162, s[44:47], 0 offen sc1
  ds_write_b128 v38, v[192:195] offset:28688
  ds_write_b128 v38, v[196:199] offset:28944
  v_lshlrev_b32 v118, 16, v85
  v_and_b32 v119, 0xffff0000, v85
  buffer_load_dwordx4 v[24:27], v163, s[44:47], 0 offen sc1
  v_lshlrev_b32 v120, 16, v87
  v_and_b32 v121, 0xffff0000, v87
  v_pk_mul_f32 v[172:173], v[118:119], v[104:105]
  v_pk_mul_f32 v[174:175], v[116:117], v[106:107]
  buffer_load_dwordx4 v[28:31], v164, s[44:47], 0 offen sc1
  v_pk_mul_f32 v[176:177], v[114:115], v[108:109]
  v_pk_mul_f32 v[178:179], v[112:113], v[110:111]
  v_pk_mul_f32 v[180:181], v[120:121], v[104:105]
  v_pk_mul_f32 v[182:183], v[118:119], v[106:107]
  buffer_load_dwordx4 v[32:35], v165, s[44:47], 0 offen sc1
  v_pk_mul_f32 v[184:185], v[116:117], v[108:109]
  v_pk_mul_f32 v[186:187], v[114:115], v[110:111]
  v_cvt_pk_bf16_f32 v188, v178, v176
  v_cvt_pk_bf16_f32 v189, v179, v177
  s_lshl1_add_u32 s93, s82, s4
  s_lshl_b32 s94, s93, 12
  s_add_u32 s72, s34, s94
  s_addc_u32 s73, s35, 0
  s_and_b32 s73, s73, 0xffff
  s_mov_b32 s74, 4096
  s_mov_b32 s75, 0x20000
  v_cvt_pk_bf16_f32 v190, v186, v184
  v_cvt_pk_bf16_f32 v191, v187, v185
  v_dot2_f32_bf16 v188, v188, v75, 0
  v_dot2_f32_bf16 v189, v189, v75, 0
  v_dot2_f32_bf16 v190, v190, v75, 0
  v_dot2_f32_bf16 v191, v191, v75, 0
  v_cvt_pk_bf16_f32 v188, v188, v174
  v_cvt_pk_bf16_f32 v189, v189, v175
  v_cvt_pk_bf16_f32 v190, v190, v182
  s_lshl_b32 s94, s82, 2
  v_mov_b32 v136, s94
  global_load_dword v136, v136, s[36:37]
  v_cvt_pk_bf16_f32 v191, v191, v183
  v_dot2_f32_bf16 v188, v188, v75, 0
  v_dot2_f32_bf16 v189, v189, v75, 0
  v_dot2_f32_bf16 v190, v190, v75, 0
  v_dot2_f32_bf16 v191, v191, v75, 0
  v_cvt_pk_bf16_f32 v188, v188, v172
  v_cvt_pk_bf16_f32 v189, v189, v173
  v_cvt_pk_bf16_f32 v190, v190, v180
  v_add_u32 v127, v5, v6
  v_subrev_u32 v127, 16, v127
  v_lshlrev_b32 v127, 2, v127
  buffer_load_dword v127, v127, s[72:75], 0 offen
  v_cvt_pk_bf16_f32 v191, v191, v181
  v_dot2_f32_bf16 v188, v188, v75, 0
  v_dot2_f32_bf16 v189, v189, v75, 0
  v_dot2_f32_bf16 v190, v190, v75, 0
  v_dot2_f32_bf16 v191, v191, v75, 0
  v_cvt_pk_bf16_f32 v188, v188, 0
  v_cvt_pk_bf16_f32 v189, 0, v189
  v_cvt_pk_bf16_f32 v190, v190, 0
  s_mul_i32 s95, s4, 16656
  s_mul_i32 s96, s3, 8336
  s_add_u32 s96, s96, s95
  s_add_u32 m0, s96, 110656
  s_lshl_b32 s5, s3, 3
  s_add_u32 s5, s5, 0
  v_cvt_pk_bf16_f32 v191, 0, v191
  v_dot2_f32_bf16 v188, v188, v97, 0
  v_dot2_f32_bf16 v189, v189, v97, 0
  v_dot2_f32_bf16 v190, v190, v99, 0
  v_dot2_f32_bf16 v191, v191, v99, 0
  s_nop 1
  v_cvt_pk_bf16_f32 v194, v190, v188
  v_cvt_pk_bf16_f32 v198, v191, v189
  s_waitcnt lgkmcnt(5)
  v_lshlrev_b32 v122, 16, v88
  buffer_load_dwordx4 v4, s[72:75], s5 offen offset:0 lds
  v_and_b32 v123, 0xffff0000, v88
  s_waitcnt lgkmcnt(4)
  v_lshlrev_b32 v112, 16, v90
  v_and_b32 v113, 0xffff0000, v90
  v_pk_mul_f32 v[172:173], v[122:123], v[104:105]
  v_pk_mul_f32 v[174:175], v[120:121], v[106:107]
  v_pk_mul_f32 v[176:177], v[118:119], v[108:109]
  v_pk_mul_f32 v[178:179], v[116:117], v[110:111]
  v_pk_mul_f32 v[180:181], v[112:113], v[104:105]
  buffer_load_dwordx4 v4, s[72:75], s5 offen offset:1024 lds
  v_pk_mul_f32 v[182:183], v[122:123], v[106:107]
  v_pk_mul_f32 v[184:185], v[120:121], v[108:109]
  v_pk_mul_f32 v[186:187], v[118:119], v[110:111]
  v_cvt_pk_bf16_f32 v188, v178, v176
  v_cvt_pk_bf16_f32 v189, v179, v177
  v_cvt_pk_bf16_f32 v190, v186, v184
  v_cvt_pk_bf16_f32 v191, v187, v185
  v_dot2_f32_bf16 v188, v188, v75, 0
  buffer_load_dwordx4 v4, s[72:75], s5 offen offset:2048 lds
  v_dot2_f32_bf16 v189, v189, v75, 0
  v_dot2_f32_bf16 v190, v190, v75, 0
  v_dot2_f32_bf16 v191, v191, v75, 0
  v_cvt_pk_bf16_f32 v188, v188, v174
  v_cvt_pk_bf16_f32 v189, v189, v175
  v_cvt_pk_bf16_f32 v190, v190, v182
  v_cvt_pk_bf16_f32 v191, v191, v183
  v_dot2_f32_bf16 v188, v188, v75, 0
  buffer_load_dwordx4 v4, s[72:75], s5 offen offset:3072 lds
  v_dot2_f32_bf16 v189, v189, v75, 0
  v_dot2_f32_bf16 v190, v190, v75, 0
  v_dot2_f32_bf16 v191, v191, v75, 0
  v_cvt_pk_bf16_f32 v188, v188, v172
  v_cvt_pk_bf16_f32 v189, v189, v173
  v_cvt_pk_bf16_f32 v190, v190, v180
  v_cvt_pk_bf16_f32 v191, v191, v181
  v_dot2_f32_bf16 v188, v188, v75, 0
  s_mul_i32 s95, s4, 16656
  s_mul_i32 s96, s3, 8320
  s_add_u32 s96, s96, s95
  s_add_u32 m0, s96, 114832
  s_lshl_b32 s5, s3, 3
  s_add_u32 s5, s5, 4
  v_dot2_f32_bf16 v189, v189, v75, 0
  v_dot2_f32_bf16 v190, v190, v75, 0
  v_dot2_f32_bf16 v191, v191, v75, 0
  v_cvt_pk_bf16_f32 v188, v188, 0
  v_cvt_pk_bf16_f32 v189, 0, v189
  v_cvt_pk_bf16_f32 v190, v190, 0
  v_cvt_pk_bf16_f32 v191, 0, v191
  s_waitcnt lgkmcnt(3)
  v_dot2_f32_bf16 v188, v188, v100, 0
  buffer_load_dwordx4 v4, s[72:75], s5 offen offset:0 lds
  v_dot2_f32_bf16 v189, v189, v100, 0
  s_waitcnt lgkmcnt(2)
  v_dot2_f32_bf16 v190, v190, v102, 0
  v_dot2_f32_bf16 v191, v191, v102, 0
  s_nop 1
  v_cvt_pk_bf16_f32 v193, v190, v188
  v_cvt_pk_bf16_f32 v197, v191, v189
  v_lshlrev_b32 v114, 16, v89
  v_and_b32 v115, 0xffff0000, v89
  v_lshlrev_b32 v116, 16, v91
  buffer_load_dwordx4 v4, s[72:75], s5 offen offset:1024 lds
  v_and_b32 v117, 0xffff0000, v91
  v_pk_mul_f32 v[172:173], v[114:115], v[104:105]
  v_pk_mul_f32 v[174:175], v[112:113], v[106:107]
  v_pk_mul_f32 v[176:177], v[122:123], v[108:109]
  v_pk_mul_f32 v[178:179], v[120:121], v[110:111]
  v_pk_mul_f32 v[180:181], v[116:117], v[104:105]
  v_pk_mul_f32 v[182:183], v[114:115], v[106:107]
  v_pk_mul_f32 v[184:185], v[112:113], v[108:109]
  buffer_load_dwordx4 v4, s[72:75], s5 offen offset:2048 lds
  v_pk_mul_f32 v[186:187], v[122:123], v[110:111]
  v_cvt_pk_bf16_f32 v188, v178, v176
  v_cvt_pk_bf16_f32 v189, v179, v177
  v_cvt_pk_bf16_f32 v190, v186, v184
  v_cvt_pk_bf16_f32 v191, v187, v185
  v_dot2_f32_bf16 v188, v188, v75, 0
  v_dot2_f32_bf16 v189, v189, v75, 0
  v_dot2_f32_bf16 v190, v190, v75, 0
  buffer_load_dwordx4 v4, s[72:75], s5 offen offset:3072 lds
  v_dot2_f32_bf16 v191, v191, v75, 0
  v_cvt_pk_bf16_f32 v188, v188, v174
  v_cvt_pk_bf16_f32 v189, v189, v175
  v_cvt_pk_bf16_f32 v190, v190, v182
  v_cvt_pk_bf16_f32 v191, v191, v183
  v_dot2_f32_bf16 v188, v188, v75, 0
  v_dot2_f32_bf16 v189, v189, v75, 0
  v_dot2_f32_bf16 v190, v190, v75, 0
  s_mov_b32 s83, 300000
  s_waitcnt vmcnt(20)
L_pollc_6:
  v_cmp_ne_u32 vcc, v157, v158
  s_sub_u32 s83, s83, 1
  s_cselect_b64 vcc, 0, vcc
  s_cmp_lg_u64 vcc, 0
  s_cbranch_scc1 L_poll_5
  v_dot2_f32_bf16 v191, v191, v75, 0
  v_cvt_pk_bf16_f32 v188, v188, v172
  v_cvt_pk_bf16_f32 v189, v189, v173
  v_cvt_pk_bf16_f32 v190, v190, v180
  v_cvt_pk_bf16_f32 v191, v191, v181
  v_dot2_f32_bf16 v188, v188, v75, 0
  v_dot2_f32_bf16 v189, v189, v75, 0
  v_dot2_f32_bf16 v190, v190, v75, 0
  buffer_load_dwordx4 a[144:147], v4, s[44:47], s21 offen offset:0 sc1
  v_dot2_f32_bf16 v191, v191, v75, 0
  v_cvt_pk_bf16_f32 v188, v188, 0
  v_cvt_pk_bf16_f32 v189, 0, v189
  v_cvt_pk_bf16_f32 v190, v190, 0
  v_cvt_pk_bf16_f32 v191, 0, v191
  v_dot2_f32_bf16 v188, v188, v101, 0
  v_dot2_f32_bf16 v189, v189, v101, 0
  v_dot2_f32_bf16 v190, v190, v103, 0
  buffer_load_dwordx4 a[148:151], v4, s[44:47], s21 offen offset:1024 sc1
  v_dot2_f32_bf16 v191, v191, v103, 0
  s_nop 0
  v_cvt_pk_bf16_f32 v192, v190, v188
  s_nop 0
  v_cvt_pk_bf16_f32 v196, v191, v189
  ds_write_b128 v38, v[192:195] offset:28672
  ds_write_b128 v38, v[196:199] offset:28928
  v_mul_u32_u24 v36, 5632, v6
  v_lshl_add_u32 v36, v5, 4, v36
  s_mul_i32 s93, s99, 90112
  s_lshl_b32 s94, s76, 8
  s_sub_u32 s93, s93, s94
  s_add_u32 s93, s93, 23074048
  s_cmp_lt_u32 s77, 6
  s_cselect_b32 s93, s93, 0x40000000
  v_add_u32 v36, s93, v36
  s_waitcnt lgkmcnt(0)
  s_barrier
  ds_read_b128 v[76:79], v39 offset:28672
  ds_read_b128 v[80:83], v39 offset:29728
  ds_read_b128 v[84:87], v39 offset:30784
  ds_read_b128 v[88:91], v39 offset:31840
  s_mov_b32 s94, 0
  s_waitcnt lgkmcnt(3)
  buffer_store_dwordx4 v[76:79], v36, s[44:47], s94 offen sc1
  s_mov_b32 s94, 22528
  s_waitcnt lgkmcnt(2)
  buffer_store_dwordx4 v[80:83], v36, s[44:47], s94 offen sc1
  s_mov_b32 s94, 45056
  s_waitcnt lgkmcnt(1)
  buffer_store_dwordx4 v[84:87], v36, s[44:47], s94 offen sc1
  s_mov_b32 s94, 67584
  s_waitcnt lgkmcnt(0)
  buffer_store_dwordx4 v[88:91], v36, s[44:47], s94 offen sc1
  s_nop 1
  s_lshl1_add_u32 s93, s82, s4
  s_mul_i32 s94, s93, 5632
  s_mul_i32 s96, s3, 2736
  s_add_u32 s94, s94, s96
  s_add_u32 s94, s94, 23068832
  v_add_u32 v206, s94, v4
  s_sub_u32 s93, 44, s3
  v_cmp_gt_u32 vcc, s93, v1
  s_nop 1
  v_cndmask_b32 v207, v7, v206, vcc
  v_cndmask_b32 v205, 0, v2, vcc
  s_sub_u32 s93, 43, s3
  v_cmp_gt_u32 vcc, s93, v1
  s_nop 1
  v_cndmask_b32 v204, v7, v206, vcc
  s_mov_b32 s83, 300000
  s_waitcnt vmcnt(16)
L_pollc_8:
  v_bitop3_b32 v36, v13, v15, v166 bitop3:0x7e
  v_bitop3_b32 v37, v17, v19, v167 bitop3:0x7e
  v_or_b32 v36, v36, v37
  v_bitop3_b32 v37, v21, v23, v168 bitop3:0x7e
  v_or_b32 v36, v36, v37
  v_bitop3_b32 v37, v25, v27, v169 bitop3:0x7e
  v_or_b32 v36, v36, v37
  v_bitop3_b32 v37, v29, v31, v170 bitop3:0x7e
  v_or_b32 v36, v36, v37
  v_bitop3_b32 v37, v33, v35, v171 bitop3:0x7e
  v_or_b32 v36, v36, v37
  v_cmp_ne_u32 vcc, 0, v36
  s_sub_u32 s83, s83, 1
  s_cselect_b64 vcc, 0, vcc
  s_cmp_lg_u64 vcc, 0
  s_cbranch_scc1 L_poll_7
  v_mov_b32 v13, v14
  v_mov_b32 v17, v18
  v_mov_b32 v21, v22
  v_mov_b32 v25, v26
  v_mov_b32 v29, v30
  v_mov_b32 v33, v34
  v_pk_fma_f32 v[28:29], v[32:33], v[54:55], v[28:29] op_sel:[0,0,0] op_sel_hi:[1,0,1]
  v_pk_fma_f32 v[28:29], v[32:33], v[54:55], v[28:29] op_sel:[1,1,0] op_sel_hi:[0,1,1] neg_lo:[1,0,0]
  v_pk_fma_f32 v[24:25], v[28:29], v[54:55], v[24:25] op_sel:[0,0,0] op_sel_hi:[1,0,1]
  v_pk_fma_f32 v[24:25], v[28:29], v[54:55], v[24:25] op_sel:[1,1,0] op_sel_hi:[0,1,1] neg_lo:[1,0,0]
  v_pk_fma_f32 v[20:21], v[24:25], v[54:55], v[20:21] op_sel:[0,0,0] op_sel_hi:[1,0,1]
  v_pk_fma_f32 v[20:21], v[24:25], v[54:55], v[20:21] op_sel:[1,1,0] op_sel_hi:[0,1,1] neg_lo:[1,0,0]
  v_pk_fma_f32 v[16:17], v[20:21], v[54:55], v[16:17] op_sel:[0,0,0] op_sel_hi:[1,0,1]
  v_pk_fma_f32 v[16:17], v[20:21], v[54:55], v[16:17] op_sel:[1,1,0] op_sel_hi:[0,1,1] neg_lo:[1,0,0]
  v_pk_fma_f32 v[12:13], v[16:17], v[54:55], v[12:13] op_sel:[0,0,0] op_sel_hi:[1,0,1]
  v_pk_fma_f32 v[12:13], v[16:17], v[54:55], v[12:13] op_sel:[1,1,0] op_sel_hi:[0,1,1] neg_lo:[1,0,0]
  v_pk_mul_f32 v[36:37], v[12:13], v[56:57] op_sel:[0,0] op_sel_hi:[1,0]
  v_pk_fma_f32 v[36:37], v[12:13], v[56:57], v[36:37] op_sel:[1,1,0] op_sel_hi:[0,1,1] neg_lo:[1,0,0]
  v_mov_b64 v[38:39], v[36:37]
  s_nop 1
  v_permlane32_swap_b32 v36, v38
  v_permlane32_swap_b32 v37, v39
  v_pk_add_f32 v[36:37], v[36:37], v[38:39]
  v_mov_b64 v[38:39], v[36:37]
  s_nop 1
  v_permlane16_swap_b32 v36, v38
  v_permlane16_swap_b32 v37, v39
  v_pk_add_f32 v[36:37], v[36:37], v[38:39]
  v_pk_fma_f32 v[150:151], v[36:37], v[58:59], v[150:151] op_sel:[0,0,0] op_sel_hi:[1,0,1]
  v_pk_fma_f32 v[150:151], v[36:37], v[58:59], v[150:151] op_sel:[1,1,0] op_sel_hi:[0,1,1] neg_lo:[1,0,0]
  v_pk_fma_f32 v[124:125], v[150:151], v[50:51], v[124:125] op_sel:[0,0,0] op_sel_hi:[1,0,1]
  v_pk_fma_f32 v[124:125], v[150:151], v[50:51], v[124:125] op_sel:[1,1,0] op_sel_hi:[0,1,1] neg_lo:[1,0,0]
  v_mov_b32 v36, v150
  v_mov_b32 v37, v124
  v_mov_b32 v38, v151
  v_mov_b32 v39, v125
  s_mul_i32 s95, s76, 216
  s_add_u32 s95, s95, s99
  s_lshl_b32 s95, s95, 10
  v_pk_fma_f32 v[208:209], v[36:37], v[48:49], v[208:209] op_sel:[0,0,0] op_sel_hi:[1,0,1]
  v_pk_fma_f32 v[232:233], v[38:39], v[48:49], v[232:233] op_sel:[0,0,0] op_sel_hi:[1,0,1]
  v_pk_fma_f32 v[208:209], v[38:39], v[48:49], v[208:209] op_sel:[0,1,0] op_sel_hi:[1,1,1] neg_lo:[1,0,0] neg_hi:[1,0,0]
  v_pk_fma_f32 v[232:233], v[36:37], v[48:49], v[232:233] op_sel:[0,1,0] op_sel_hi:[1,1,1]
  v_cvt_pk_bf16_f32 v132, v208, v232
  v_cvt_pk_bf16_f32 v133, v209, v233
  ds_write_b32 v71, v132 offset:0
  ds_write_b32 v71, v133 offset:64
  buffer_load_dwordx4 a[152:155], v4, s[44:47], s21 offen offset:2048 sc1
  v_pk_fma_f32 v[210:211], v[208:209], v[48:49], v[210:211] op_sel:[0,0,0] op_sel_hi:[1,0,1]
  v_pk_fma_f32 v[234:235], v[232:233], v[48:49], v[234:235] op_sel:[0,0,0] op_sel_hi:[1,0,1]
  v_pk_fma_f32 v[210:211], v[232:233], v[48:49], v[210:211] op_sel:[0,1,0] op_sel_hi:[1,1,1] neg_lo:[1,0,0] neg_hi:[1,0,0]
  v_pk_fma_f32 v[234:235], v[208:209], v[48:49], v[234:235] op_sel:[0,1,0] op_sel_hi:[1,1,1]
  v_cvt_pk_bf16_f32 v134, v210, v234
  v_cvt_pk_bf16_f32 v135, v211, v235
  ds_write_b32 v71, v134 offset:128
  ds_write_b32 v71, v135 offset:192
  ds_read_b128 v[12:15], v72 offset:0
  v_pk_fma_f32 v[212:213], v[210:211], v[48:49], v[212:213] op_sel:[0,0,0] op_sel_hi:[1,0,1]
  v_pk_fma_f32 v[236:237], v[234:235], v[48:49], v[236:237] op_sel:[0,0,0] op_sel_hi:[1,0,1]
  v_pk_fma_f32 v[212:213], v[234:235], v[48:49], v[212:213] op_sel:[0,1,0] op_sel_hi:[1,1,1] neg_lo:[1,0,0] neg_hi:[1,0,0]
  v_pk_fma_f32 v[236:237], v[210:211], v[48:49], v[236:237] op_sel:[0,1,0] op_sel_hi:[1,1,1]
  v_cvt_pk_bf16_f32 v132, v212, v236
  v_cvt_pk_bf16_f32 v133, v213, v237
  ds_write_b32 v71, v132 offset:1024
  ds_write_b32 v71, v133 offset:1088
  buffer_load_dwordx4 a[156:159], v4, s[44:47], s21 offen offset:3072 sc1
  s_add_u32 s21, s21, 4096
  v_pk_fma_f32 v[214:215], v[212:213], v[48:49], v[214:215] op_sel:[0,0,0] op_sel_hi:[1,0,1]
  v_pk_fma_f32 v[238:239], v[236:237], v[48:49], v[238:239] op_sel:[0,0,0] op_sel_hi:[1,0,1]
  v_pk_fma_f32 v[214:215], v[236:237], v[48:49], v[214:215] op_sel:[0,1,0] op_sel_hi:[1,1,1] neg_lo:[1,0,0] neg_hi:[1,0,0]
  v_pk_fma_f32 v[238:239], v[212:213], v[48:49], v[238:239] op_sel:[0,1,0] op_sel_hi:[1,1,1]
  v_cvt_pk_bf16_f32 v134, v214, v238
  v_cvt_pk_bf16_f32 v135, v215, v239
  ds_write_b32 v71, v134 offset:1152
  ds_write_b32 v71, v135 offset:1216
  ds_read_b128 v[16:19], v72 offset:1024
  v_pk_fma_f32 v[216:217], v[214:215], v[48:49], v[216:217] op_sel:[0,0,0] op_sel_hi:[1,0,1]
  v_pk_fma_f32 v[240:241], v[238:239], v[48:49], v[240:241] op_sel:[0,0,0] op_sel_hi:[1,0,1]
  v_pk_fma_f32 v[216:217], v[238:239], v[48:49], v[216:217] op_sel:[0,1,0] op_sel_hi:[1,1,1] neg_lo:[1,0,0] neg_hi:[1,0,0]
  v_pk_fma_f32 v[240:241], v[214:215], v[48:49], v[240:241] op_sel:[0,1,0] op_sel_hi:[1,1,1]
  v_cvt_pk_bf16_f32 v132, v216, v240
  v_cvt_pk_bf16_f32 v133, v217, v241
  ds_write_b32 v71, v132 offset:2048
  ds_write_b32 v71, v133 offset:2112
  buffer_load_dwordx4 a[160:163], v4, s[44:47], s21 offen offset:0 sc1
  v_pk_fma_f32 v[218:219], v[216:217], v[48:49], v[218:219] op_sel:[0,0,0] op_sel_hi:[1,0,1]
  v_pk_fma_f32 v[242:243], v[240:241], v[48:49], v[242:243] op_sel:[0,0,0] op_sel_hi:[1,0,1]
  v_pk_fma_f32 v[218:219], v[240:241], v[48:49], v[218:219] op_sel:[0,1,0] op_sel_hi:[1,1,1] neg_lo:[1,0,0] neg_hi:[1,0,0]
  v_pk_fma_f32 v[242:243], v[216:217], v[48:49], v[242:243] op_sel:[0,1,0] op_sel_hi:[1,1,1]
  v_cvt_pk_bf16_f32 v134, v218, v242
  v_cvt_pk_bf16_f32 v135, v219, v243
  ds_write_b32 v71, v134 offset:2176
  ds_write_b32 v71, v135 offset:2240
  ds_read_b128 v[20:23], v72 offset:2048
  v_pk_fma_f32 v[220:221], v[218:219], v[48:49], v[220:221] op_sel:[0,0,0] op_sel_hi:[1,0,1]
  v_pk_fma_f32 v[244:245], v[242:243], v[48:49], v[244:245] op_sel:[0,0,0] op_sel_hi:[1,0,1]
  v_pk_fma_f32 v[220:221], v[242:243], v[48:49], v[220:221] op_sel:[0,1,0] op_sel_hi:[1,1,1] neg_lo:[1,0,0] neg_hi:[1,0,0]
  v_pk_fma_f32 v[244:245], v[218:219], v[48:49], v[244:245] op_sel:[0,1,0] op_sel_hi:[1,1,1]
  v_cvt_pk_bf16_f32 v132, v220, v244
  v_cvt_pk_bf16_f32 v133, v221, v245
  ds_write_b32 v71, v132 offset:3072
  ds_write_b32 v71, v133 offset:3136
  buffer_load_dwordx4 a[164:167], v4, s[44:47], s21 offen offset:1024 sc1
  v_pk_fma_f32 v[222:223], v[220:221], v[48:49], v[222:223] op_sel:[0,0,0] op_sel_hi:[1,0,1]
  v_pk_fma_f32 v[246:247], v[244:245], v[48:49], v[246:247] op_sel:[0,0,0] op_sel_hi:[1,0,1]
  v_pk_fma_f32 v[222:223], v[244:245], v[48:49], v[222:223] op_sel:[0,1,0] op_sel_hi:[1,1,1] neg_lo:[1,0,0] neg_hi:[1,0,0]
  v_pk_fma_f32 v[246:247], v[220:221], v[48:49], v[246:247] op_sel:[0,1,0] op_sel_hi:[1,1,1]
  v_cvt_pk_bf16_f32 v134, v222, v246
  v_cvt_pk_bf16_f32 v135, v223, v247
  ds_write_b32 v71, v134 offset:3200
  ds_write_b32 v71, v135 offset:3264
  ds_read_b128 v[24:27], v72 offset:3072
  v_pk_fma_f32 v[224:225], v[222:223], v[48:49], v[224:225] op_sel:[0,0,0] op_sel_hi:[1,0,1]
  v_pk_fma_f32 v[248:249], v[246:247], v[48:49], v[248:249] op_sel:[0,0,0] op_sel_hi:[1,0,1]
  v_pk_fma_f32 v[224:225], v[246:247], v[48:49], v[224:225] op_sel:[0,1,0] op_sel_hi:[1,1,1] neg_lo:[1,0,0] neg_hi:[1,0,0]
  v_pk_fma_f32 v[248:249], v[222:223], v[48:49], v[248:249] op_sel:[0,1,0] op_sel_hi:[1,1,1]
  v_cvt_pk_bf16_f32 v132, v224, v248
  v_cvt_pk_bf16_f32 v133, v225, v249
  ds_write_b32 v71, v132 offset:4096
  ds_write_b32 v71, v133 offset:4160
  buffer_load_dwordx4 a[168:171], v4, s[44:47], s21 offen offset:2048 sc1
  v_pk_fma_f32 v[226:227], v[224:225], v[48:49], v[226:227] op_sel:[0,0,0] op_sel_hi:[1,0,1]
  v_pk_fma_f32 v[250:251], v[248:249], v[48:49], v[250:251] op_sel:[0,0,0] op_sel_hi:[1,0,1]
  v_pk_fma_f32 v[226:227], v[248:249], v[48:49], v[226:227] op_sel:[0,1,0] op_sel_hi:[1,1,1] neg_lo:[1,0,0] neg_hi:[1,0,0]
  v_pk_fma_f32 v[250:251], v[224:225], v[48:49], v[250:251] op_sel:[0,1,0] op_sel_hi:[1,1,1]
  v_cvt_pk_bf16_f32 v134, v226, v250
  v_cvt_pk_bf16_f32 v135, v227, v251
  ds_write_b32 v71, v134 offset:4224
  ds_write_b32 v71, v135 offset:4288
  ds_read_b128 v[28:31], v72 offset:4096
  v_pk_fma_f32 v[228:229], v[226:227], v[48:49], v[228:229] op_sel:[0,0,0] op_sel_hi:[1,0,1]
  v_pk_fma_f32 v[252:253], v[250:251], v[48:49], v[252:253] op_sel:[0,0,0] op_sel_hi:[1,0,1]
  v_pk_fma_f32 v[228:229], v[250:251], v[48:49], v[228:229] op_sel:[0,1,0] op_sel_hi:[1,1,1] neg_lo:[1,0,0] neg_hi:[1,0,0]
  v_pk_fma_f32 v[252:253], v[226:227], v[48:49], v[252:253] op_sel:[0,1,0] op_sel_hi:[1,1,1]
  v_cvt_pk_bf16_f32 v132, v228, v252
  v_cvt_pk_bf16_f32 v133, v229, v253
  ds_write_b32 v71, v132 offset:5120
  ds_write_b32 v71, v133 offset:5184
  v_pk_fma_f32 v[230:231], v[228:229], v[48:49], v[230:231] op_sel:[0,0,0] op_sel_hi:[1,0,1]
  v_pk_fma_f32 v[254:255], v[252:253], v[48:49], v[254:255] op_sel:[0,0,0] op_sel_hi:[1,0,1]
  v_pk_fma_f32 v[230:231], v[252:253], v[48:49], v[230:231] op_sel:[0,1,0] op_sel_hi:[1,1,1] neg_lo:[1,0,0] neg_hi:[1,0,0]
  v_pk_fma_f32 v[254:255], v[228:229], v[48:49], v[254:255] op_sel:[0,1,0] op_sel_hi:[1,1,1]
  v_cvt_pk_bf16_f32 v134, v230, v254
  v_cvt_pk_bf16_f32 v135, v231, v255
  ds_write_b32 v71, v134 offset:5248
  ds_write_b32 v71, v135 offset:5312
  ds_read_b128 v[32:35], v72 offset:5120
  s_lshl2_add_u32 s93, s76, s79
  s_lshl4_add_u32 s93, s93, s77
  s_lshl_b32 s93, s93, 2
  s_add_u32 s93, s93, 16384
  s_waitcnt lgkmcnt(0)
  s_cmp_eq_u32 s78, 0
  s_cbranch_scc1 L_slow_9
  s_add_u32 s94, s95, 7077888
  buffer_store_dwordx4 v[12:15], v4, s[44:47], s94 offen
  s_add_u32 s94, s95, 7114752
  buffer_store_dwordx4 v[16:19], v4, s[44:47], s94 offen
  s_add_u32 s94, s95, 7151616
  buffer_store_dwordx4 v[20:23], v4, s[44:47], s94 offen
  s_add_u32 s94, s95, 7188480
  buffer_store_dwordx4 v[24:27], v4, s[44:47], s94 offen
  s_add_u32 s94, s95, 7225344
  buffer_store_dwordx4 v[28:31], v4, s[44:47], s94 offen
  s_add_u32 s94, s95, 7262208
  buffer_store_dwordx4 v[32:35], v4, s[44:47], s94 offen
L_back_10:
  s_mov_b32 s5, s93
  buffer_load_dwordx4 v[188:191], v206, s[44:47], 0 offen offset:0 sc1
  buffer_load_dwordx4 v[192:195], v206, s[44:47], 0 offen offset:1024 sc1
  buffer_load_dwordx4 v[196:199], v207, s[44:47], 0 offen offset:2048 sc1
  buffer_load_dword v200, v206, s[44:47], 0 offen offset:16 sc1
  buffer_load_dword v201, v206, s[44:47], 0 offen offset:1040 sc1
  buffer_load_dword v202, v204, s[44:47], 0 offen offset:2064 sc1
  v_mul_u32_u24 v120, 272, v5
  v_lshl_add_u32 v120, v6, 4, v120
  s_mul_i32 s93, s79, 4352
  v_add_u32 v120, s93, v120
  s_lshl_b32 s93, s79, 2
  v_add_u32 v12, s93, v6
  v_mul_u32_u24 v121, 272, v12
  v_lshl_add_u32 v121, v5, 4, v121
  v_add_u32 v122, 52224, v120
  v_add_u32 v123, 52224, v121
  s_barrier
  s_waitcnt vmcnt(31)
  ds_write_b32 v156, v127
  ds_write_b64 v155, v[10:11] offset:4112
  s_waitcnt vmcnt(6)
  s_cmp_eq_u32 s78, 0
  s_cbranch_scc1 L_slow_11
  s_mov_b64 exec, 1
  buffer_store_dword v2, v10, s[44:47], s5 offen
  s_mov_b64 exec, -1
L_back_12:
  v_lshlrev_b32 v16, 16, v138
  v_and_b32 v17, 0xffff0000, v138
  v_lshlrev_b32 v18, 16, v139
  v_and_b32 v19, 0xffff0000, v139
  v_lshlrev_b32 v20, 16, v140
  v_and_b32 v21, 0xffff0000, v140
  v_lshlrev_b32 v22, 16, v141
  v_and_b32 v23, 0xffff0000, v141
  v_lshlrev_b32 v24, 16, v142
  v_and_b32 v25, 0xffff0000, v142
  v_lshlrev_b32 v26, 16, v143
  v_and_b32 v27, 0xffff0000, v143
  v_lshlrev_b32 v28, 16, v144
  v_and_b32 v29, 0xffff0000, v144
  v_lshlrev_b32 v30, 16, v145
  v_and_b32 v31, 0xffff0000, v145
  v_lshlrev_b32 v32, 16, v146
  v_and_b32 v33, 0xffff0000, v146
  v_lshlrev_b32 v34, 16, v147
  v_and_b32 v35, 0xffff0000, v147
  v_lshlrev_b32 v36, 16, v148
  v_and_b32 v37, 0xffff0000, v148
  v_lshlrev_b32 v38, 16, v149
  v_and_b32 v39, 0xffff0000, v149
  v_mov_b64_dpp v[124:125], v[128:129] row_newbcast:0 row_mask:0xf bank_mask:0xf
  v_pk_add_f32 v[16:17], v[16:17], v[124:125] op_sel:[0,0] op_sel_hi:[1,0] neg_lo:[0,1] neg_hi:[0,1]
  v_pk_add_f32 v[18:19], v[18:19], v[124:125] op_sel:[0,0] op_sel_hi:[1,0] neg_lo:[0,1] neg_hi:[0,1]
  v_cvt_pk_bf16_f32 v132, v16, v17
  v_cvt_pk_bf16_f32 v134, v18, v19
  v_and_b32 v133, 0xffff0000, v132
  v_lshlrev_b32 v132, 16, v132
  v_and_b32 v135, 0xffff0000, v134
  v_lshlrev_b32 v134, 16, v134
  v_pk_mul_f32 v[132:133], v[132:133], v[124:125] op_sel:[0,1] op_sel_hi:[1,1]
  v_pk_mul_f32 v[134:135], v[134:135], v[124:125] op_sel:[0,1] op_sel_hi:[1,1]
  v_cvt_pk_bf16_f32 v132, v132, v133
  v_cvt_pk_bf16_f32 v134, v134, v135
  v_and_b32 v133, 0xffff0000, v132
  v_lshlrev_b32 v132, 16, v132
  v_and_b32 v135, 0xffff0000, v134
  v_lshlrev_b32 v134, 16, v134
  v_pk_mul_f32 v[132:133], v[132:133], v[40:41]
  v_pk_mul_f32 v[134:135], v[134:135], v[42:43]
  v_cvt_pk_bf16_f32 v132, v132, v133
  v_cvt_pk_bf16_f32 v134, v134, v135
  v_and_b32 v133, 0xffff0000, v132
  v_lshlrev_b32 v132, 16, v132
  v_and_b32 v135, 0xffff0000, v134
  v_lshlrev_b32 v134, 16, v134
  v_pk_add_f32 v[16:17], v[16:17], v[132:133]
  v_pk_add_f32 v[18:19], v[18:19], v[134:135]
  v_mov_b64_dpp v[124:125], v[128:129] row_newbcast:4 row_mask:0xf bank_mask:0xf
  v_pk_add_f32 v[20:21], v[20:21], v[124:125] op_sel:[0,0] op_sel_hi:[1,0] neg_lo:[0,1] neg_hi:[0,1]
  v_pk_add_f32 v[22:23], v[22:23], v[124:125] op_sel:[0,0] op_sel_hi:[1,0] neg_lo:[0,1] neg_hi:[0,1]
  v_cvt_pk_bf16_f32 v132, v20, v21
  v_cvt_pk_bf16_f32 v134, v22, v23
  v_and_b32 v133, 0xffff0000, v132
  v_lshlrev_b32 v132, 16, v132
  v_and_b32 v135, 0xffff0000, v134
  v_lshlrev_b32 v134, 16, v134
  v_pk_mul_f32 v[132:133], v[132:133], v[124:125] op_sel:[0,1] op_sel_hi:[1,1]
  v_pk_mul_f32 v[134:135], v[134:135], v[124:125] op_sel:[0,1] op_sel_hi:[1,1]
  v_cvt_pk_bf16_f32 v132, v132, v133
  v_cvt_pk_bf16_f32 v134, v134, v135
  v_and_b32 v133, 0xffff0000, v132
  v_lshlrev_b32 v132, 16, v132
  v_and_b32 v135, 0xffff0000, v134
  v_lshlrev_b32 v134, 16, v134
  v_pk_mul_f32 v[132:133], v[132:133], v[40:41]
  v_pk_mul_f32 v[134:135], v[134:135], v[42:43]
  v_cvt_pk_bf16_f32 v132, v132, v133
  v_cvt_pk_bf16_f32 v134, v134, v135
  v_and_b32 v133, 0xffff0000, v132
  v_lshlrev_b32 v132, 16, v132
  v_and_b32 v135, 0xffff0000, v134
  v_lshlrev_b32 v134, 16, v134
  v_pk_add_f32 v[20:21], v[20:21], v[132:133]
  v_pk_add_f32 v[22:23], v[22:23], v[134:135]
  v_mov_b64_dpp v[124:125], v[130:131] row_newbcast:0 row_mask:0xf bank_mask:0xf
  v_pk_add_f32 v[24:25], v[24:25], v[124:125] op_sel:[0,0] op_sel_hi:[1,0] neg_lo:[0,1] neg_hi:[0,1]
  v_pk_add_f32 v[26:27], v[26:27], v[124:125] op_sel:[0,0] op_sel_hi:[1,0] neg_lo:[0,1] neg_hi:[0,1]
  v_cvt_pk_bf16_f32 v132, v24, v25
  v_cvt_pk_bf16_f32 v134, v26, v27
  v_and_b32 v133, 0xffff0000, v132
  v_lshlrev_b32 v132, 16, v132
  v_and_b32 v135, 0xffff0000, v134
  v_lshlrev_b32 v134, 16, v134
  v_pk_mul_f32 v[132:133], v[132:133], v[124:125] op_sel:[0,1] op_sel_hi:[1,1]
  v_pk_mul_f32 v[134:135], v[134:135], v[124:125] op_sel:[0,1] op_sel_hi:[1,1]
  v_cvt_pk_bf16_f32 v132, v132, v133
  v_cvt_pk_bf16_f32 v134, v134, v135
  v_and_b32 v133, 0xffff0000, v132
  v_lshlrev_b32 v132, 16, v132
  v_and_b32 v135, 0xffff0000, v134
  v_lshlrev_b32 v134, 16, v134
  v_pk_mul_f32 v[132:133], v[132:133], v[40:41]
  v_pk_mul_f32 v[134:135], v[134:135], v[42:43]
  v_cvt_pk_bf16_f32 v132, v132, v133
  v_cvt_pk_bf16_f32 v134, v134, v135
  v_and_b32 v133, 0xffff0000, v132
  v_lshlrev_b32 v132, 16, v132
  v_and_b32 v135, 0xffff0000, v134
  v_lshlrev_b32 v134, 16, v134
  v_pk_add_f32 v[24:25], v[24:25], v[132:133]
  v_pk_add_f32 v[26:27], v[26:27], v[134:135]
  v_mov_b64_dpp v[124:125], v[128:129] row_newbcast:8 row_mask:0xf bank_mask:0xf
  v_pk_add_f32 v[28:29], v[28:29], v[124:125] op_sel:[0,0] op_sel_hi:[1,0] neg_lo:[0,1] neg_hi:[0,1]
  v_pk_add_f32 v[30:31], v[30:31], v[124:125] op_sel:[0,0] op_sel_hi:[1,0] neg_lo:[0,1] neg_hi:[0,1]
  v_cvt_pk_bf16_f32 v132, v28, v29
  v_cvt_pk_bf16_f32 v134, v30, v31
  v_and_b32 v133, 0xffff0000, v132
  v_lshlrev_b32 v132, 16, v132
  v_and_b32 v135, 0xffff0000, v134
  v_lshlrev_b32 v134, 16, v134
  v_pk_mul_f32 v[132:133], v[132:133], v[124:125] op_sel:[0,1] op_sel_hi:[1,1]
  v_pk_mul_f32 v[134:135], v[134:135], v[124:125] op_sel:[0,1] op_sel_hi:[1,1]
  v_cvt_pk_bf16_f32 v132, v132, v133
  v_cvt_pk_bf16_f32 v134, v134, v135
  v_and_b32 v133, 0xffff0000, v132
  v_lshlrev_b32 v132, 16, v132
  v_and_b32 v135, 0xffff0000, v134
  v_lshlrev_b32 v134, 16, v134
  v_pk_mul_f32 v[132:133], v[132:133], v[40:41]
  v_pk_mul_f32 v[134:135], v[134:135], v[42:43]
  v_cvt_pk_bf16_f32 v132, v132, v133
  v_cvt_pk_bf16_f32 v134, v134, v135
  v_and_b32 v133, 0xffff0000, v132
  v_lshlrev_b32 v132, 16, v132
  v_and_b32 v135, 0xffff0000, v134
  v_lshlrev_b32 v134, 16, v134
  v_pk_add_f32 v[28:29], v[28:29], v[132:133]
  v_pk_add_f32 v[30:31], v[30:31], v[134:135]
  v_mov_b64_dpp v[124:125], v[128:129] row_newbcast:12 row_mask:0xf bank_mask:0xf
  v_pk_add_f32 v[32:33], v[32:33], v[124:125] op_sel:[0,0] op_sel_hi:[1,0] neg_lo:[0,1] neg_hi:[0,1]
  v_pk_add_f32 v[34:35], v[34:35], v[124:125] op_sel:[0,0] op_sel_hi:[1,0] neg_lo:[0,1] neg_hi:[0,1]
  v_cvt_pk_bf16_f32 v132, v32, v33
  v_cvt_pk_bf16_f32 v134, v34, v35
  v_and_b32 v133, 0xffff0000, v132
  v_lshlrev_b32 v132, 16, v132
  v_and_b32 v135, 0xffff0000, v134
  v_lshlrev_b32 v134, 16, v134
  v_pk_mul_f32 v[132:133], v[132:133], v[124:125] op_sel:[0,1] op_sel_hi:[1,1]
  v_pk_mul_f32 v[134:135], v[134:135], v[124:125] op_sel:[0,1] op_sel_hi:[1,1]
  v_cvt_pk_bf16_f32 v132, v132, v133
  v_cvt_pk_bf16_f32 v134, v134, v135
  v_and_b32 v133, 0xffff0000, v132
  v_lshlrev_b32 v132, 16, v132
  v_and_b32 v135, 0xffff0000, v134
  v_lshlrev_b32 v134, 16, v134
  v_pk_mul_f32 v[132:133], v[132:133], v[40:41]
  v_pk_mul_f32 v[134:135], v[134:135], v[42:43]
  v_cvt_pk_bf16_f32 v132, v132, v133
  v_cvt_pk_bf16_f32 v134, v134, v135
  v_and_b32 v133, 0xffff0000, v132
  v_lshlrev_b32 v132, 16, v132
  v_and_b32 v135, 0xffff0000, v134
  v_lshlrev_b32 v134, 16, v134
  v_pk_add_f32 v[32:33], v[32:33], v[132:133]
  v_pk_add_f32 v[34:35], v[34:35], v[134:135]
  v_mov_b64_dpp v[124:125], v[130:131] row_newbcast:8 row_mask:0xf bank_mask:0xf
  v_pk_add_f32 v[36:37], v[36:37], v[124:125] op_sel:[0,0] op_sel_hi:[1,0] neg_lo:[0,1] neg_hi:[0,1]
  v_pk_add_f32 v[38:39], v[38:39], v[124:125] op_sel:[0,0] op_sel_hi:[1,0] neg_lo:[0,1] neg_hi:[0,1]
  v_cvt_pk_bf16_f32 v132, v36, v37
  v_cvt_pk_bf16_f32 v134, v38, v39
  v_and_b32 v133, 0xffff0000, v132
  v_lshlrev_b32 v132, 16, v132
  v_and_b32 v135, 0xffff0000, v134
  v_lshlrev_b32 v134, 16, v134
  v_pk_mul_f32 v[132:133], v[132:133], v[124:125] op_sel:[0,1] op_sel_hi:[1,1]
  v_pk_mul_f32 v[134:135], v[134:135], v[124:125] op_sel:[0,1] op_sel_hi:[1,1]
  v_cvt_pk_bf16_f32 v132, v132, v133
  v_cvt_pk_bf16_f32 v134, v134, v135
  v_and_b32 v133, 0xffff0000, v132
  v_lshlrev_b32 v132, 16, v132
  v_and_b32 v135, 0xffff0000, v134
  v_lshlrev_b32 v134, 16, v134
  v_pk_mul_f32 v[132:133], v[132:133], v[40:41]
  v_pk_mul_f32 v[134:135], v[134:135], v[42:43]
  v_cvt_pk_bf16_f32 v132, v132, v133
  v_cvt_pk_bf16_f32 v134, v134, v135
  v_and_b32 v133, 0xffff0000, v132
  v_lshlrev_b32 v132, 16, v132
  v_and_b32 v135, 0xffff0000, v134
  v_lshlrev_b32 v134, 16, v134
  v_pk_add_f32 v[36:37], v[36:37], v[132:133]
  v_pk_add_f32 v[38:39], v[38:39], v[134:135]
  s_mov_b32 s83, 300000
  s_waitcnt vmcnt(4)
L_pollc_14:
  v_bitop3_b32 v124, v191, v195, v2 bitop3:0x7e
  v_xor_b32 v125, v199, v205
  v_or_b32 v124, v124, v125
  v_cmp_ne_u32 vcc, 0, v124
  s_sub_u32 s83, s83, 1
  s_cselect_b64 vcc, 0, vcc
  s_cmp_lg_u64 vcc, 0
  s_cbranch_scc1 L_poll_13
  s_waitcnt vmcnt(1)
  ds_write_b32 v154, v188 offset:8
  v_alignbit_b32 v138, v189, v188, 16
  ds_write_b32 v154, v189 offset:12
  v_alignbit_b32 v139, v190, v189, 16
  ds_write_b32 v154, v190 offset:16
  v_alignbit_b32 v140, v200, v190, 16
  ds_write_b32 v154, v138 offset:4648
  ds_write_b32 v154, v139 offset:4652
  ds_write_b32 v154, v140 offset:4656
  ds_write_b32 v154, v192 offset:776
  v_alignbit_b32 v141, v193, v192, 16
  ds_write_b32 v154, v193 offset:780
  v_alignbit_b32 v142, v194, v193, 16
  ds_write_b32 v154, v194 offset:784
  v_alignbit_b32 v143, v201, v194, 16
  ds_write_b32 v154, v141 offset:5416
  ds_write_b32 v154, v142 offset:5420
  ds_write_b32 v154, v143 offset:5424
  v_cmp_gt_u32 vcc, 43, v1
  s_mov_b64 exec, vcc
  ds_write_b32 v154, v196 offset:1544
  v_alignbit_b32 v144, v197, v196, 16
  ds_write_b32 v154, v197 offset:1548
  v_alignbit_b32 v145, v198, v197, 16
  ds_write_b32 v154, v198 offset:1552
  v_alignbit_b32 v146, v202, v198, 16
  ds_write_b32 v154, v144 offset:6184
  ds_write_b32 v154, v145 offset:6188
  ds_write_b32 v154, v146 offset:6192
  s_mov_b64 exec, -1
  s_waitcnt lgkmcnt(0)
  s_barrier
  ds_read_b128 v[148:151], v153 offset:0
  buffer_load_dwordx4 a[172:175], v4, s[44:47], s21 offen offset:3072 sc1
  s_add_u32 s21, s21, 4096
  ds_read_b128 v[212:215], v152 offset:0
  ds_read_b128 v[208:211], v152 offset:512
  ds_read_b128 v[204:207], v152 offset:1024
  ds_read_b128 v[200:203], v152 offset:1536
  buffer_load_dwordx4 a[176:179], v4, s[44:47], s21 offen offset:0 sc1
  ds_read_b128 v[196:199], v152 offset:2048
  ds_read_b128 v[192:195], v152 offset:2560
  ds_read_b128 v[188:191], v152 offset:3072
  ds_read_b128 v[184:187], v152 offset:3584
  v_lshlrev_b32 v15, 1, v5
  v_lshl_add_u32 v15, v6, 6, v15
  v_add_u32 v216, 0, v15
  v_mul_u32_u24 v216, 171, v216
  v_lshrrev_b32 v216, 9, v216
  v_add_u32 v216, v216, v15
  s_mul_i32 s96, s79, 10944
  v_lshl_add_u32 v216, v216, 2, s96
  v_add_u32 v217, 1, v15
  v_mul_u32_u24 v217, 171, v217
  v_lshrrev_b32 v217, 9, v217
  v_add_u32 v217, v217, v15
  s_mul_i32 s96, s79, 10944
  v_lshl_add_u32 v217, v217, 2, s96
  v_add_u32 v218, 2, v15
  v_mul_u32_u24 v218, 171, v218
  v_lshrrev_b32 v218, 9, v218
  v_add_u32 v218, v218, v15
  s_mul_i32 s96, s79, 10944
  v_lshl_add_u32 v218, v218, 2, s96
  s_waitcnt lgkmcnt(7)
  v_mfma_f32_16x16x32_bf16 v[144:147], v[212:215], v[148:151], 0
  ds_read_b128 v[156:159], v153 offset:512
  buffer_load_dwordx4 a[180:183], v4, s[44:47], s21 offen offset:1024 sc1
  ds_read_b128 v[212:215], v152 offset:64
  s_waitcnt lgkmcnt(8)
  v_mfma_f32_16x16x32_bf16 v[140:143], v[208:211], v[148:151], 0
  ds_read_b128 v[160:163], v153 offset:1024
  s_waitcnt lgkmcnt(8)
  v_mfma_f32_16x16x32_bf16 v[132:135], v[204:207], v[148:151], 0
  ds_read_b128 v[164:167], v153 offset:1536
  s_waitcnt lgkmcnt(8)
  v_mfma_f32_16x16x32_bf16 v[128:131], v[200:203], v[148:151], 0
  ds_read_b128 v[168:171], v153 offset:2048
  s_waitcnt lgkmcnt(8)
  v_mfma_f32_16x16x32_bf16 v[124:127], v[196:199], v[148:151], 0
  buffer_load_dwordx4 a[184:187], v4, s[44:47], s21 offen offset:2048 sc1
  ds_read_b128 v[172:175], v153 offset:2560
  s_waitcnt lgkmcnt(8)
  v_mfma_f32_16x16x32_bf16 v[116:119], v[192:195], v[148:151], 0
  ds_read_b128 v[176:179], v153 offset:3072
  s_waitcnt lgkmcnt(8)
  v_mfma_f32_16x16x32_bf16 v[112:115], v[188:191], v[148:151], 0
  ds_read_b128 v[180:183], v153 offset:3584
  s_waitcnt lgkmcnt(8)
  v_mfma_f32_16x16x32_bf16 v[108:111], v[184:187], v[148:151], 0
  ds_read_b128 v[148:151], v153 offset:64
  buffer_load_dwordx4 a[188:191], v4, s[44:47], s21 offen offset:3072 sc1
  s_add_u32 s21, s21, 4096
  s_waitcnt lgkmcnt(8)
  v_mfma_f32_16x16x32_bf16 v[144:147], v[208:211], v[156:159], v[144:147]
  ds_read_b128 v[208:211], v152 offset:576
  v_mfma_f32_16x16x32_bf16 v[140:143], v[204:207], v[156:159], v[140:143]
  v_mfma_f32_16x16x32_bf16 v[132:135], v[200:203], v[156:159], v[132:135]
  v_mfma_f32_16x16x32_bf16 v[128:131], v[196:199], v[156:159], v[128:131]
  buffer_load_dwordx4 a[192:195], v4, s[44:47], s21 offen offset:0 sc1
  v_mfma_f32_16x16x32_bf16 v[124:127], v[192:195], v[156:159], v[124:127]
  v_mfma_f32_16x16x32_bf16 v[116:119], v[188:191], v[156:159], v[116:119]
  v_mfma_f32_16x16x32_bf16 v[112:115], v[184:187], v[156:159], v[112:115]
  ds_read_b128 v[156:159], v153 offset:576
  s_waitcnt lgkmcnt(8)
  v_mfma_f32_16x16x32_bf16 v[144:147], v[204:207], v[160:163], v[144:147]
  ds_read_b128 v[204:207], v152 offset:1088
  buffer_load_dwordx4 a[196:199], v4, s[44:47], s21 offen offset:1024 sc1
  v_mfma_f32_16x16x32_bf16 v[140:143], v[200:203], v[160:163], v[140:143]
  v_mfma_f32_16x16x32_bf16 v[132:135], v[196:199], v[160:163], v[132:135]
  v_mfma_f32_16x16x32_bf16 v[128:131], v[192:195], v[160:163], v[128:131]
  v_mfma_f32_16x16x32_bf16 v[124:127], v[188:191], v[160:163], v[124:127]
  buffer_load_dwordx4 a[200:203], v4, s[44:47], s21 offen offset:2048 sc1
  v_mfma_f32_16x16x32_bf16 v[116:119], v[184:187], v[160:163], v[116:119]
  ds_read_b128 v[160:163], v153 offset:1088
  s_waitcnt lgkmcnt(9)
  v_mfma_f32_16x16x32_bf16 v[144:147], v[200:203], v[164:167], v[144:147]
  ds_read_b128 v[200:203], v152 offset:1600
  v_mfma_f32_16x16x32_bf16 v[140:143], v[196:199], v[164:167], v[140:143]
  v_mfma_f32_16x16x32_bf16 v[132:135], v[192:195], v[164:167], v[132:135]
  buffer_load_dwordx4 a[204:207], v4, s[44:47], s21 offen offset:3072 sc1
  s_add_u32 s21, s21, 4096
  v_mfma_f32_16x16x32_bf16 v[128:131], v[188:191], v[164:167], v[128:131]
  v_mfma_f32_16x16x32_bf16 v[124:127], v[184:187], v[164:167], v[124:127]
  ds_read_b128 v[164:167], v153 offset:1600
  s_waitcnt lgkmcnt(10)
  v_mfma_f32_16x16x32_bf16 v[144:147], v[196:199], v[168:171], v[144:147]
  ds_read_b128 v[196:199], v152 offset:2112
  buffer_load_dwordx4 a[208:211], v4, s[44:47], s21 offen offset:0 sc1
  v_mfma_f32_16x16x32_bf16 v[140:143], v[192:195], v[168:171], v[140:143]
  v_mfma_f32_16x16x32_bf16 v[132:135], v[188:191], v[168:171], v[132:135]
  v_mfma_f32_16x16x32_bf16 v[128:131], v[184:187], v[168:171], v[128:131]
  ds_read_b128 v[168:171], v153 offset:2112
  s_waitcnt lgkmcnt(11)
  v_mfma_f32_16x16x32_bf16 v[144:147], v[192:195], v[172:175], v[144:147]
  ds_read_b128 v[192:195], v152 offset:2624
  buffer_load_dwordx4 a[212:215], v4, s[44:47], s21 offen offset:1024 sc1
  v_mfma_f32_16x16x32_bf16 v[140:143], v[188:191], v[172:175], v[140:143]
  v_mfma_f32_16x16x32_bf16 v[132:135], v[184:187], v[172:175], v[132:135]
  ds_read_b128 v[172:175], v153 offset:2624
  s_waitcnt lgkmcnt(12)
  v_mfma_f32_16x16x32_bf16 v[144:147], v[188:191], v[176:179], v[144:147]
  ds_read_b128 v[188:191], v152 offset:3136
  v_mfma_f32_16x16x32_bf16 v[140:143], v[184:187], v[176:179], v[140:143]
  ds_read_b128 v[176:179], v153 offset:3136
  buffer_load_dwordx4 a[216:219], v4, s[44:47], s21 offen offset:2048 sc1
  s_waitcnt lgkmcnt(13)
  v_mfma_f32_16x16x32_bf16 v[144:147], v[184:187], v[180:183], v[144:147]
  ds_read_b128 v[184:187], v152 offset:3648
  ds_read_b128 v[180:183], v153 offset:3648
  s_waitcnt lgkmcnt(14)
  v_mfma_f32_16x16x32_bf16 v[144:147], v[212:215], v[148:151], v[144:147]
  ds_read_b128 v[212:215], v152 offset:128
  s_waitcnt lgkmcnt(14)
  v_mfma_f32_16x16x32_bf16 v[140:143], v[208:211], v[148:151], v[140:143]
  buffer_load_dwordx4 a[220:223], v4, s[44:47], s21 offen offset:3072 sc1
  s_add_u32 s21, s21, 4096
  s_waitcnt lgkmcnt(12)
  v_mfma_f32_16x16x32_bf16 v[132:135], v[204:207], v[148:151], v[132:135]
  s_waitcnt lgkmcnt(10)
  v_mfma_f32_16x16x32_bf16 v[128:131], v[200:203], v[148:151], v[128:131]
  s_waitcnt lgkmcnt(8)
  v_mfma_f32_16x16x32_bf16 v[124:127], v[196:199], v[148:151], v[124:127]
  s_waitcnt lgkmcnt(6)
  v_mfma_f32_16x16x32_bf16 v[116:119], v[192:195], v[148:151], v[116:119]
  buffer_load_dwordx4 a[224:227], v4, s[44:47], s21 offen offset:0 sc1
  s_waitcnt lgkmcnt(4)
  v_mfma_f32_16x16x32_bf16 v[112:115], v[188:191], v[148:151], v[112:115]
  s_waitcnt lgkmcnt(2)
  v_mfma_f32_16x16x32_bf16 v[108:111], v[184:187], v[148:151], v[108:111]
  ds_read_b128 v[148:151], v153 offset:128
  v_mfma_f32_16x16x32_bf16 v[144:147], v[208:211], v[156:159], v[144:147]
  ds_read_b128 v[208:211], v152 offset:640
  v_mfma_f32_16x16x32_bf16 v[140:143], v[204:207], v[156:159], v[140:143]
  buffer_load_dwordx4 a[228:231], v4, s[44:47], s21 offen offset:1024 sc1
  v_mfma_f32_16x16x32_bf16 v[132:135], v[200:203], v[156:159], v[132:135]
  v_mfma_f32_16x16x32_bf16 v[128:131], v[196:199], v[156:159], v[128:131]
  v_mfma_f32_16x16x32_bf16 v[124:127], v[192:195], v[156:159], v[124:127]
  v_mfma_f32_16x16x32_bf16 v[116:119], v[188:191], v[156:159], v[116:119]
  buffer_load_dwordx4 a[232:235], v4, s[44:47], s21 offen offset:2048 sc1
  v_mfma_f32_16x16x32_bf16 v[112:115], v[184:187], v[156:159], v[112:115]
  ds_read_b128 v[156:159], v153 offset:640
  v_mfma_f32_16x16x32_bf16 v[144:147], v[204:207], v[160:163], v[144:147]
  ds_read_b128 v[204:207], v152 offset:1152
  v_mfma_f32_16x16x32_bf16 v[140:143], v[200:203], v[160:163], v[140:143]
  v_mfma_f32_16x16x32_bf16 v[132:135], v[196:199], v[160:163], v[132:135]
  buffer_load_dwordx4 a[236:239], v4, s[44:47], s21 offen offset:3072 sc1
  s_add_u32 s21, s21, 4096
  v_mfma_f32_16x16x32_bf16 v[128:131], v[192:195], v[160:163], v[128:131]
  v_mfma_f32_16x16x32_bf16 v[124:127], v[188:191], v[160:163], v[124:127]
  v_mfma_f32_16x16x32_bf16 v[116:119], v[184:187], v[160:163], v[116:119]
  ds_read_b128 v[160:163], v153 offset:1152
  buffer_load_dwordx4 a[240:243], v4, s[44:47], s21 offen offset:0 sc1
  v_mfma_f32_16x16x32_bf16 v[144:147], v[200:203], v[164:167], v[144:147]
  ds_read_b128 v[200:203], v152 offset:1664
  v_mfma_f32_16x16x32_bf16 v[140:143], v[196:199], v[164:167], v[140:143]
  v_mfma_f32_16x16x32_bf16 v[132:135], v[192:195], v[164:167], v[132:135]
  v_mfma_f32_16x16x32_bf16 v[128:131], v[188:191], v[164:167], v[128:131]
  buffer_load_dwordx4 a[244:247], v4, s[44:47], s21 offen offset:1024 sc1
  v_mfma_f32_16x16x32_bf16 v[124:127], v[184:187], v[164:167], v[124:127]
  ds_read_b128 v[164:167], v153 offset:1664
  v_mfma_f32_16x16x32_bf16 v[144:147], v[196:199], v[168:171], v[144:147]
  ds_read_b128 v[196:199], v152 offset:2176
  v_mfma_f32_16x16x32_bf16 v[140:143], v[192:195], v[168:171], v[140:143]
  v_mfma_f32_16x16x32_bf16 v[132:135], v[188:191], v[168:171], v[132:135]
  buffer_load_dwordx4 a[248:251], v4, s[44:47], s21 offen offset:2048 sc1
  v_mfma_f32_16x16x32_bf16 v[128:131], v[184:187], v[168:171], v[128:131]
  ds_read_b128 v[168:171], v153 offset:2176
  v_mfma_f32_16x16x32_bf16 v[144:147], v[192:195], v[172:175], v[144:147]
  ds_read_b128 v[192:195], v152 offset:2688
  v_mfma_f32_16x16x32_bf16 v[140:143], v[188:191], v[172:175], v[140:143]
  v_mfma_f32_16x16x32_bf16 v[132:135], v[184:187], v[172:175], v[132:135]
  ds_read_b128 v[172:175], v153 offset:2688
  buffer_load_dwordx4 a[252:255], v4, s[44:47], s21 offen offset:3072 sc1
  s_add_u32 s21, s21, 4096
  v_mfma_f32_16x16x32_bf16 v[144:147], v[188:191], v[176:179], v[144:147]
  ds_read_b128 v[188:191], v152 offset:3200
  v_mfma_f32_16x16x32_bf16 v[140:143], v[184:187], v[176:179], v[140:143]
  ds_read_b128 v[176:179], v153 offset:3200
  s_waitcnt lgkmcnt(14)
  v_mfma_f32_16x16x32_bf16 v[144:147], v[184:187], v[180:183], v[144:147]
  ds_read_b128 v[184:187], v152 offset:3712
  buffer_load_dwordx4 v[76:79], v4, s[44:47], s21 offen offset:0 sc1
  ds_read_b128 v[180:183], v153 offset:3712
  s_waitcnt lgkmcnt(14)
  v_mfma_f32_16x16x32_bf16 v[144:147], v[212:215], v[148:151], v[144:147]
  ds_read_b128 v[212:215], v152 offset:192
  s_waitcnt lgkmcnt(14)
  v_mfma_f32_16x16x32_bf16 v[140:143], v[208:211], v[148:151], v[140:143]
  s_waitcnt lgkmcnt(12)
  v_mfma_f32_16x16x32_bf16 v[132:135], v[204:207], v[148:151], v[132:135]
  s_waitcnt lgkmcnt(10)
  v_mfma_f32_16x16x32_bf16 v[128:131], v[200:203], v[148:151], v[128:131]
  buffer_load_dwordx4 v[80:83], v4, s[44:47], s21 offen offset:1024 sc1
  s_waitcnt lgkmcnt(8)
  v_mfma_f32_16x16x32_bf16 v[124:127], v[196:199], v[148:151], v[124:127]
  s_waitcnt lgkmcnt(6)
  v_mfma_f32_16x16x32_bf16 v[116:119], v[192:195], v[148:151], v[116:119]
  s_waitcnt lgkmcnt(4)
  v_mfma_f32_16x16x32_bf16 v[112:115], v[188:191], v[148:151], v[112:115]
  s_waitcnt lgkmcnt(2)
  v_mfma_f32_16x16x32_bf16 v[108:111], v[184:187], v[148:151], v[108:111]
  ds_read_b128 v[148:151], v153 offset:192
  buffer_load_dwordx4 v[84:87], v4, s[44:47], s21 offen offset:2048 sc1
  v_mfma_f32_16x16x32_bf16 v[144:147], v[208:211], v[156:159], v[144:147]
  ds_read_b128 v[208:211], v152 offset:704
  v_mfma_f32_16x16x32_bf16 v[140:143], v[204:207], v[156:159], v[140:143]
  v_mfma_f32_16x16x32_bf16 v[132:135], v[200:203], v[156:159], v[132:135]
  v_mfma_f32_16x16x32_bf16 v[128:131], v[196:199], v[156:159], v[128:131]
  buffer_load_dwordx4 v[88:91], v4, s[44:47], s21 offen offset:3072 sc1
  s_add_u32 s21, s21, 4096
  v_mfma_f32_16x16x32_bf16 v[124:127], v[192:195], v[156:159], v[124:127]
  v_mfma_f32_16x16x32_bf16 v[116:119], v[188:191], v[156:159], v[116:119]
  v_mfma_f32_16x16x32_bf16 v[112:115], v[184:187], v[156:159], v[112:115]
  ds_read_b128 v[156:159], v153 offset:704
  buffer_load_dwordx4 v[92:95], v4, s[44:47], s21 offen offset:0 sc1
  v_mfma_f32_16x16x32_bf16 v[144:147], v[204:207], v[160:163], v[144:147]
  ds_read_b128 v[204:207], v152 offset:1216
  v_mfma_f32_16x16x32_bf16 v[140:143], v[200:203], v[160:163], v[140:143]
  v_mfma_f32_16x16x32_bf16 v[132:135], v[196:199], v[160:163], v[132:135]
  v_mfma_f32_16x16x32_bf16 v[128:131], v[192:195], v[160:163], v[128:131]
  buffer_load_dwordx4 v[96:99], v4, s[44:47], s21 offen offset:1024 sc1
  v_mfma_f32_16x16x32_bf16 v[124:127], v[188:191], v[160:163], v[124:127]
  v_mfma_f32_16x16x32_bf16 v[116:119], v[184:187], v[160:163], v[116:119]
  ds_read_b128 v[160:163], v153 offset:1216
  v_mfma_f32_16x16x32_bf16 v[144:147], v[200:203], v[164:167], v[144:147]
  ds_read_b128 v[200:203], v152 offset:1728
  v_mfma_f32_16x16x32_bf16 v[140:143], v[196:199], v[164:167], v[140:143]
  buffer_load_dwordx4 v[100:103], v4, s[44:47], s21 offen offset:2048 sc1
  v_mfma_f32_16x16x32_bf16 v[132:135], v[192:195], v[164:167], v[132:135]
  v_mfma_f32_16x16x32_bf16 v[128:131], v[188:191], v[164:167], v[128:131]
  v_mfma_f32_16x16x32_bf16 v[124:127], v[184:187], v[164:167], v[124:127]
  ds_read_b128 v[164:167], v153 offset:1728
  v_mfma_f32_16x16x32_bf16 v[144:147], v[196:199], v[168:171], v[144:147]
  ds_read_b128 v[196:199], v152 offset:2240
  buffer_load_dwordx4 v[104:107], v4, s[44:47], s21 offen offset:3072 sc1
  s_add_u32 s21, s21, 4096
  v_mfma_f32_16x16x32_bf16 v[140:143], v[192:195], v[168:171], v[140:143]
  v_mfma_f32_16x16x32_bf16 v[132:135], v[188:191], v[168:171], v[132:135]
  v_mfma_f32_16x16x32_bf16 v[128:131], v[184:187], v[168:171], v[128:131]
  ds_read_b128 v[168:171], v153 offset:2240
  s_lshr_b32 s93, s2, 3
  s_lshl_b32 s93, s93, 11
  s_add_u32 s93, s93, L_mid-L_pc
  v_lshl_add_u32 v12, v0, 3, s93
  s_mov_b32 s94, L_end-L_pc-16
  v_min_u32 v12, s94, v12
  global_load_dword v8, v12, s[6:7]
  v_mfma_f32_16x16x32_bf16 v[144:147], v[192:195], v[172:175], v[144:147]
  ds_read_b128 v[192:195], v152 offset:2752
  s_lshl2_add_u32 s94, s76, s79
  s_lshl_b32 s94, s94, 6
  s_add_u32 s94, s94, 16384
  v_lshl_add_u32 v13, v5, 2, s94
  v_mfma_f32_16x16x32_bf16 v[140:143], v[188:191], v[172:175], v[140:143]
  v_cmp_gt_u32 vcc, 9, v5
  s_nop 1
  v_cndmask_b32 v13, v7, v13, vcc
  v_mfma_f32_16x16x32_bf16 v[132:135], v[184:187], v[172:175], v[132:135]
  ds_read_b128 v[172:175], v153 offset:2752
  s_mul_i32 s94, s76, 216
  s_add_u32 s94, s94, s79
  s_lshl_b32 s94, s94, 10
  s_add_u32 s22, s94, 7077888
  v_mfma_f32_16x16x32_bf16 v[144:147], v[188:191], v[176:179], v[144:147]
  ds_read_b128 v[188:191], v152 offset:3264
  buffer_load_dword v14, v13, s[44:47], 0 offen sc1
  v_mfma_f32_16x16x32_bf16 v[140:143], v[184:187], v[176:179], v[140:143]
  ds_read_b128 v[176:179], v153 offset:3264
  s_waitcnt lgkmcnt(14)
  v_mfma_f32_16x16x32_bf16 v[144:147], v[184:187], v[180:183], v[144:147]
  ds_read_b128 v[184:187], v152 offset:3776
  ds_read_b128 v[180:183], v153 offset:3776
  s_mov_b32 s83, 300000
  s_waitcnt vmcnt(0)
L_pollc_16:
  v_cmp_ne_u32 vcc, v14, v67
  s_sub_u32 s83, s83, 1
  s_cselect_b64 vcc, 0, vcc
  s_cmp_lg_u64 vcc, 0
  s_cbranch_scc1 L_poll_15
  s_waitcnt lgkmcnt(14)
  v_mfma_f32_16x16x32_bf16 v[144:147], v[212:215], v[148:151], v[144:147]
  buffer_load_dwordx4 v[212:215], v4, s[44:47], s22 offen sc1
  s_add_u32 s22, s22, 4096
  s_waitcnt lgkmcnt(13)
  v_mfma_f32_16x16x32_bf16 v[140:143], v[208:211], v[148:151], v[140:143]
  s_waitcnt lgkmcnt(11)
  v_mfma_f32_16x16x32_bf16 v[132:135], v[204:207], v[148:151], v[132:135]
  s_waitcnt lgkmcnt(9)
  v_mfma_f32_16x16x32_bf16 v[128:131], v[200:203], v[148:151], v[128:131]
  s_waitcnt lgkmcnt(7)
  v_mfma_f32_16x16x32_bf16 v[124:127], v[196:199], v[148:151], v[124:127]
  s_waitcnt lgkmcnt(5)
  v_mfma_f32_16x16x32_bf16 v[116:119], v[192:195], v[148:151], v[116:119]
  s_waitcnt lgkmcnt(3)
  v_mfma_f32_16x16x32_bf16 v[112:115], v[188:191], v[148:151], v[112:115]
  s_waitcnt lgkmcnt(1)
  v_mfma_f32_16x16x32_bf16 v[108:111], v[184:187], v[148:151], v[108:111]
  buffer_load_dwordx4 v[148:151], v4, s[44:47], s22 offen sc1
  s_add_u32 s22, s22, 4096
  v_mfma_f32_16x16x32_bf16 v[144:147], v[208:211], v[156:159], v[144:147]
  buffer_load_dwordx4 v[208:211], v4, s[44:47], s22 offen sc1
  s_add_u32 s22, s22, 4096
  v_mfma_f32_16x16x32_bf16 v[140:143], v[204:207], v[156:159], v[140:143]
  v_mfma_f32_16x16x32_bf16 v[132:135], v[200:203], v[156:159], v[132:135]
  v_mfma_f32_16x16x32_bf16 v[128:131], v[196:199], v[156:159], v[128:131]
  v_mfma_f32_16x16x32_bf16 v[124:127], v[192:195], v[156:159], v[124:127]
  v_mfma_f32_16x16x32_bf16 v[116:119], v[188:191], v[156:159], v[116:119]
  v_mfma_f32_16x16x32_bf16 v[112:115], v[184:187], v[156:159], v[112:115]
  buffer_load_dwordx4 v[156:159], v4, s[44:47], s22 offen sc1
  s_add_u32 s22, s22, 4096
  v_mfma_f32_16x16x32_bf16 v[144:147], v[204:207], v[160:163], v[144:147]
  buffer_load_dwordx4 v[204:207], v4, s[44:47], s22 offen sc1
  s_add_u32 s22, s22, 4096
  v_mfma_f32_16x16x32_bf16 v[140:143], v[200:203], v[160:163], v[140:143]
  v_mfma_f32_16x16x32_bf16 v[132:135], v[196:199], v[160:163], v[132:135]
  v_mfma_f32_16x16x32_bf16 v[128:131], v[192:195], v[160:163], v[128:131]
  v_mfma_f32_16x16x32_bf16 v[124:127], v[188:191], v[160:163], v[124:127]
  v_mfma_f32_16x16x32_bf16 v[116:119], v[184:187], v[160:163], v[116:119]
  buffer_load_dwordx4 v[160:163], v4, s[44:47], s22 offen sc1
  s_add_u32 s22, s22, 4096
  ds_write_b32 v216, v108 offset:20480
  ds_write_b32 v217, v109 offset:20484
  ds_write_b32 v218, v110 offset:20648
  ds_write_b32 v216, v111 offset:20656
  v_mfma_f32_16x16x32_bf16 v[144:147], v[200:203], v[164:167], v[144:147]
  buffer_load_dwordx4 v[200:203], v4, s[44:47], s22 offen sc1
  s_add_u32 s22, s22, 4096
  v_mfma_f32_16x16x32_bf16 v[140:143], v[196:199], v[164:167], v[140:143]
  v_mfma_f32_16x16x32_bf16 v[132:135], v[192:195], v[164:167], v[132:135]
  v_mfma_f32_16x16x32_bf16 v[128:131], v[188:191], v[164:167], v[128:131]
  v_mfma_f32_16x16x32_bf16 v[124:127], v[184:187], v[164:167], v[124:127]
  buffer_load_dwordx4 v[164:167], v4, s[44:47], s22 offen sc1
  s_add_u32 s22, s22, 4096
  ds_write_b32 v217, v112 offset:21844
  ds_write_b32 v218, v113 offset:21848
  ds_write_b32 v216, v114 offset:22016
  ds_write_b32 v217, v115 offset:22020
  v_mfma_f32_16x16x32_bf16 v[144:147], v[196:199], v[168:171], v[144:147]
  buffer_load_dwordx4 v[196:199], v4, s[44:47], s22 offen sc1
  s_add_u32 s22, s22, 4096
  v_mfma_f32_16x16x32_bf16 v[140:143], v[192:195], v[168:171], v[140:143]
  v_mfma_f32_16x16x32_bf16 v[132:135], v[188:191], v[168:171], v[132:135]
  v_mfma_f32_16x16x32_bf16 v[128:131], v[184:187], v[168:171], v[128:131]
  buffer_load_dwordx4 v[168:171], v4, s[44:47], s22 offen sc1
  s_add_u32 s22, s22, 4096
  ds_write_b32 v218, v116 offset:23208
  ds_write_b32 v216, v117 offset:23216
  ds_write_b32 v217, v118 offset:23380
  ds_write_b32 v218, v119 offset:23384
  v_mfma_f32_16x16x32_bf16 v[144:147], v[192:195], v[172:175], v[144:147]
  buffer_load_dwordx4 v[192:195], v4, s[44:47], s22 offen sc1
  s_add_u32 s22, s22, 4096
  v_mfma_f32_16x16x32_bf16 v[140:143], v[188:191], v[172:175], v[140:143]
  v_mfma_f32_16x16x32_bf16 v[132:135], v[184:187], v[172:175], v[132:135]
  buffer_load_dwordx4 v[172:175], v4, s[44:47], s22 offen sc1
  s_add_u32 s22, s22, 4096
  ds_write_b32 v216, v124 offset:24576
  ds_write_b32 v217, v125 offset:24580
  ds_write_b32 v218, v126 offset:24744
  ds_write_b32 v216, v127 offset:24752
  v_mfma_f32_16x16x32_bf16 v[144:147], v[188:191], v[176:179], v[144:147]
  buffer_load_dwordx4 v[188:191], v4, s[44:47], s22 offen sc1
  s_add_u32 s22, s22, 4096
  v_mfma_f32_16x16x32_bf16 v[140:143], v[184:187], v[176:179], v[140:143]
  buffer_load_dwordx4 v[176:179], v4, s[44:47], s22 offen sc1
  s_add_u32 s22, s22, 4096
  ds_write_b32 v217, v128 offset:25940
  ds_write_b32 v218, v129 offset:25944
  ds_write_b32 v216, v130 offset:26112
  ds_write_b32 v217, v131 offset:26116
  s_waitcnt lgkmcnt(15)
  v_mfma_f32_16x16x32_bf16 v[144:147], v[184:187], v[180:183], v[144:147]
  buffer_load_dwordx4 v[184:187], v4, s[44:47], s22 offen sc1
  s_add_u32 s22, s22, 4096
  buffer_load_dwordx4 v[180:183], v4, s[44:47], s22 offen sc1
  s_add_u32 s22, s22, 4096
  ds_write_b32 v218, v132 offset:27304
  ds_write_b32 v216, v133 offset:27312
  ds_write_b32 v217, v134 offset:27476
  ds_write_b32 v218, v135 offset:27480
  ds_write_b32 v216, v140 offset:28672
  ds_write_b32 v217, v141 offset:28676
  ds_write_b32 v218, v142 offset:28840
  ds_write_b32 v216, v143 offset:28848
  ds_write_b32 v217, v144 offset:30036
  ds_write_b32 v218, v145 offset:30040
  ds_write_b32 v216, v146 offset:30208
  ds_write_b32 v217, v147 offset:30212
L_mid:
  s_waitcnt lgkmcnt(0)
  s_barrier
  s_waitcnt vmcnt(15)
  v_mfma_f32_16x16x32_bf16 v[252:255], a[144:147], v[212:215], 0
  s_waitcnt vmcnt(14)
  v_lshlrev_b32 v12, 4, v0
  v_mul_u32_u24 v13, 6, v0
  v_mfma_f32_16x16x32_bf16 v[248:251], a[148:151], v[212:215], 0
  v_sub_u32 v13, 4090, v13
  v_and_b32 v13, -4, v13
  v_mfma_f32_16x16x32_bf16 v[244:247], a[152:155], v[212:215], 0
  v_and_b32 v15, 1, v0
  v_sub_u32 v15, 1, v15
  v_mfma_f32_16x16x32_bf16 v[240:243], a[156:159], v[212:215], 0
  buffer_load_dwordx4 v[212:215], v4, s[44:47], s22 offen sc1
  s_add_u32 s22, s22, 4096
  v_mfma_f32_16x16x32_bf16 v[252:255], a[160:163], v[148:151], v[252:255]
  s_waitcnt vmcnt(14)
  v_mul_u32_u24 v15, 4640, v15
  v_add_u32 v13, v13, v15
  v_mfma_f32_16x16x32_bf16 v[248:251], a[164:167], v[148:151], v[248:251]
  ds_read_b32 v128, v13 offset:16
  v_mfma_f32_16x16x32_bf16 v[244:247], a[168:171], v[148:151], v[244:247]
  ds_read_b32 v129, v13 offset:20
  v_mfma_f32_16x16x32_bf16 v[240:243], a[172:175], v[148:151], v[240:243]
  buffer_load_dwordx4 v[148:151], v4, s[44:47], s22 offen sc1
  s_add_u32 s22, s22, 4096
  v_mfma_f32_16x16x32_bf16 v[252:255], a[176:179], v[208:211], v[252:255]
  s_waitcnt vmcnt(14)
  ds_read_b32 v130, v13 offset:9296
  v_mfma_f32_16x16x32_bf16 v[248:251], a[180:183], v[208:211], v[248:251]
  ds_read_b32 v131, v13 offset:9300
  v_mfma_f32_16x16x32_bf16 v[244:247], a[184:187], v[208:211], v[244:247]
  ds_read_b128 v[236:239], v12 offset:20480
  v_mfma_f32_16x16x32_bf16 v[240:243], a[188:191], v[208:211], v[240:243]
  buffer_load_dwordx4 v[208:211], v4, s[44:47], s22 offen sc1
  s_add_u32 s22, s22, 4096
  v_mfma_f32_16x16x32_bf16 v[252:255], a[192:195], v[156:159], v[252:255]
  s_waitcnt vmcnt(14)
  ds_read_b128 v[232:235], v12 offset:31424
  v_mfma_f32_16x16x32_bf16 v[248:251], a[196:199], v[156:159], v[248:251]
  ds_read_b128 v[228:231], v12 offset:42368
  v_mfma_f32_16x16x32_bf16 v[244:247], a[200:203], v[156:159], v[244:247]
  ds_read_b128 v[224:227], v12 offset:53312
  v_and_b32 v137, 0xffff0000, v136
  v_mfma_f32_16x16x32_bf16 v[240:243], a[204:207], v[156:159], v[240:243]
  buffer_load_dwordx4 v[156:159], v4, s[44:47], s22 offen sc1
  s_add_u32 s22, s22, 4096
  v_mfma_f32_16x16x32_bf16 v[252:255], a[208:211], v[204:207], v[252:255]
  s_waitcnt vmcnt(14)
  v_lshlrev_b32 v136, 16, v136
  s_mul_i32 s94, s82, 11264
  s_add_u32 s94, s94, 19660800
  v_add_u32 v14, s94, v12
  v_mfma_f32_16x16x32_bf16 v[248:251], a[212:215], v[204:207], v[248:251]
  v_mov_b32 v147, v2
  v_subrev_u32 v13, 1536, v13
  v_mfma_f32_16x16x32_bf16 v[244:247], a[216:219], v[204:207], v[244:247]
  ds_read_b32 v132, v13 offset:16
  v_mfma_f32_16x16x32_bf16 v[240:243], a[220:223], v[204:207], v[240:243]
  buffer_load_dwordx4 v[204:207], v4, s[44:47], s22 offen sc1
  s_add_u32 s22, s22, 4096
  v_mfma_f32_16x16x32_bf16 v[252:255], a[224:227], v[160:163], v[252:255]
  s_waitcnt vmcnt(14)
  ds_read_b32 v133, v13 offset:20
  v_mfma_f32_16x16x32_bf16 v[248:251], a[228:231], v[160:163], v[248:251]
  ds_read_b32 v134, v13 offset:9296
  v_mfma_f32_16x16x32_bf16 v[244:247], a[232:235], v[160:163], v[244:247]
  ds_read_b32 v135, v13 offset:9300
  v_mfma_f32_16x16x32_bf16 v[240:243], a[236:239], v[160:163], v[240:243]
  buffer_load_dwordx4 v[160:163], v4, s[44:47], s22 offen sc1
  s_add_u32 s22, s22, 4096
  v_mfma_f32_16x16x32_bf16 v[252:255], a[240:243], v[200:203], v[252:255]
  s_waitcnt vmcnt(14)
  ds_read_b128 v[108:111], v12 offset:24576
  v_mfma_f32_16x16x32_bf16 v[248:251], a[244:247], v[200:203], v[248:251]
  ds_read_b128 v[112:115], v12 offset:35520
  v_mfma_f32_16x16x32_bf16 v[244:247], a[248:251], v[200:203], v[244:247]
  ds_read_b128 v[116:119], v12 offset:46464
  v_mfma_f32_16x16x32_bf16 v[240:243], a[252:255], v[200:203], v[240:243]
  buffer_load_dwordx4 v[200:203], v4, s[44:47], s22 offen sc1
  s_add_u32 s22, s22, 4096
  v_mfma_f32_16x16x32_bf16 v[252:255], v[76:79], v[164:167], v[252:255]
  s_waitcnt vmcnt(14)
  ds_read_b128 v[124:127], v12 offset:57408
  s_waitcnt lgkmcnt(14)
  v_lshlrev_b32 v138, 16, v129
  v_mfma_f32_16x16x32_bf16 v[248:251], v[80:83], v[164:167], v[248:251]
  v_and_b32 v139, 0xffff0000, v128
  v_lshlrev_b32 v140, 16, v128
  v_mfma_f32_16x16x32_bf16 v[244:247], v[84:87], v[164:167], v[244:247]
  v_mul_f32 v138, v138, v136
  v_mul_f32 v139, v139, v136
  v_mfma_f32_16x16x32_bf16 v[240:243], v[88:91], v[164:167], v[240:243]
  buffer_load_dwordx4 v[164:167], v4, s[44:47], s22 offen sc1
  s_add_u32 s22, s22, 4096
  v_mfma_f32_16x16x32_bf16 v[252:255], v[92:95], v[196:199], v[252:255]
  v_mul_f32 v140, v140, v136
  s_waitcnt lgkmcnt(12)
  v_lshlrev_b32 v141, 16, v131
  v_mfma_f32_16x16x32_bf16 v[248:251], v[96:99], v[196:199], v[248:251]
  v_and_b32 v142, 0xffff0000, v130
  v_lshlrev_b32 v143, 16, v130
  v_mfma_f32_16x16x32_bf16 v[244:247], v[100:103], v[196:199], v[244:247]
  v_mul_f32 v141, v141, v137
  v_mul_f32 v142, v142, v137
  v_mfma_f32_16x16x32_bf16 v[240:243], v[104:107], v[196:199], v[240:243]
  buffer_load_dwordx4 v[196:199], v4, s[44:47], s22 offen sc1
  s_add_u32 s22, s22, 4096
  v_mul_f32 v143, v143, v137
  s_waitcnt lgkmcnt(10)
  v_add_f32 v236, v236, v232
  v_add_f32 v237, v237, v233
  v_add_f32 v238, v238, v234
  v_cvt_pk_bf16_f32 v138, v236, v138
  v_cvt_pk_bf16_f32 v139, v237, v139
  v_cvt_pk_bf16_f32 v140, v238, v140
  s_waitcnt lgkmcnt(8)
  v_add_f32 v228, v228, v224
  v_add_f32 v229, v229, v225
  v_add_f32 v230, v230, v226
  v_cvt_pk_bf16_f32 v141, v228, v141
  v_cvt_pk_bf16_f32 v142, v229, v142
  v_cvt_pk_bf16_f32 v143, v230, v143
  s_waitcnt vmcnt(15)
  v_mfma_f32_16x16x32_bf16 v[236:239], a[144:147], v[168:171], 0
  s_waitcnt vmcnt(14)
  v_lshlrev_b32 v15, 16, v138
  v_and_b32 v138, 0xffff0000, v138
  v_mfma_f32_16x16x32_bf16 v[232:235], a[148:151], v[168:171], 0
  v_add_f32 v138, v138, v15
  v_lshlrev_b32 v15, 16, v139
  v_mfma_f32_16x16x32_bf16 v[228:231], a[152:155], v[168:171], 0
  v_and_b32 v139, 0xffff0000, v139
  v_add_f32 v139, v139, v15
  v_mfma_f32_16x16x32_bf16 v[224:227], a[156:159], v[168:171], 0
  buffer_load_dwordx4 v[168:171], v4, s[44:47], s22 offen sc1
  s_add_u32 s22, s22, 4096
  v_mfma_f32_16x16x32_bf16 v[236:239], a[160:163], v[192:195], v[236:239]
  s_waitcnt vmcnt(14)
  v_lshlrev_b32 v15, 16, v140
  v_and_b32 v140, 0xffff0000, v140
  v_mfma_f32_16x16x32_bf16 v[232:235], a[164:167], v[192:195], v[232:235]
  v_add_f32 v140, v140, v15
  v_lshlrev_b32 v15, 16, v141
  v_mfma_f32_16x16x32_bf16 v[228:231], a[168:171], v[192:195], v[228:231]
  v_and_b32 v141, 0xffff0000, v141
  v_add_f32 v141, v141, v15
  v_mfma_f32_16x16x32_bf16 v[224:227], a[172:175], v[192:195], v[224:227]
  buffer_load_dwordx4 v[192:195], v4, s[44:47], s22 offen sc1
  s_add_u32 s22, s22, 4096
  v_mfma_f32_16x16x32_bf16 v[236:239], a[176:179], v[172:175], v[236:239]
  s_waitcnt vmcnt(14)
  v_lshlrev_b32 v15, 16, v142
  v_and_b32 v142, 0xffff0000, v142
  v_mfma_f32_16x16x32_bf16 v[232:235], a[180:183], v[172:175], v[232:235]
  v_add_f32 v142, v142, v15
  v_lshlrev_b32 v15, 16, v143
  v_mfma_f32_16x16x32_bf16 v[228:231], a[184:187], v[172:175], v[228:231]
  v_and_b32 v143, 0xffff0000, v143
  v_add_f32 v143, v143, v15
  v_mfma_f32_16x16x32_bf16 v[224:227], a[188:191], v[172:175], v[224:227]
  buffer_load_dwordx4 v[172:175], v4, s[44:47], s22 offen sc1
  s_add_u32 s22, s22, 4096
  v_mfma_f32_16x16x32_bf16 v[236:239], a[192:195], v[188:191], v[236:239]
  s_waitcnt vmcnt(14)
  v_cvt_pk_bf16_f32 v144, v138, v141
  v_cvt_pk_bf16_f32 v145, v139, v142
  v_mfma_f32_16x16x32_bf16 v[232:235], a[196:199], v[188:191], v[232:235]
  v_cvt_pk_bf16_f32 v146, v140, v143
  buffer_store_dwordx4 v[144:147], v14, s[44:47], 0 offen sc1
  v_mfma_f32_16x16x32_bf16 v[228:231], a[200:203], v[188:191], v[228:231]
  v_add_u32 v14, 4096, v14
  s_waitcnt lgkmcnt(6)
  v_lshlrev_b32 v138, 16, v133
  v_mfma_f32_16x16x32_bf16 v[224:227], a[204:207], v[188:191], v[224:227]
  buffer_load_dwordx4 v[188:191], v4, s[44:47], s22 offen sc1
  s_add_u32 s22, s22, 4096
  v_mfma_f32_16x16x32_bf16 v[236:239], a[208:211], v[176:179], v[236:239]
  s_waitcnt vmcnt(15)
  v_and_b32 v139, 0xffff0000, v132
  v_lshlrev_b32 v140, 16, v132
  v_mfma_f32_16x16x32_bf16 v[232:235], a[212:215], v[176:179], v[232:235]
  v_mul_f32 v138, v138, v136
  v_mul_f32 v139, v139, v136
  v_mfma_f32_16x16x32_bf16 v[228:231], a[216:219], v[176:179], v[228:231]
  v_mul_f32 v140, v140, v136
  s_waitcnt lgkmcnt(4)
  v_lshlrev_b32 v141, 16, v135
  v_mfma_f32_16x16x32_bf16 v[224:227], a[220:223], v[176:179], v[224:227]
  buffer_load_dwordx4 v[176:179], v4, s[44:47], s22 offen sc1
  s_add_u32 s22, s22, 4096
  v_mfma_f32_16x16x32_bf16 v[236:239], a[224:227], v[184:187], v[236:239]
  s_waitcnt vmcnt(15)
  v_and_b32 v142, 0xffff0000, v134
  v_lshlrev_b32 v143, 16, v134
  v_mfma_f32_16x16x32_bf16 v[232:235], a[228:231], v[184:187], v[232:235]
  v_mul_f32 v141, v141, v137
  v_mul_f32 v142, v142, v137
  v_mfma_f32_16x16x32_bf16 v[228:231], a[232:235], v[184:187], v[228:231]
  v_mul_f32 v143, v143, v137
  s_waitcnt lgkmcnt(2)
  v_add_f32 v108, v108, v112
  v_mfma_f32_16x16x32_bf16 v[224:227], a[236:239], v[184:187], v[224:227]
  buffer_load_dwordx4 v[184:187], v4, s[44:47], s22 offen sc1
  s_add_u32 s22, s22, 4096
  v_mfma_f32_16x16x32_bf16 v[236:239], a[240:243], v[180:183], v[236:239]
  s_waitcnt vmcnt(15)
  v_add_f32 v109, v109, v113
  v_add_f32 v110, v110, v114
  v_mfma_f32_16x16x32_bf16 v[232:235], a[244:247], v[180:183], v[232:235]
  v_cvt_pk_bf16_f32 v138, v108, v138
  v_cvt_pk_bf16_f32 v139, v109, v139
  v_mfma_f32_16x16x32_bf16 v[228:231], a[248:251], v[180:183], v[228:231]
  v_cvt_pk_bf16_f32 v140, v110, v140
  s_waitcnt lgkmcnt(0)
  v_add_f32 v116, v116, v124
  v_mfma_f32_16x16x32_bf16 v[224:227], a[252:255], v[180:183], v[224:227]
  buffer_load_dwordx4 v[180:183], v4, s[44:47], s22 offen sc1
  s_add_u32 s22, s22, 4096
  v_mfma_f32_16x16x32_bf16 v[236:239], v[76:79], v[212:215], v[236:239]
  s_waitcnt vmcnt(15)
  v_add_f32 v117, v117, v125
  v_add_f32 v118, v118, v126
  v_mfma_f32_16x16x32_bf16 v[232:235], v[80:83], v[212:215], v[232:235]
  v_cvt_pk_bf16_f32 v141, v116, v141
  v_cvt_pk_bf16_f32 v142, v117, v142
  v_mfma_f32_16x16x32_bf16 v[228:231], v[84:87], v[212:215], v[228:231]
  v_cvt_pk_bf16_f32 v143, v118, v143
  v_subrev_u32 v13, 1536, v13
  v_mfma_f32_16x16x32_bf16 v[224:227], v[88:91], v[212:215], v[224:227]
  buffer_load_dwordx4 v[212:215], v4, s[44:47], s22 offen sc1
  s_add_u32 s22, s22, 4096
  v_mfma_f32_16x16x32_bf16 v[236:239], v[92:95], v[148:151], v[236:239]
  v_max_i32 v13, 0, v13
  ds_read_b32 v128, v13 offset:16
  v_mfma_f32_16x16x32_bf16 v[232:235], v[96:99], v[148:151], v[232:235]
  v_mfma_f32_16x16x32_bf16 v[228:231], v[100:103], v[148:151], v[228:231]
  ds_read_b32 v129, v13 offset:20
  v_mfma_f32_16x16x32_bf16 v[224:227], v[104:107], v[148:151], v[224:227]
  buffer_load_dwordx4 v[148:151], v4, s[44:47], s22 offen sc1
  s_add_u32 s22, s22, 4096
  ds_write_b128 v122, v[252:255] offset:17408
  ds_write_b128 v122, v[248:251] offset:17472
  ds_write_b128 v122, v[244:247] offset:17536
  ds_write_b128 v122, v[240:243] offset:17600
  s_waitcnt vmcnt(16)
  v_mfma_f32_16x16x32_bf16 v[252:255], a[144:147], v[208:211], 0
  s_waitcnt vmcnt(15)
  v_mfma_f32_16x16x32_bf16 v[248:251], a[148:151], v[208:211], 0
  v_mfma_f32_16x16x32_bf16 v[244:247], a[152:155], v[208:211], 0
  v_mfma_f32_16x16x32_bf16 v[240:243], a[156:159], v[208:211], 0
  buffer_load_dwordx4 v[208:211], v4, s[44:47], s22 offen sc1
  s_add_u32 s22, s22, 4096
  v_mfma_f32_16x16x32_bf16 v[252:255], a[160:163], v[156:159], v[252:255]
  s_waitcnt vmcnt(15)
  ds_read_b32 v130, v13 offset:9296
  v_mfma_f32_16x16x32_bf16 v[248:251], a[164:167], v[156:159], v[248:251]
  ds_read_b32 v131, v13 offset:9300
  v_mfma_f32_16x16x32_bf16 v[244:247], a[168:171], v[156:159], v[244:247]
  ds_read_b128 v[108:111], v12 offset:28672
  v_mfma_f32_16x16x32_bf16 v[240:243], a[172:175], v[156:159], v[240:243]
  buffer_load_dwordx4 v[156:159], v4, s[44:47], s22 offen sc1
  s_add_u32 s22, s22, 4096
  v_mfma_f32_16x16x32_bf16 v[252:255], a[176:179], v[204:207], v[252:255]
  s_waitcnt vmcnt(15)
  ds_read_b128 v[112:115], v12 offset:39616
  v_mfma_f32_16x16x32_bf16 v[248:251], a[180:183], v[204:207], v[248:251]
  ds_read_b128 v[116:119], v12 offset:50560
  v_mfma_f32_16x16x32_bf16 v[244:247], a[184:187], v[204:207], v[244:247]
  ds_read_b128 v[124:127], v12 offset:61504
  v_lshlrev_b32 v15, 16, v138
  v_mfma_f32_16x16x32_bf16 v[240:243], a[188:191], v[204:207], v[240:243]
  buffer_load_dwordx4 v[204:207], v4, s[44:47], s22 offen sc1
  s_add_u32 s22, s22, 4096
  v_mfma_f32_16x16x32_bf16 v[252:255], a[192:195], v[160:163], v[252:255]
  s_waitcnt vmcnt(15)
  v_and_b32 v138, 0xffff0000, v138
  v_add_f32 v138, v138, v15
  v_mfma_f32_16x16x32_bf16 v[248:251], a[196:199], v[160:163], v[248:251]
  v_lshlrev_b32 v15, 16, v139
  v_and_b32 v139, 0xffff0000, v139
  v_mfma_f32_16x16x32_bf16 v[244:247], a[200:203], v[160:163], v[244:247]
  v_add_f32 v139, v139, v15
  v_lshlrev_b32 v15, 16, v140
  v_mfma_f32_16x16x32_bf16 v[240:243], a[204:207], v[160:163], v[240:243]
  buffer_load_dwordx4 v[160:163], v4, s[44:47], s22 offen sc1
  s_add_u32 s22, s22, 4096
  v_mfma_f32_16x16x32_bf16 v[252:255], a[208:211], v[200:203], v[252:255]
  s_waitcnt vmcnt(15)
  v_and_b32 v140, 0xffff0000, v140
  v_add_f32 v140, v140, v15
  v_mfma_f32_16x16x32_bf16 v[248:251], a[212:215], v[200:203], v[248:251]
  v_lshlrev_b32 v15, 16, v141
  v_and_b32 v141, 0xffff0000, v141
  v_mfma_f32_16x16x32_bf16 v[244:247], a[216:219], v[200:203], v[244:247]
  v_add_f32 v141, v141, v15
  v_lshlrev_b32 v15, 16, v142
  v_mfma_f32_16x16x32_bf16 v[240:243], a[220:223], v[200:203], v[240:243]
  buffer_load_dwordx4 v[200:203], v4, s[44:47], s22 offen sc1
  s_add_u32 s22, s22, 4096
  v_mfma_f32_16x16x32_bf16 v[252:255], a[224:227], v[164:167], v[252:255]
  s_waitcnt vmcnt(15)
  v_and_b32 v142, 0xffff0000, v142
  v_add_f32 v142, v142, v15
  v_mfma_f32_16x16x32_bf16 v[248:251], a[228:231], v[164:167], v[248:251]
  v_lshlrev_b32 v15, 16, v143
  v_and_b32 v143, 0xffff0000, v143
  v_mfma_f32_16x16x32_bf16 v[244:247], a[232:235], v[164:167], v[244:247]
  v_add_f32 v143, v143, v15
  v_cvt_pk_bf16_f32 v144, v138, v141
  v_mfma_f32_16x16x32_bf16 v[240:243], a[236:239], v[164:167], v[240:243]
  buffer_load_dwordx4 v[164:167], v4, s[44:47], s22 offen sc1
  s_add_u32 s22, s22, 4096
  v_mfma_f32_16x16x32_bf16 v[252:255], a[240:243], v[196:199], v[252:255]
  s_waitcnt vmcnt(15)
  v_cvt_pk_bf16_f32 v145, v139, v142
  v_cvt_pk_bf16_f32 v146, v140, v143
  v_mfma_f32_16x16x32_bf16 v[248:251], a[244:247], v[196:199], v[248:251]
  buffer_store_dwordx4 v[144:147], v14, s[44:47], 0 offen sc1
  v_mfma_f32_16x16x32_bf16 v[244:247], a[248:251], v[196:199], v[244:247]
  v_add_u32 v14, 4096, v14
  v_cmp_gt_u32 vcc, 192, v0
  s_nop 1
  v_cndmask_b32 v14, v7, v14, vcc
  v_mfma_f32_16x16x32_bf16 v[240:243], a[252:255], v[196:199], v[240:243]
  buffer_load_dwordx4 v[196:199], v4, s[44:47], s22 offen sc1
  s_add_u32 s22, s22, 4096
  v_mfma_f32_16x16x32_bf16 v[252:255], v[76:79], v[168:171], v[252:255]
  s_waitcnt vmcnt(16)
  s_waitcnt lgkmcnt(10)
  v_lshlrev_b32 v138, 16, v129
  v_and_b32 v139, 0xffff0000, v128
  v_mfma_f32_16x16x32_bf16 v[248:251], v[80:83], v[168:171], v[248:251]
  v_lshlrev_b32 v140, 16, v128
  v_mul_f32 v138, v138, v136
  v_mfma_f32_16x16x32_bf16 v[244:247], v[84:87], v[168:171], v[244:247]
  v_mul_f32 v139, v139, v136
  v_mul_f32 v140, v140, v136
  v_mfma_f32_16x16x32_bf16 v[240:243], v[88:91], v[168:171], v[240:243]
  buffer_load_dwordx4 v[168:171], v4, s[44:47], s22 offen sc1
  s_add_u32 s22, s22, 4096
  v_mfma_f32_16x16x32_bf16 v[252:255], v[92:95], v[192:195], v[252:255]
  s_waitcnt lgkmcnt(4)
  v_lshlrev_b32 v141, 16, v131
  v_and_b32 v142, 0xffff0000, v130
  v_mfma_f32_16x16x32_bf16 v[248:251], v[96:99], v[192:195], v[248:251]
  v_lshlrev_b32 v143, 16, v130
  v_mul_f32 v141, v141, v137
  v_mfma_f32_16x16x32_bf16 v[244:247], v[100:103], v[192:195], v[244:247]
  v_mul_f32 v142, v142, v137
  v_mul_f32 v143, v143, v137
  v_mfma_f32_16x16x32_bf16 v[240:243], v[104:107], v[192:195], v[240:243]
  buffer_load_dwordx4 v[192:195], v4, s[44:47], s22 offen sc1
  s_add_u32 s22, s22, 4096
  ds_write_b128 v122, v[236:239] offset:34816
  ds_write_b128 v122, v[232:235] offset:34880
  ds_write_b128 v122, v[228:231] offset:34944
  ds_write_b128 v122, v[224:227] offset:35008
  s_waitcnt lgkmcnt(6)
  v_add_f32 v108, v108, v112
  v_add_f32 v109, v109, v113
  v_add_f32 v110, v110, v114
  v_cvt_pk_bf16_f32 v138, v108, v138
  v_cvt_pk_bf16_f32 v139, v109, v139
  v_cvt_pk_bf16_f32 v140, v110, v140
  s_waitcnt lgkmcnt(4)
  v_add_f32 v116, v116, v124
  v_add_f32 v117, v117, v125
  v_add_f32 v118, v118, v126
  v_cvt_pk_bf16_f32 v141, v116, v141
  v_cvt_pk_bf16_f32 v142, v117, v142
  v_cvt_pk_bf16_f32 v143, v118, v143
  v_lshlrev_b32 v15, 16, v138
  v_and_b32 v138, 0xffff0000, v138
  v_add_f32 v138, v138, v15
  v_lshlrev_b32 v15, 16, v139
  v_and_b32 v139, 0xffff0000, v139
  v_add_f32 v139, v139, v15
  v_lshlrev_b32 v15, 16, v140
  v_and_b32 v140, 0xffff0000, v140
  v_add_f32 v140, v140, v15
  v_lshlrev_b32 v15, 16, v141
  v_and_b32 v141, 0xffff0000, v141
  v_add_f32 v141, v141, v15
  v_lshlrev_b32 v15, 16, v142
  v_and_b32 v142, 0xffff0000, v142
  v_add_f32 v142, v142, v15
  v_lshlrev_b32 v15, 16, v143
  v_and_b32 v143, 0xffff0000, v143
  v_add_f32 v143, v143, v15
  v_cvt_pk_bf16_f32 v144, v138, v141
  v_cvt_pk_bf16_f32 v145, v139, v142
  v_cvt_pk_bf16_f32 v146, v140, v143
  buffer_store_dwordx4 v[144:147], v14, s[44:47], 0 offen sc1
  s_nop 1
  s_waitcnt lgkmcnt(0)
  s_barrier
  s_waitcnt vmcnt(18)
  v_mfma_f32_16x16x32_bf16 v[236:239], a[144:147], v[172:175], 0
  s_waitcnt vmcnt(16)
  ds_read_b128 v[12:15], v123 offset:17408
  v_mfma_f32_16x16x32_bf16 v[232:235], a[148:151], v[172:175], 0
  ds_read_b128 v[136:139], v123 offset:21760
  v_mfma_f32_16x16x32_bf16 v[228:231], a[152:155], v[172:175], 0
  ds_read_b128 v[140:143], v123 offset:26112
  v_mfma_f32_16x16x32_bf16 v[224:227], a[156:159], v[172:175], 0
  buffer_load_dwordx4 v[172:175], v4, s[44:47], s22 offen sc1
  s_add_u32 s22, s22, 4096
  v_mfma_f32_16x16x32_bf16 v[236:239], a[160:163], v[188:191], v[236:239]
  s_waitcnt vmcnt(16)
  ds_read_b128 v[144:147], v123 offset:30464
  v_mfma_f32_16x16x32_bf16 v[232:235], a[164:167], v[188:191], v[232:235]
  ds_write_b128 v120, v[252:255] offset:0
  v_mfma_f32_16x16x32_bf16 v[228:231], a[168:171], v[188:191], v[228:231]
  v_mfma_f32_16x16x32_bf16 v[224:227], a[172:175], v[188:191], v[224:227]
  buffer_load_dwordx4 v[188:191], v4, s[44:47], s22 offen sc1
  s_add_u32 s22, s22, 4096
  v_mfma_f32_16x16x32_bf16 v[236:239], a[176:179], v[176:179], v[236:239]
  s_waitcnt vmcnt(16)
  s_waitcnt lgkmcnt(4)
  v_add_f32 v16, v16, v12
  v_mfma_f32_16x16x32_bf16 v[232:235], a[180:183], v[176:179], v[232:235]
  v_add_f32 v17, v17, v13
  v_add_f32 v18, v18, v14
  v_mfma_f32_16x16x32_bf16 v[228:231], a[184:187], v[176:179], v[228:231]
  v_add_f32 v19, v19, v15
  ds_read_b128 v[12:15], v123 offset:34816
  v_mfma_f32_16x16x32_bf16 v[224:227], a[188:191], v[176:179], v[224:227]
  buffer_load_dwordx4 v[176:179], v4, s[44:47], s22 offen sc1
  s_add_u32 s22, s22, 4096
  v_mfma_f32_16x16x32_bf16 v[236:239], a[192:195], v[184:187], v[236:239]
  s_waitcnt vmcnt(16)
  s_waitcnt lgkmcnt(4)
  v_add_f32 v16, v16, v136
  v_add_f32 v17, v17, v137
  v_mfma_f32_16x16x32_bf16 v[232:235], a[196:199], v[184:187], v[232:235]
  v_add_f32 v18, v18, v138
  v_add_f32 v19, v19, v139
  v_mfma_f32_16x16x32_bf16 v[228:231], a[200:203], v[184:187], v[228:231]
  ds_read_b128 v[136:139], v123 offset:39168
  s_waitcnt lgkmcnt(4)
  v_add_f32 v16, v16, v140
  v_add_f32 v17, v17, v141
  v_mfma_f32_16x16x32_bf16 v[224:227], a[204:207], v[184:187], v[224:227]
  buffer_load_dwordx4 v[184:187], v4, s[44:47], s22 offen sc1
  s_add_u32 s22, s22, 4096
  v_mfma_f32_16x16x32_bf16 v[236:239], a[208:211], v[180:183], v[236:239]
  s_waitcnt vmcnt(16)
  v_add_f32 v18, v18, v142
  v_add_f32 v19, v19, v143
  v_mfma_f32_16x16x32_bf16 v[232:235], a[212:215], v[180:183], v[232:235]
  ds_read_b128 v[140:143], v123 offset:43520
  s_waitcnt lgkmcnt(4)
  v_add_f32 v16, v16, v144
  v_add_f32 v17, v17, v145
  v_mfma_f32_16x16x32_bf16 v[228:231], a[216:219], v[180:183], v[228:231]
  v_add_f32 v18, v18, v146
  v_add_f32 v19, v19, v147
  v_mfma_f32_16x16x32_bf16 v[224:227], a[220:223], v[180:183], v[224:227]
  buffer_load_dwordx4 v[180:183], v4, s[44:47], s22 offen sc1
  s_add_u32 s22, s22, 4096
  v_mfma_f32_16x16x32_bf16 v[236:239], a[224:227], v[212:215], v[236:239]
  s_waitcnt vmcnt(16)
  ds_read_b128 v[144:147], v123 offset:47872
  v_add_f32 v124, v16, v17
  v_mfma_f32_16x16x32_bf16 v[232:235], a[228:231], v[212:215], v[232:235]
  v_mul_f32 v130, v16, v16
  v_add_f32 v124, v124, v18
  v_mfma_f32_16x16x32_bf16 v[228:231], a[232:235], v[212:215], v[228:231]
  v_fmac_f32 v130, v17, v17
  v_add_f32 v124, v124, v19
  v_mfma_f32_16x16x32_bf16 v[224:227], a[236:239], v[212:215], v[224:227]
  buffer_load_dwordx4 v[212:215], v4, s[44:47], s22 offen sc1
  s_add_u32 s22, s22, 4096
  v_mfma_f32_16x16x32_bf16 v[236:239], a[240:243], v[148:151], v[236:239]
  s_waitcnt vmcnt(16)
  v_fmac_f32 v130, v18, v18
  v_fmac_f32 v130, v19, v19
  v_mfma_f32_16x16x32_bf16 v[232:235], a[244:247], v[148:151], v[232:235]
  s_waitcnt lgkmcnt(3)
  v_add_f32 v20, v20, v12
  v_add_f32 v21, v21, v13
  v_mfma_f32_16x16x32_bf16 v[228:231], a[248:251], v[148:151], v[228:231]
  v_add_f32 v22, v22, v14
  v_add_f32 v23, v23, v15
  v_mfma_f32_16x16x32_bf16 v[224:227], a[252:255], v[148:151], v[224:227]
  buffer_load_dwordx4 v[148:151], v4, s[44:47], s22 offen sc1
  s_add_u32 s22, s22, 4096
  v_mfma_f32_16x16x32_bf16 v[236:239], v[76:79], v[208:211], v[236:239]
  s_waitcnt vmcnt(16)
  s_waitcnt lgkmcnt(2)
  v_add_f32 v20, v20, v136
  v_add_f32 v21, v21, v137
  v_mfma_f32_16x16x32_bf16 v[232:235], v[80:83], v[208:211], v[232:235]
  v_add_f32 v22, v22, v138
  v_add_f32 v23, v23, v139
  v_mfma_f32_16x16x32_bf16 v[228:231], v[84:87], v[208:211], v[228:231]
  s_waitcnt lgkmcnt(1)
  v_add_f32 v20, v20, v140
  v_add_f32 v21, v21, v141
  v_mfma_f32_16x16x32_bf16 v[224:227], v[88:91], v[208:211], v[224:227]
  buffer_load_dwordx4 v[208:211], v4, s[44:47], s22 offen sc1
  s_add_u32 s22, s22, 4096
  v_mfma_f32_16x16x32_bf16 v[236:239], v[92:95], v[156:159], v[236:239]
  v_add_f32 v22, v22, v142
  v_add_f32 v23, v23, v143
  v_mfma_f32_16x16x32_bf16 v[232:235], v[96:99], v[156:159], v[232:235]
  s_waitcnt lgkmcnt(0)
  v_add_f32 v20, v20, v144
  v_add_f32 v21, v21, v145
  v_mfma_f32_16x16x32_bf16 v[228:231], v[100:103], v[156:159], v[228:231]
  v_add_f32 v22, v22, v146
  v_add_f32 v23, v23, v147
  v_mfma_f32_16x16x32_bf16 v[224:227], v[104:107], v[156:159], v[224:227]
  buffer_load_dwordx4 v[156:159], v4, s[44:47], s22 offen sc1
  s_add_u32 s22, s22, 4096
  ds_write_b128 v120, v[248:251] offset:64
  ds_write_b128 v120, v[244:247] offset:128
  ds_write_b128 v120, v[240:243] offset:192
  s_waitcnt lgkmcnt(0)
  s_barrier
  s_waitcnt vmcnt(17)
  v_mfma_f32_16x16x32_bf16 v[252:255], a[144:147], v[204:207], 0
  s_waitcnt vmcnt(16)
  v_add_f32 v125, v20, v21
  v_mul_f32 v131, v20, v20
  v_mfma_f32_16x16x32_bf16 v[248:251], a[148:151], v[204:207], 0
  v_add_f32 v125, v125, v22
  v_fmac_f32 v131, v21, v21
  v_mfma_f32_16x16x32_bf16 v[244:247], a[152:155], v[204:207], 0
  v_add_f32 v125, v125, v23
  v_fmac_f32 v131, v22, v22
  v_mfma_f32_16x16x32_bf16 v[240:243], a[156:159], v[204:207], 0
  buffer_load_dwordx4 v[204:207], v4, s[44:47], s22 offen sc1
  s_add_u32 s22, s22, 4096
  v_mfma_f32_16x16x32_bf16 v[252:255], a[160:163], v[160:163], v[252:255]
  s_waitcnt vmcnt(16)
  v_fmac_f32 v131, v23, v23
  ds_read_b128 v[12:15], v121 offset:0
  v_mfma_f32_16x16x32_bf16 v[248:251], a[164:167], v[160:163], v[248:251]
  v_mfma_f32_16x16x32_bf16 v[244:247], a[168:171], v[160:163], v[244:247]
  ds_read_b128 v[136:139], v121 offset:4352
  v_mfma_f32_16x16x32_bf16 v[240:243], a[172:175], v[160:163], v[240:243]
  buffer_load_dwordx4 v[160:163], v4, s[44:47], s22 offen sc1
  s_add_u32 s22, s22, 4096
  v_mfma_f32_16x16x32_bf16 v[252:255], a[176:179], v[200:203], v[252:255]
  s_waitcnt vmcnt(16)
  ds_read_b128 v[140:143], v121 offset:8704
  v_mfma_f32_16x16x32_bf16 v[248:251], a[180:183], v[200:203], v[248:251]
  ds_read_b128 v[144:147], v121 offset:13056
  v_mfma_f32_16x16x32_bf16 v[244:247], a[184:187], v[200:203], v[244:247]
  ds_write_b128 v120, v[236:239] offset:17408
  v_mfma_f32_16x16x32_bf16 v[240:243], a[188:191], v[200:203], v[240:243]
  v_mfma_f32_16x16x32_bf16 v[252:255], a[192:195], v[164:167], v[252:255]
  s_waitcnt vmcnt(14)
  v_mfma_f32_16x16x32_bf16 v[248:251], a[196:199], v[164:167], v[248:251]
  s_waitcnt lgkmcnt(4)
  v_add_f32 v24, v24, v12
  v_add_f32 v25, v25, v13
  v_mfma_f32_16x16x32_bf16 v[244:247], a[200:203], v[164:167], v[244:247]
  v_add_f32 v26, v26, v14
  v_add_f32 v27, v27, v15
  v_mfma_f32_16x16x32_bf16 v[240:243], a[204:207], v[164:167], v[240:243]
  s_waitcnt lgkmcnt(3)
  v_add_f32 v24, v24, v136
  v_add_f32 v25, v25, v137
  v_mfma_f32_16x16x32_bf16 v[252:255], a[208:211], v[196:199], v[252:255]
  s_waitcnt vmcnt(13)
  v_add_f32 v26, v26, v138
  v_add_f32 v27, v27, v139
  v_mfma_f32_16x16x32_bf16 v[248:251], a[212:215], v[196:199], v[248:251]
  s_waitcnt lgkmcnt(2)
  v_add_f32 v24, v24, v140
  v_add_f32 v25, v25, v141
  v_mfma_f32_16x16x32_bf16 v[244:247], a[216:219], v[196:199], v[244:247]
  v_add_f32 v26, v26, v142
  v_add_f32 v27, v27, v143
  v_mfma_f32_16x16x32_bf16 v[240:243], a[220:223], v[196:199], v[240:243]
  s_waitcnt lgkmcnt(1)
  v_add_f32 v24, v24, v144
  v_add_f32 v25, v25, v145
  v_mfma_f32_16x16x32_bf16 v[252:255], a[224:227], v[168:171], v[252:255]
  s_waitcnt vmcnt(12)
  v_add_f32 v26, v26, v146
  v_add_f32 v27, v27, v147
  v_mfma_f32_16x16x32_bf16 v[248:251], a[228:231], v[168:171], v[248:251]
  v_add_f32 v126, v24, v25
  v_mul_f32 v132, v24, v24
  v_mfma_f32_16x16x32_bf16 v[244:247], a[232:235], v[168:171], v[244:247]
  v_add_f32 v126, v126, v26
  v_fmac_f32 v132, v25, v25
  v_mfma_f32_16x16x32_bf16 v[240:243], a[236:239], v[168:171], v[240:243]
  v_add_f32 v126, v126, v27
  v_fmac_f32 v132, v26, v26
  v_mfma_f32_16x16x32_bf16 v[252:255], a[240:243], v[192:195], v[252:255]
  s_waitcnt vmcnt(10)
  v_fmac_f32 v132, v27, v27
  v_add_u32 v153, 16, v2
  v_mfma_f32_16x16x32_bf16 v[248:251], a[244:247], v[192:195], v[248:251]
  v_add_u32 v155, 16, v2
  v_add_f32_dpp v124, v124, v124 row_ror:8 row_mask:0xf bank_mask:0xf
  v_mfma_f32_16x16x32_bf16 v[244:247], a[248:251], v[192:195], v[244:247]
  v_add_f32_dpp v125, v125, v125 row_ror:8 row_mask:0xf bank_mask:0xf
  v_add_f32_dpp v126, v126, v126 row_ror:8 row_mask:0xf bank_mask:0xf
  v_mfma_f32_16x16x32_bf16 v[240:243], a[252:255], v[192:195], v[240:243]
  v_add_f32_dpp v130, v130, v130 row_ror:8 row_mask:0xf bank_mask:0xf
  v_add_f32_dpp v131, v131, v131 row_ror:8 row_mask:0xf bank_mask:0xf
  v_mfma_f32_16x16x32_bf16 v[252:255], v[76:79], v[172:175], v[252:255]
  s_waitcnt vmcnt(9)
  v_add_f32_dpp v132, v132, v132 row_ror:8 row_mask:0xf bank_mask:0xf
  v_add_f32_dpp v124, v124, v124 row_half_mirror row_mask:0xf bank_mask:0x5
  v_mfma_f32_16x16x32_bf16 v[248:251], v[80:83], v[172:175], v[248:251]
  v_add_f32_dpp v126, v126, v126 row_half_mirror row_mask:0xf bank_mask:0xf
  v_add_f32_dpp v130, v130, v130 row_half_mirror row_mask:0xf bank_mask:0x5
  v_mfma_f32_16x16x32_bf16 v[244:247], v[84:87], v[172:175], v[244:247]
  v_add_f32_dpp v132, v132, v132 row_half_mirror row_mask:0xf bank_mask:0xf
  v_add_f32_dpp v124, v125, v125 row_half_mirror row_mask:0xf bank_mask:0xa
  v_mfma_f32_16x16x32_bf16 v[240:243], v[88:91], v[172:175], v[240:243]
  v_add_f32_dpp v130, v131, v131 row_half_mirror row_mask:0xf bank_mask:0xa
  v_add_f32_dpp v126, v126, v126 quad_perm:[1,0,3,2] row_mask:0xf bank_mask:0xf
  v_mfma_f32_16x16x32_bf16 v[252:255], v[92:95], v[188:191], v[252:255]
  v_add_f32_dpp v132, v132, v132 quad_perm:[1,0,3,2] row_mask:0xf bank_mask:0xf
  v_add_f32_dpp v124, v124, v124 quad_perm:[1,0,3,2] row_mask:0xf bank_mask:0xf
  v_mfma_f32_16x16x32_bf16 v[248:251], v[96:99], v[188:191], v[248:251]
  v_add_f32_dpp v130, v130, v130 quad_perm:[1,0,3,2] row_mask:0xf bank_mask:0xf
  v_add_f32_dpp v126, v126, v126 quad_perm:[2,3,0,1] row_mask:0xf bank_mask:0xf
  v_mfma_f32_16x16x32_bf16 v[244:247], v[100:103], v[188:191], v[244:247]
  v_add_f32_dpp v132, v132, v132 quad_perm:[2,3,0,1] row_mask:0xf bank_mask:0xf
  v_add_f32_dpp v124, v124, v124 quad_perm:[2,3,0,1] row_mask:0xf bank_mask:0xf
  v_mfma_f32_16x16x32_bf16 v[240:243], v[104:107], v[188:191], v[240:243]
  ds_write_b128 v120, v[232:235] offset:17472
  ds_write_b128 v120, v[228:231] offset:17536
  ds_write_b128 v120, v[224:227] offset:17600
  s_waitcnt lgkmcnt(0)
  s_barrier
  s_waitcnt vmcnt(8)
  v_mfma_f32_16x16x32_bf16 v[236:239], a[144:147], v[176:179], 0
  s_waitcnt vmcnt(7)
  v_add_f32_dpp v130, v130, v130 quad_perm:[2,3,0,1] row_mask:0xf bank_mask:0xf
  v_cndmask_b32 v152, v124, v126, s[26:27]
  v_mfma_f32_16x16x32_bf16 v[232:235], a[148:151], v[176:179], 0
  v_cndmask_b32 v154, v130, v132, s[26:27]
  s_cmp_eq_u32 s78, 0
  s_cbranch_scc1 L_slow_17
  s_mov_b32 s93, 655360
  s_mov_b32 exec_lo, 0xff00ff
  s_mov_b32 exec_hi, 0xff00ff
  buffer_store_dwordx4 v[152:155], v65, s[44:47], s93 offen
  s_mov_b64 exec, -1
  s_nop 0
L_back_18:
  v_mfma_f32_16x16x32_bf16 v[228:231], a[152:155], v[176:179], 0
  ds_read_b128 v[12:15], v121 offset:17408
  v_lshrrev_b32 v75, 3, v1
  v_mul_u32_u24 v75, 11136, v75
  v_mfma_f32_16x16x32_bf16 v[224:227], a[156:159], v[176:179], 0
  ds_read_b128 v[136:139], v121 offset:21760
  s_mul_i32 s94, s77, 360448
  s_lshl2_add_u32 s95, s76, s79
  s_lshl_b32 s95, s95, 7
  s_add_u32 s94, s94, s95
  s_add_u32 s94, s94, 19660800
  v_add3_u32 v75, v75, v4, s94
  v_mfma_f32_16x16x32_bf16 v[236:239], a[160:163], v[184:187], v[236:239]
  s_waitcnt vmcnt(7)
  s_mov_b32 s94, 0
  buffer_load_dwordx4 v[196:199], v75, s[44:47], s94 offen sc1
  v_mfma_f32_16x16x32_bf16 v[232:235], a[164:167], v[184:187], v[232:235]
  s_mov_b32 s94, 90112
  buffer_load_dwordx4 v[168:171], v75, s[44:47], s94 offen sc1
  v_mfma_f32_16x16x32_bf16 v[228:231], a[168:171], v[184:187], v[228:231]
  s_mov_b32 s94, 180224
  buffer_load_dwordx4 v[192:195], v75, s[44:47], s94 offen sc1
  v_mfma_f32_16x16x32_bf16 v[224:227], a[172:175], v[184:187], v[224:227]
  s_mov_b32 s94, 270336
  buffer_load_dwordx4 v[172:175], v75, s[44:47], s94 offen sc1
  v_mfma_f32_16x16x32_bf16 v[236:239], a[176:179], v[180:183], v[236:239]
  s_waitcnt vmcnt(10)
  ds_read_b128 v[140:143], v121 offset:26112
  v_and_b32 v216, 1, v6
  v_mfma_f32_16x16x32_bf16 v[232:235], a[180:183], v[180:183], v[232:235]
  ds_read_b128 v[144:147], v121 offset:30464
  s_waitcnt lgkmcnt(3)
  v_add_f32 v28, v28, v12
  v_mfma_f32_16x16x32_bf16 v[228:231], a[184:187], v[180:183], v[228:231]
  v_add_f32 v29, v29, v13
  v_add_f32 v30, v30, v14
  v_mfma_f32_16x16x32_bf16 v[224:227], a[188:191], v[180:183], v[224:227]
  v_add_f32 v31, v31, v15
  s_waitcnt lgkmcnt(2)
  v_add_f32 v28, v28, v136
  v_mfma_f32_16x16x32_bf16 v[236:239], a[192:195], v[212:215], v[236:239]
  s_waitcnt vmcnt(9)
  v_add_f32 v29, v29, v137
  v_add_f32 v30, v30, v138
  v_mfma_f32_16x16x32_bf16 v[232:235], a[196:199], v[212:215], v[232:235]
  v_add_f32 v31, v31, v139
  ds_write_b128 v120, v[252:255] offset:34816
  v_mfma_f32_16x16x32_bf16 v[228:231], a[200:203], v[212:215], v[228:231]
  v_lshlrev_b32 v216, 6, v216
  v_mul_u32_u24 v217, 272, v5
  v_mfma_f32_16x16x32_bf16 v[224:227], a[204:207], v[212:215], v[224:227]
  v_add3_u32 v216, v216, v217, s98
  v_lshrrev_b32 v217, 1, v6
  v_mfma_f32_16x16x32_bf16 v[236:239], a[208:211], v[148:151], v[236:239]
  s_waitcnt vmcnt(8)
  v_lshl_add_u32 v216, v217, 2, v216
  v_lshl_add_u32 v217, v217, 2, v216
  v_mfma_f32_16x16x32_bf16 v[232:235], a[212:215], v[148:151], v[232:235]
  s_waitcnt lgkmcnt(2)
  v_add_f32 v28, v28, v140
  v_add_f32 v29, v29, v141
  v_mfma_f32_16x16x32_bf16 v[228:231], a[216:219], v[148:151], v[228:231]
  v_add_f32 v30, v30, v142
  v_add_f32 v31, v31, v143
  v_mfma_f32_16x16x32_bf16 v[224:227], a[220:223], v[148:151], v[224:227]
  s_waitcnt lgkmcnt(1)
  v_add_f32 v28, v28, v144
  v_add_f32 v29, v29, v145
  v_mfma_f32_16x16x32_bf16 v[236:239], a[224:227], v[208:211], v[236:239]
  s_waitcnt vmcnt(7)
  v_add_f32 v30, v30, v146
  v_add_f32 v31, v31, v147
  v_mfma_f32_16x16x32_bf16 v[232:235], a[228:231], v[208:211], v[232:235]
  v_add_f32 v127, v28, v29
  v_mul_f32 v133, v28, v28
  v_mfma_f32_16x16x32_bf16 v[228:231], a[232:235], v[208:211], v[228:231]
  v_add_f32 v127, v127, v30
  v_fmac_f32 v133, v29, v29
  v_mfma_f32_16x16x32_bf16 v[224:227], a[236:239], v[208:211], v[224:227]
  v_add_f32 v127, v127, v31
  v_fmac_f32 v133, v30, v30
  v_mfma_f32_16x16x32_bf16 v[236:239], a[240:243], v[156:159], v[236:239]
  s_waitcnt vmcnt(6)
  v_fmac_f32 v133, v31, v31
  ds_write_b128 v120, v[248:251] offset:34880
  v_mfma_f32_16x16x32_bf16 v[232:235], a[244:247], v[156:159], v[232:235]
  v_mfma_f32_16x16x32_bf16 v[228:231], a[248:251], v[156:159], v[228:231]
  v_mfma_f32_16x16x32_bf16 v[224:227], a[252:255], v[156:159], v[224:227]
  v_mfma_f32_16x16x32_bf16 v[236:239], v[76:79], v[204:207], v[236:239]
  s_waitcnt vmcnt(5)
  ds_write_b128 v120, v[244:247] offset:34944
  v_mfma_f32_16x16x32_bf16 v[232:235], v[80:83], v[204:207], v[232:235]
  v_mfma_f32_16x16x32_bf16 v[228:231], v[84:87], v[204:207], v[228:231]
  v_mfma_f32_16x16x32_bf16 v[224:227], v[88:91], v[204:207], v[224:227]
  v_mfma_f32_16x16x32_bf16 v[236:239], v[92:95], v[160:163], v[236:239]
  ds_write_b128 v120, v[240:243] offset:35008
  v_mfma_f32_16x16x32_bf16 v[232:235], v[96:99], v[160:163], v[232:235]
  v_mfma_f32_16x16x32_bf16 v[228:231], v[100:103], v[160:163], v[228:231]
  v_mfma_f32_16x16x32_bf16 v[224:227], v[104:107], v[160:163], v[224:227]
  s_mov_b32 s93, 655360
  buffer_load_dwordx4 v[136:139], v66, s[44:47], s93 offen sc1
  s_mov_b32 s93, 659456
  buffer_load_dwordx4 v[140:143], v66, s[44:47], s93 offen sc1
  s_mov_b32 s93, 663552
  buffer_load_dwordx4 v[144:147], v66, s[44:47], s93 offen sc1
  ds_write_b128 v122, v[236:239] offset:0
  ds_write_b128 v122, v[232:235] offset:64
  ds_write_b128 v122, v[228:231] offset:128
  ds_write_b128 v122, v[224:227] offset:192
  s_waitcnt lgkmcnt(0)
  s_barrier
  ds_read_b128 v[212:215], v121 offset:34816
  ds_read_b128 v[148:151], v121 offset:39168
  ds_read_b128 v[208:211], v121 offset:43520
  ds_read_b128 v[156:159], v121 offset:47872
  ds_read_b128 v[204:207], v123 offset:0
  ds_read_b128 v[160:163], v123 offset:4352
  ds_read_b128 v[200:203], v123 offset:8704
  ds_read_b128 v[164:167], v123 offset:13056
  s_waitcnt lgkmcnt(6)
  v_pk_add_f32 v[212:213], v[212:213], v[148:149]
  s_waitcnt lgkmcnt(4)
  v_pk_add_f32 v[208:209], v[208:209], v[156:157]
  v_pk_add_f32 v[32:33], v[32:33], v[212:213]
  v_pk_add_f32 v[32:33], v[32:33], v[208:209]
  v_pk_add_f32 v[214:215], v[214:215], v[150:151]
  v_pk_add_f32 v[210:211], v[210:211], v[158:159]
  v_pk_add_f32 v[34:35], v[34:35], v[214:215]
  v_pk_add_f32 v[34:35], v[34:35], v[210:211]
  v_pk_add_f32 v[252:253], v[32:33], v[34:35]
  v_pk_mul_f32 v[254:255], v[32:33], v[32:33]
  v_add_f32 v128, v252, v253
  v_pk_fma_f32 v[254:255], v[34:35], v[34:35], v[254:255]
  v_add_f32 v134, v254, v255
  s_waitcnt lgkmcnt(2)
  v_pk_add_f32 v[204:205], v[204:205], v[160:161]
  s_waitcnt lgkmcnt(0)
  v_pk_add_f32 v[200:201], v[200:201], v[164:165]
  v_pk_add_f32 v[36:37], v[36:37], v[204:205]
  v_pk_add_f32 v[36:37], v[36:37], v[200:201]
  v_pk_add_f32 v[206:207], v[206:207], v[162:163]
  v_pk_add_f32 v[202:203], v[202:203], v[166:167]
  v_pk_add_f32 v[38:39], v[38:39], v[206:207]
  v_pk_add_f32 v[38:39], v[38:39], v[202:203]
  v_pk_add_f32 v[252:253], v[36:37], v[38:39]
  v_pk_mul_f32 v[254:255], v[36:37], v[36:37]
  v_add_f32 v129, v252, v253
  v_pk_fma_f32 v[254:255], v[38:39], v[38:39], v[254:255]
  v_add_f32 v135, v254, v255
  v_add_u32 v153, 16, v2
  v_add_u32 v155, 16, v2
  v_add_f32_dpp v127, v127, v127 row_ror:8 row_mask:0xf bank_mask:0xf
  v_add_f32_dpp v128, v128, v128 row_ror:8 row_mask:0xf bank_mask:0xf
  v_add_f32_dpp v129, v129, v129 row_ror:8 row_mask:0xf bank_mask:0xf
  v_add_f32_dpp v133, v133, v133 row_ror:8 row_mask:0xf bank_mask:0xf
  v_add_f32_dpp v134, v134, v134 row_ror:8 row_mask:0xf bank_mask:0xf
  v_add_f32_dpp v135, v135, v135 row_ror:8 row_mask:0xf bank_mask:0xf
  v_add_f32_dpp v127, v127, v127 row_half_mirror row_mask:0xf bank_mask:0x5
  v_add_f32_dpp v129, v129, v129 row_half_mirror row_mask:0xf bank_mask:0xf
  v_add_f32_dpp v133, v133, v133 row_half_mirror row_mask:0xf bank_mask:0x5
  v_add_f32_dpp v135, v135, v135 row_half_mirror row_mask:0xf bank_mask:0xf
  v_add_f32_dpp v127, v128, v128 row_half_mirror row_mask:0xf bank_mask:0xa
  v_add_f32_dpp v133, v134, v134 row_half_mirror row_mask:0xf bank_mask:0xa
  v_add_f32_dpp v129, v129, v129 quad_perm:[1,0,3,2] row_mask:0xf bank_mask:0xf
  v_add_f32_dpp v135, v135, v135 quad_perm:[1,0,3,2] row_mask:0xf bank_mask:0xf
  v_add_f32_dpp v127, v127, v127 quad_perm:[1,0,3,2] row_mask:0xf bank_mask:0xf
  v_add_f32_dpp v133, v133, v133 quad_perm:[1,0,3,2] row_mask:0xf bank_mask:0xf
  v_add_f32_dpp v129, v129, v129 quad_perm:[2,3,0,1] row_mask:0xf bank_mask:0xf
  v_add_f32_dpp v135, v135, v135 quad_perm:[2,3,0,1] row_mask:0xf bank_mask:0xf
  v_add_f32_dpp v127, v127, v127 quad_perm:[2,3,0,1] row_mask:0xf bank_mask:0xf
  v_add_f32_dpp v133, v133, v133 quad_perm:[2,3,0,1] row_mask:0xf bank_mask:0xf
  v_cndmask_b32 v152, v127, v129, s[26:27]
  v_cndmask_b32 v154, v133, v135, s[26:27]
  s_cmp_eq_u32 s78, 0
  s_cbranch_scc1 L_slow_21
  s_mov_b32 s93, 655360
  s_mov_b32 exec_lo, 0xff00ff00
  s_mov_b32 exec_hi, 0xff00ff00
  buffer_store_dwordx4 v[152:155], v65, s[44:47], s93 offen
  s_mov_b64 exec, -1
  s_nop 0
L_back_22:
  s_mul_i32 s8, s76, 36
  s_add_u32 s8, s8, s77
  s_mul_i32 s8, s8, 6144
  s_add_u32 s8, s8, 7077888
  s_lshl_b32 s10, s76, 8
  s_add_u32 s10, s10, 27648
  s_lshl2_add_u32 s9, s99, s10
  s_add_u32 s11, s9, 11264
  v_add_u32 v152, 16, v2
  v_cmp_gt_u32 vcc, 9, v5
  s_nop 1
  v_cndmask_b32 v152, 0, v152, vcc
  s_mov_b32 s83, 300000
  s_waitcnt vmcnt(4)
L_pollc_20:
  v_bitop3_b32 v218, v199, v171, v2 bitop3:0x7e
  v_bitop3_b32 v219, v195, v175, v2 bitop3:0x7e
  v_or_b32 v218, v218, v219
  v_cmp_ne_u32 vcc, 0, v218
  s_sub_u32 s83, s83, 1
  s_cselect_b64 vcc, 0, vcc
  s_cmp_lg_u64 vcc, 0
  s_cbranch_scc1 L_poll_19
  v_lshlrev_b32 v75, 4, v6
  v_add3_u32 v75, v75, v4, s98
  ds_write_b128 v75, v[196:199] offset:0
  ds_write_b128 v75, v[168:171] offset:1088
  ds_write_b128 v75, v[192:195] offset:2176
  ds_write_b128 v75, v[172:175] offset:3264
  ds_read2_b32 v[108:109], v216 offset0:0 offset1:32
  ds_read2_b32 v[110:111], v217 offset0:2 offset1:34
  ds_read2_b32 v[112:113], v216 offset0:5 offset1:37
  ds_read2_b32 v[114:115], v216 offset0:8 offset1:40
  ds_read2_b32 v[116:117], v217 offset0:10 offset1:42
  ds_read2_b32 v[118:119], v216 offset0:13 offset1:45
  s_waitcnt lgkmcnt(5)
  v_lshlrev_b32 v168, 16, v108
  v_and_b32 v169, 0xffff0000, v108
  v_lshlrev_b32 v170, 16, v109
  v_and_b32 v171, 0xffff0000, v109
  s_waitcnt lgkmcnt(4)
  v_lshlrev_b32 v172, 16, v110
  v_and_b32 v173, 0xffff0000, v110
  v_lshlrev_b32 v174, 16, v111
  v_and_b32 v175, 0xffff0000, v111
  s_waitcnt lgkmcnt(3)
  v_lshlrev_b32 v176, 16, v112
  v_and_b32 v177, 0xffff0000, v112
  v_lshlrev_b32 v178, 16, v113
  v_and_b32 v179, 0xffff0000, v113
  s_mov_b32 s83, 300000
  s_waitcnt vmcnt(1)
L_pollc_24:
  v_bitop3_b32 v153, v137, v139, v152 bitop3:0x7e
  v_bitop3_b32 v154, v141, v143, v152 bitop3:0x7e
  v_or_b32 v153, v153, v154
  v_bitop3_b32 v154, v145, v147, v152 bitop3:0x7e
  v_or_b32 v153, v153, v154
  v_cmp_ne_u32 vcc, 0, v153
  s_sub_u32 s83, s83, 1
  s_cselect_b64 vcc, 0, vcc
  s_cmp_lg_u64 vcc, 0
  s_cbranch_scc1 L_poll_23
  v_add_f32_dpp v136, v136, v136 row_ror:8 row_mask:0xf bank_mask:0xf
  v_add_f32_dpp v140, v140, v140 row_ror:8 row_mask:0xf bank_mask:0xf
  v_add_f32_dpp v144, v144, v144 row_ror:8 row_mask:0xf bank_mask:0xf
  v_add_f32_dpp v138, v138, v138 row_ror:8 row_mask:0xf bank_mask:0xf
  v_add_f32_dpp v142, v142, v142 row_ror:8 row_mask:0xf bank_mask:0xf
  v_add_f32_dpp v146, v146, v146 row_ror:8 row_mask:0xf bank_mask:0xf
  v_add_f32_dpp v136, v136, v136 row_half_mirror row_mask:0xf bank_mask:0x5
  v_add_f32_dpp v144, v144, v144 row_half_mirror row_mask:0xf bank_mask:0xf
  v_add_f32_dpp v138, v138, v138 row_half_mirror row_mask:0xf bank_mask:0x5
  v_add_f32_dpp v146, v146, v146 row_half_mirror row_mask:0xf bank_mask:0xf
  v_add_f32_dpp v136, v140, v140 row_half_mirror row_mask:0xf bank_mask:0xa
  v_add_f32_dpp v138, v142, v142 row_half_mirror row_mask:0xf bank_mask:0xa
  v_add_f32_dpp v144, v144, v144 quad_perm:[1,0,3,2] row_mask:0xf bank_mask:0xf
  v_add_f32_dpp v146, v146, v146 quad_perm:[1,0,3,2] row_mask:0xf bank_mask:0xf
  v_add_f32_dpp v136, v136, v136 quad_perm:[1,0,3,2] row_mask:0xf bank_mask:0xf
  v_add_f32_dpp v138, v138, v138 quad_perm:[1,0,3,2] row_mask:0xf bank_mask:0xf
  v_add_f32_dpp v144, v144, v144 quad_perm:[2,3,0,1] row_mask:0xf bank_mask:0xf
  v_add_f32_dpp v146, v146, v146 quad_perm:[2,3,0,1] row_mask:0xf bank_mask:0xf
  v_add_f32_dpp v136, v136, v136 quad_perm:[2,3,0,1] row_mask:0xf bank_mask:0xf
  v_add_f32_dpp v138, v138, v138 quad_perm:[2,3,0,1] row_mask:0xf bank_mask:0xf
  v_mul_f32 v180, 0x3ae38e39, v136
  v_mul_f32 v181, 0x3ae38e39, v138
  v_mul_f32 v182, 0x3ae38e39, v144
  v_mul_f32 v183, 0x3ae38e39, v146
  v_fma_f32 v181, -v180, v180, v181
  v_fma_f32 v183, -v182, v182, v183
  v_max_f32 v181, 0, v181
  v_max_f32 v183, 0, v183
  v_add_f32 v181, 0x3727c5ac, v181
  v_add_f32 v183, 0x3727c5ac, v183
  v_rsq_f32 v181, v181
  v_rsq_f32 v183, v183
  v_add_f32_dpp v62, v180, v62 quad_perm:[0,1,2,3] row_mask:0xf bank_mask:0x3
  v_add_f32_dpp v63, v182, v63 quad_perm:[0,1,2,3] row_mask:0xf bank_mask:0x3
  s_mov_b32 s93, 667648
  buffer_load_dwordx4 v[156:159], v66, s[44:47], s93 offen sc1
  s_mov_b32 s93, 671744
  buffer_load_dwordx4 v[160:163], v66, s[44:47], s93 offen sc1
  s_mov_b32 s93, 675840
  buffer_load_dwordx4 v[164:167], v66, s[44:47], s93 offen sc1
  v_mov_b64_dpp v[136:137], v[180:181] row_newbcast:0 row_mask:0xf bank_mask:0xf
  v_mov_b64_dpp v[140:141], v[180:181] row_newbcast:4 row_mask:0xf bank_mask:0xf
  v_mov_b64_dpp v[144:145], v[182:183] row_newbcast:0 row_mask:0xf bank_mask:0xf
  v_pk_add_f32 v[16:17], v[16:17], v[136:137] op_sel:[0,0] op_sel_hi:[1,0] neg_lo:[0,1] neg_hi:[0,1]
  v_pk_fma_f32 v[168:169], v[168:169], v[136:137], 1.0 op_sel:[0,1,0] op_sel_hi:[1,1,0]
  v_pk_add_f32 v[18:19], v[18:19], v[136:137] op_sel:[0,0] op_sel_hi:[1,0] neg_lo:[0,1] neg_hi:[0,1]
  v_pk_fma_f32 v[170:171], v[170:171], v[136:137], 1.0 op_sel:[0,1,0] op_sel_hi:[1,1,0]
  v_pk_mul_f32 v[16:17], v[16:17], v[168:169]
  v_pk_mul_f32 v[18:19], v[18:19], v[170:171]
  v_pk_add_f32 v[20:21], v[20:21], v[140:141] op_sel:[0,0] op_sel_hi:[1,0] neg_lo:[0,1] neg_hi:[0,1]
  v_pk_fma_f32 v[172:173], v[172:173], v[140:141], 1.0 op_sel:[0,1,0] op_sel_hi:[1,1,0]
  v_pk_add_f32 v[22:23], v[22:23], v[140:141] op_sel:[0,0] op_sel_hi:[1,0] neg_lo:[0,1] neg_hi:[0,1]
  v_pk_fma_f32 v[174:175], v[174:175], v[140:141], 1.0 op_sel:[0,1,0] op_sel_hi:[1,1,0]
  v_pk_mul_f32 v[20:21], v[20:21], v[172:173]
  v_pk_mul_f32 v[22:23], v[22:23], v[174:175]
  v_pk_add_f32 v[24:25], v[24:25], v[144:145] op_sel:[0,0] op_sel_hi:[1,0] neg_lo:[0,1] neg_hi:[0,1]
  v_pk_fma_f32 v[176:177], v[176:177], v[144:145], 1.0 op_sel:[0,1,0] op_sel_hi:[1,1,0]
  v_pk_add_f32 v[26:27], v[26:27], v[144:145] op_sel:[0,0] op_sel_hi:[1,0] neg_lo:[0,1] neg_hi:[0,1]
  v_pk_fma_f32 v[178:179], v[178:179], v[144:145], 1.0 op_sel:[0,1,0] op_sel_hi:[1,1,0]
  v_pk_mul_f32 v[24:25], v[24:25], v[176:177]
  v_pk_mul_f32 v[26:27], v[26:27], v[178:179]
  v_cvt_pk_bf16_f32 v168, v16, v17
  v_cvt_pk_bf16_f32 v169, v18, v19
  v_cvt_pk_bf16_f32 v170, v20, v21
  v_cvt_pk_bf16_f32 v171, v22, v23
  v_cvt_pk_bf16_f32 v172, v24, v25
  v_cvt_pk_bf16_f32 v173, v26, v27
  s_cmp_eq_u32 s78, 0
  s_cbranch_scc1 L_slow_25
  s_add_u32 s93, s8, 0
  s_add_u32 s94, s93, 4096
  buffer_store_dwordx2 v[168:169], v74, s[44:47], s93 offen offset:0
  buffer_store_dwordx2 v[170:171], v74, s[44:47], s93 offen offset:2048
  buffer_store_dwordx2 v[172:173], v74, s[44:47], s94 offen offset:0
L_back_26:
  s_waitcnt lgkmcnt(2)
  v_lshlrev_b32 v136, 16, v114
  v_and_b32 v137, 0xffff0000, v114
  v_lshlrev_b32 v138, 16, v115
  v_and_b32 v139, 0xffff0000, v115
  s_waitcnt lgkmcnt(1)
  v_lshlrev_b32 v140, 16, v116
  v_and_b32 v141, 0xffff0000, v116
  v_lshlrev_b32 v142, 16, v117
  v_and_b32 v143, 0xffff0000, v117
  s_waitcnt lgkmcnt(0)
  v_lshlrev_b32 v144, 16, v118
  v_and_b32 v145, 0xffff0000, v118
  v_lshlrev_b32 v146, 16, v119
  v_and_b32 v147, 0xffff0000, v119
  v_lshl_add_u32 v12, v1, 2, s10
  v_cmp_gt_u32 vcc, 36, v1
  s_nop 1
  v_cndmask_b32 v12, v7, v12, vcc
  v_cndmask_b32 v13, 0, v2, vcc
  s_mov_b32 s12, 11264
  v_pk_add_f32 v[148:149], v[16:17], v[18:19]
  v_pk_mul_f32 v[150:151], v[16:17], v[16:17]
  v_add_f32 v124, v148, v149
  v_pk_fma_f32 v[150:151], v[18:19], v[18:19], v[150:151]
  v_add_f32 v130, v150, v151
  v_pk_add_f32 v[148:149], v[20:21], v[22:23]
  v_pk_mul_f32 v[150:151], v[20:21], v[20:21]
  v_add_f32 v125, v148, v149
  v_pk_fma_f32 v[150:151], v[22:23], v[22:23], v[150:151]
  v_add_f32 v131, v150, v151
  v_pk_add_f32 v[148:149], v[24:25], v[26:27]
  v_pk_mul_f32 v[150:151], v[24:25], v[24:25]
  v_add_f32 v126, v148, v149
  v_pk_fma_f32 v[150:151], v[26:27], v[26:27], v[150:151]
  v_add_f32 v132, v150, v151
  s_waitcnt vmcnt(0)
  s_cmp_eq_u32 s78, 0
  s_cbranch_scc1 L_slow_27
  s_mov_b64 exec, 1
  buffer_store_dword v2, v10, s[44:47], s9 offen
  s_mov_b64 exec, -1
L_back_28:
  s_mov_b32 s83, 300000
L_pollc_30:
  v_bitop3_b32 v153, v157, v159, v152 bitop3:0x7e
  v_bitop3_b32 v154, v161, v163, v152 bitop3:0x7e
  v_or_b32 v153, v153, v154
  v_bitop3_b32 v154, v165, v167, v152 bitop3:0x7e
  v_or_b32 v153, v153, v154
  v_cmp_ne_u32 vcc, 0, v153
  s_sub_u32 s83, s83, 1
  s_cselect_b64 vcc, 0, vcc
  s_cmp_lg_u64 vcc, 0
  s_cbranch_scc1 L_poll_29
  v_add_f32_dpp v156, v156, v156 row_ror:8 row_mask:0xf bank_mask:0xf
  v_add_f32_dpp v160, v160, v160 row_ror:8 row_mask:0xf bank_mask:0xf
  v_add_f32_dpp v164, v164, v164 row_ror:8 row_mask:0xf bank_mask:0xf
  v_add_f32_dpp v158, v158, v158 row_ror:8 row_mask:0xf bank_mask:0xf
  v_add_f32_dpp v162, v162, v162 row_ror:8 row_mask:0xf bank_mask:0xf
  v_add_f32_dpp v166, v166, v166 row_ror:8 row_mask:0xf bank_mask:0xf
  v_add_f32_dpp v156, v156, v156 row_half_mirror row_mask:0xf bank_mask:0x5
  v_add_f32_dpp v164, v164, v164 row_half_mirror row_mask:0xf bank_mask:0xf
  v_add_f32_dpp v158, v158, v158 row_half_mirror row_mask:0xf bank_mask:0x5
  v_add_f32_dpp v166, v166, v166 row_half_mirror row_mask:0xf bank_mask:0xf
  v_add_f32_dpp v156, v160, v160 row_half_mirror row_mask:0xf bank_mask:0xa
  v_add_f32_dpp v158, v162, v162 row_half_mirror row_mask:0xf bank_mask:0xa
  v_add_f32_dpp v164, v164, v164 quad_perm:[1,0,3,2] row_mask:0xf bank_mask:0xf
  v_add_f32_dpp v166, v166, v166 quad_perm:[1,0,3,2] row_mask:0xf bank_mask:0xf
  v_add_f32_dpp v156, v156, v156 quad_perm:[1,0,3,2] row_mask:0xf bank_mask:0xf
  v_add_f32_dpp v158, v158, v158 quad_perm:[1,0,3,2] row_mask:0xf bank_mask:0xf
  v_add_f32_dpp v164, v164, v164 quad_perm:[2,3,0,1] row_mask:0xf bank_mask:0xf
  v_add_f32_dpp v166, v166, v166 quad_perm:[2,3,0,1] row_mask:0xf bank_mask:0xf
  v_add_f32_dpp v156, v156, v156 quad_perm:[2,3,0,1] row_mask:0xf bank_mask:0xf
  v_add_f32_dpp v158, v158, v158 quad_perm:[2,3,0,1] row_mask:0xf bank_mask:0xf
  v_mul_f32 v168, 0x3ae38e39, v156
  v_mul_f32 v169, 0x3ae38e39, v158
  v_mul_f32 v170, 0x3ae38e39, v164
  v_mul_f32 v171, 0x3ae38e39, v166
  v_fma_f32 v169, -v168, v168, v169
  v_fma_f32 v171, -v170, v170, v171
  v_max_f32 v169, 0, v169
  v_max_f32 v171, 0, v171
  v_add_f32 v169, 0x3727c5ac, v169
  v_add_f32 v171, 0x3727c5ac, v171
  v_rsq_f32 v169, v169
  v_rsq_f32 v171, v171
  v_add_f32_dpp v62, v168, v62 quad_perm:[0,1,2,3] row_mask:0xf bank_mask:0xc
  v_add_f32_dpp v63, v170, v63 quad_perm:[0,1,2,3] row_mask:0xf bank_mask:0xc
  v_mov_b64_dpp v[156:157], v[168:169] row_newbcast:8 row_mask:0xf bank_mask:0xf
  v_mov_b64_dpp v[160:161], v[168:169] row_newbcast:12 row_mask:0xf bank_mask:0xf
  v_mov_b64_dpp v[164:165], v[170:171] row_newbcast:8 row_mask:0xf bank_mask:0xf
  v_pk_add_f32 v[28:29], v[28:29], v[156:157] op_sel:[0,0] op_sel_hi:[1,0] neg_lo:[0,1] neg_hi:[0,1]
  v_pk_fma_f32 v[136:137], v[136:137], v[156:157], 1.0 op_sel:[0,1,0] op_sel_hi:[1,1,0]
  v_pk_add_f32 v[30:31], v[30:31], v[156:157] op_sel:[0,0] op_sel_hi:[1,0] neg_lo:[0,1] neg_hi:[0,1]
  v_pk_fma_f32 v[138:139], v[138:139], v[156:157], 1.0 op_sel:[0,1,0] op_sel_hi:[1,1,0]
  v_pk_mul_f32 v[28:29], v[28:29], v[136:137]
  v_pk_mul_f32 v[30:31], v[30:31], v[138:139]
  v_pk_add_f32 v[32:33], v[32:33], v[160:161] op_sel:[0,0] op_sel_hi:[1,0] neg_lo:[0,1] neg_hi:[0,1]
  v_pk_fma_f32 v[140:141], v[140:141], v[160:161], 1.0 op_sel:[0,1,0] op_sel_hi:[1,1,0]
  v_pk_add_f32 v[34:35], v[34:35], v[160:161] op_sel:[0,0] op_sel_hi:[1,0] neg_lo:[0,1] neg_hi:[0,1]
  v_pk_fma_f32 v[142:143], v[142:143], v[160:161], 1.0 op_sel:[0,1,0] op_sel_hi:[1,1,0]
  v_pk_mul_f32 v[32:33], v[32:33], v[140:141]
  v_pk_mul_f32 v[34:35], v[34:35], v[142:143]
  v_pk_add_f32 v[36:37], v[36:37], v[164:165] op_sel:[0,0] op_sel_hi:[1,0] neg_lo:[0,1] neg_hi:[0,1]
  v_pk_fma_f32 v[144:145], v[144:145], v[164:165], 1.0 op_sel:[0,1,0] op_sel_hi:[1,1,0]
  v_pk_add_f32 v[38:39], v[38:39], v[164:165] op_sel:[0,0] op_sel_hi:[1,0] neg_lo:[0,1] neg_hi:[0,1]
  v_pk_fma_f32 v[146:147], v[146:147], v[164:165], 1.0 op_sel:[0,1,0] op_sel_hi:[1,1,0]
  v_pk_mul_f32 v[36:37], v[36:37], v[144:145]
  v_pk_mul_f32 v[38:39], v[38:39], v[146:147]
  v_cvt_pk_bf16_f32 v136, v28, v29
  v_cvt_pk_bf16_f32 v137, v30, v31
  v_cvt_pk_bf16_f32 v138, v32, v33
  v_cvt_pk_bf16_f32 v139, v34, v35
  v_cvt_pk_bf16_f32 v140, v36, v37
  v_cvt_pk_bf16_f32 v141, v38, v39
  s_cmp_eq_u32 s78, 0
  s_cbranch_scc1 L_slow_31
  s_add_u32 s93, s8, 55296
  s_add_u32 s94, s93, 4096
  buffer_store_dwordx2 v[136:137], v74, s[44:47], s93 offen offset:0
  buffer_store_dwordx2 v[138:139], v74, s[44:47], s93 offen offset:2048
  buffer_store_dwordx2 v[140:141], v74, s[44:47], s94 offen offset:0
L_back_32:
  buffer_load_dword v14, v12, s[44:47], 0 offen sc1
  v_pk_add_f32 v[136:137], v[28:29], v[30:31]
  v_pk_mul_f32 v[138:139], v[28:29], v[28:29]
  v_add_f32 v127, v136, v137
  v_pk_fma_f32 v[138:139], v[30:31], v[30:31], v[138:139]
  v_add_f32 v133, v138, v139
  v_pk_add_f32 v[136:137], v[32:33], v[34:35]
  v_pk_mul_f32 v[138:139], v[32:33], v[32:33]
  v_add_f32 v128, v136, v137
  v_pk_fma_f32 v[138:139], v[34:35], v[34:35], v[138:139]
  v_add_f32 v134, v138, v139
  v_pk_add_f32 v[136:137], v[36:37], v[38:39]
  v_pk_mul_f32 v[138:139], v[36:37], v[36:37]
  v_add_f32 v129, v136, v137
  v_pk_fma_f32 v[138:139], v[38:39], v[38:39], v[138:139]
  v_add_f32 v135, v138, v139
  v_add_u32 v137, 32, v2
  v_add_u32 v139, 32, v2
  v_add_f32_dpp v124, v124, v124 row_ror:8 row_mask:0xf bank_mask:0x3
  v_add_f32_dpp v125, v125, v125 row_ror:8 row_mask:0xf bank_mask:0x3
  v_add_f32_dpp v126, v126, v126 row_ror:8 row_mask:0xf bank_mask:0x3
  v_add_f32_dpp v130, v130, v130 row_ror:8 row_mask:0xf bank_mask:0x3
  v_add_f32_dpp v131, v131, v131 row_ror:8 row_mask:0xf bank_mask:0x3
  v_add_f32_dpp v132, v132, v132 row_ror:8 row_mask:0xf bank_mask:0x3
  v_add_f32_dpp v124, v127, v127 row_ror:8 row_mask:0xf bank_mask:0xc
  v_add_f32_dpp v125, v128, v128 row_ror:8 row_mask:0xf bank_mask:0xc
  v_add_f32_dpp v126, v129, v129 row_ror:8 row_mask:0xf bank_mask:0xc
  v_add_f32_dpp v130, v133, v133 row_ror:8 row_mask:0xf bank_mask:0xc
  v_add_f32_dpp v131, v134, v134 row_ror:8 row_mask:0xf bank_mask:0xc
  v_add_f32_dpp v132, v135, v135 row_ror:8 row_mask:0xf bank_mask:0xc
  v_add_f32_dpp v124, v124, v124 row_half_mirror row_mask:0xf bank_mask:0x5
  v_add_f32_dpp v126, v126, v126 row_half_mirror row_mask:0xf bank_mask:0xf
  v_add_f32_dpp v130, v130, v130 row_half_mirror row_mask:0xf bank_mask:0x5
  v_add_f32_dpp v132, v132, v132 row_half_mirror row_mask:0xf bank_mask:0xf
  v_add_f32_dpp v124, v125, v125 row_half_mirror row_mask:0xf bank_mask:0xa
  v_add_f32_dpp v130, v131, v131 row_half_mirror row_mask:0xf bank_mask:0xa
  v_add_f32_dpp v126, v126, v126 quad_perm:[1,0,3,2] row_mask:0xf bank_mask:0xf
  v_add_f32_dpp v132, v132, v132 quad_perm:[1,0,3,2] row_mask:0xf bank_mask:0xf
  v_add_f32_dpp v124, v124, v124 quad_perm:[1,0,3,2] row_mask:0xf bank_mask:0xf
  v_add_f32_dpp v130, v130, v130 quad_perm:[1,0,3,2] row_mask:0xf bank_mask:0xf
  v_add_f32_dpp v126, v126, v126 quad_perm:[2,3,0,1] row_mask:0xf bank_mask:0xf
  v_add_f32_dpp v132, v132, v132 quad_perm:[2,3,0,1] row_mask:0xf bank_mask:0xf
  v_add_f32_dpp v124, v124, v124 quad_perm:[2,3,0,1] row_mask:0xf bank_mask:0xf
  v_add_f32_dpp v130, v130, v130 quad_perm:[2,3,0,1] row_mask:0xf bank_mask:0xf
  v_cndmask_b32 v136, v124, v126, s[26:27]
  v_cndmask_b32 v138, v130, v132, s[26:27]
  s_cmp_eq_u32 s78, 0
  s_cbranch_scc1 L_slow_33
  s_mov_b32 s93, 1196032
  buffer_store_dwordx4 v[136:139], v65, s[44:47], s93 offen
  s_nop 1
L_back_34:
  s_mul_i32 s93, s76, 221184
  s_add_u32 s93, s93, 7077888
  s_add_u32 s93, s93, s97
  v_add_u32 v75, s93, v4
  s_waitcnt vmcnt(2)
  s_cmp_eq_u32 s78, 0
  s_cbranch_scc1 L_slow_35
  s_mov_b64 exec, 1
  buffer_store_dword v2, v10, s[44:47], s11 offen
  s_mov_b64 exec, -1
L_back_36:
  s_mov_b32 s83, 300000
  s_waitcnt vmcnt(2)
L_pollc_38:
  v_cmp_ne_u32 vcc, v14, v13
  s_sub_u32 s83, s83, 1
  s_cselect_b64 vcc, 0, vcc
  s_cmp_lg_u64 vcc, 0
  s_cbranch_scc1 L_poll_37
  s_add_u32 m0, s97, 0
  s_mov_b32 s13, 0
  buffer_load_dwordx4 v75, s[44:47], s13 offen sc1 lds
  s_add_u32 m0, s97, 4096
  s_mov_b32 s13, 4096
  buffer_load_dwordx4 v75, s[44:47], s13 offen sc1 lds
  s_add_u32 m0, s97, 8192
  s_mov_b32 s13, 8192
  buffer_load_dwordx4 v75, s[44:47], s13 offen sc1 lds
  s_add_u32 m0, s97, 12288
  s_mov_b32 s13, 12288
  buffer_load_dwordx4 v75, s[44:47], s13 offen sc1 lds
  s_add_u32 m0, s97, 16384
  s_mov_b32 s13, 16384
  buffer_load_dwordx4 v75, s[44:47], s13 offen sc1 lds
  s_add_u32 m0, s97, 20480
  s_mov_b32 s13, 20480
  buffer_load_dwordx4 v75, s[44:47], s13 offen sc1 lds
  s_waitcnt vmcnt(3)
  s_barrier
  ds_read_b128 v[160:163], v44 offset:0
  s_add_u32 m0, s97, 24576
  s_mov_b32 s13, 24576
  buffer_load_dwordx4 v75, s[44:47], s13 offen sc1 lds
  ds_read_b128 v[164:167], v44 offset:2048
  s_add_u32 m0, s97, 28672
  v_add_u32 v148, 32, v2
  v_cmp_gt_u32 vcc, 9, v5
  s_nop 1
  v_cndmask_b32 v148, 0, v148, vcc
  ds_read_b128 v[168:171], v44 offset:4096
  ds_read_b128 v[172:175], v45 offset:0
  s_mov_b32 s13, 28672
  buffer_load_dwordx4 v75, s[44:47], s13 offen sc1 lds
  ds_read_b128 v[176:179], v45 offset:2048
  s_add_u32 m0, s97, 32768
  ds_read_b128 v[180:183], v45 offset:4096
  s_waitcnt lgkmcnt(3)
  v_mfma_f32_16x16x32_bf16 v[208:211], v[160:163], a[0:3], 0
  s_mov_b32 s13, 32768
  buffer_load_dwordx4 v75, s[44:47], s13 offen sc1 lds
  v_mfma_f32_16x16x32_bf16 v[232:235], v[160:163], a[4:7], 0
  ds_read_b128 v[184:187], v44 offset:6144
  v_mfma_f32_16x16x32_bf16 v[212:215], v[164:167], a[0:3], 0
  ds_read_b128 v[188:191], v44 offset:8192
  v_mfma_f32_16x16x32_bf16 v[236:239], v[164:167], a[4:7], 0
  buffer_load_dword v15, v12, s[44:47], s12 offen sc1
  v_mfma_f32_16x16x32_bf16 v[216:219], v[168:171], a[0:3], 0
  ds_read_b128 v[192:195], v44 offset:10240
  s_add_u32 m0, s97, 36864
  v_mfma_f32_16x16x32_bf16 v[240:243], v[168:171], a[4:7], 0
  s_waitcnt lgkmcnt(3)
  ds_read_b128 v[196:199], v45 offset:6144
  v_mfma_f32_16x16x32_bf16 v[208:211], v[172:175], a[8:11], v[208:211]
  s_mov_b32 s13, 36864
  buffer_load_dwordx4 v75, s[44:47], s13 offen sc1 lds
  v_mfma_f32_16x16x32_bf16 v[232:235], v[172:175], a[12:15], v[232:235]
  ds_read_b128 v[200:203], v45 offset:8192
  s_add_u32 m0, s97, 40960
  v_mfma_f32_16x16x32_bf16 v[212:215], v[176:179], a[8:11], v[212:215]
  ds_read_b128 v[204:207], v45 offset:10240
  v_mfma_f32_16x16x32_bf16 v[236:239], v[176:179], a[12:15], v[236:239]
  s_mov_b32 s13, 40960
  buffer_load_dwordx4 v75, s[44:47], s13 offen sc1 lds
  v_mfma_f32_16x16x32_bf16 v[216:219], v[180:183], a[8:11], v[216:219]
  s_add_u32 m0, s97, 45056
  v_mfma_f32_16x16x32_bf16 v[240:243], v[180:183], a[12:15], v[240:243]
  s_waitcnt vmcnt(6)
  s_barrier
  ds_read_b128 v[160:163], v44 offset:12288
  s_mov_b32 s13, 45056
  buffer_load_dwordx4 v75, s[44:47], s13 offen sc1 lds
  s_waitcnt lgkmcnt(4)
  v_mfma_f32_16x16x32_bf16 v[208:211], v[184:187], a[16:19], v[208:211]
  ds_read_b128 v[164:167], v44 offset:14336
  s_add_u32 m0, s97, 49152
  v_mfma_f32_16x16x32_bf16 v[232:235], v[184:187], a[20:23], v[232:235]
  ds_read_b128 v[168:171], v44 offset:16384
  v_mfma_f32_16x16x32_bf16 v[212:215], v[188:191], a[16:19], v[212:215]
  s_mov_b32 s13, 49152
  buffer_load_dwordx4 v75, s[44:47], s13 offen sc1 lds
  v_mfma_f32_16x16x32_bf16 v[236:239], v[188:191], a[20:23], v[236:239]
  s_add_u32 m0, s97, 53248
  v_mfma_f32_16x16x32_bf16 v[216:219], v[192:195], a[16:19], v[216:219]
  v_mfma_f32_16x16x32_bf16 v[240:243], v[192:195], a[20:23], v[240:243]
  s_waitcnt lgkmcnt(3)
  s_mov_b32 s13, 53248
  buffer_load_dwordx4 v75, s[44:47], s13 offen sc1 lds
  v_mfma_f32_16x16x32_bf16 v[208:211], v[196:199], a[24:27], v[208:211]
  ds_read_b128 v[172:175], v45 offset:12288
  v_mfma_f32_16x16x32_bf16 v[232:235], v[196:199], a[28:31], v[232:235]
  ds_read_b128 v[176:179], v45 offset:14336
  v_mfma_f32_16x16x32_bf16 v[212:215], v[200:203], a[24:27], v[212:215]
  s_mov_b32 s93, 1196032
  buffer_load_dwordx4 v[124:127], v66, s[44:47], s93 offen sc1
  v_mfma_f32_16x16x32_bf16 v[236:239], v[200:203], a[28:31], v[236:239]
  ds_read_b128 v[180:183], v45 offset:16384
  v_mfma_f32_16x16x32_bf16 v[216:219], v[204:207], a[24:27], v[216:219]
  v_mfma_f32_16x16x32_bf16 v[240:243], v[204:207], a[28:31], v[240:243]
  s_waitcnt lgkmcnt(3)
  s_mov_b32 s93, 1200128
  buffer_load_dwordx4 v[128:131], v66, s[44:47], s93 offen sc1
  v_mfma_f32_16x16x32_bf16 v[208:211], v[160:163], a[32:35], v[208:211]
  ds_read_b128 v[184:187], v44 offset:18432
  v_mfma_f32_16x16x32_bf16 v[232:235], v[160:163], a[36:39], v[232:235]
  ds_read_b128 v[188:191], v44 offset:20480
  v_mfma_f32_16x16x32_bf16 v[212:215], v[164:167], a[32:35], v[212:215]
  s_mov_b32 s93, 1204224
  buffer_load_dwordx4 v[132:135], v66, s[44:47], s93 offen sc1
  v_mfma_f32_16x16x32_bf16 v[236:239], v[164:167], a[36:39], v[236:239]
  ds_read_b128 v[192:195], v44 offset:22528
  v_mfma_f32_16x16x32_bf16 v[216:219], v[168:171], a[32:35], v[216:219]
  v_mfma_f32_16x16x32_bf16 v[240:243], v[168:171], a[36:39], v[240:243]
  s_waitcnt lgkmcnt(3)
  s_mov_b32 s93, 1208320
  buffer_load_dwordx4 v[136:139], v66, s[44:47], s93 offen sc1
  v_mfma_f32_16x16x32_bf16 v[208:211], v[172:175], a[40:43], v[208:211]
  ds_read_b128 v[196:199], v45 offset:18432
  v_mfma_f32_16x16x32_bf16 v[232:235], v[172:175], a[44:47], v[232:235]
  ds_read_b128 v[200:203], v45 offset:20480
  v_mfma_f32_16x16x32_bf16 v[212:215], v[176:179], a[40:43], v[212:215]
  s_mov_b32 s93, 1212416
  buffer_load_dwordx4 v[140:143], v66, s[44:47], s93 offen sc1
  v_mfma_f32_16x16x32_bf16 v[236:239], v[176:179], a[44:47], v[236:239]
  ds_read_b128 v[204:207], v45 offset:22528
  v_mfma_f32_16x16x32_bf16 v[216:219], v[180:183], a[40:43], v[216:219]
  v_mfma_f32_16x16x32_bf16 v[240:243], v[180:183], a[44:47], v[240:243]
  s_waitcnt vmcnt(5)
  s_barrier
  s_waitcnt lgkmcnt(3)
  v_mfma_f32_16x16x32_bf16 v[208:211], v[184:187], a[48:51], v[208:211]
  s_mov_b32 s93, 1216512
  buffer_load_dwordx4 v[144:147], v66, s[44:47], s93 offen sc1
  v_mfma_f32_16x16x32_bf16 v[232:235], v[184:187], a[52:55], v[232:235]
  ds_read_b128 v[160:163], v44 offset:24576
  s_mov_b32 s83, 300000
L_pollc_40:
  v_cmp_ne_u32 vcc, v15, v13
  s_sub_u32 s83, s83, 1
  s_cselect_b64 vcc, 0, vcc
  s_cmp_lg_u64 vcc, 0
  s_cbranch_scc1 L_poll_39
  v_mfma_f32_16x16x32_bf16 v[212:215], v[188:191], a[48:51], v[212:215]
  ds_read_b128 v[164:167], v44 offset:26624
  s_add_u32 m0, s97, 55296
  s_mov_b32 s13, 55296
  buffer_load_dwordx4 v75, s[44:47], s13 offen sc1 lds
  v_mfma_f32_16x16x32_bf16 v[236:239], v[188:191], a[52:55], v[236:239]
  ds_read_b128 v[168:171], v44 offset:28672
  s_add_u32 m0, s97, 59392
  v_mfma_f32_16x16x32_bf16 v[216:219], v[192:195], a[48:51], v[216:219]
  v_mfma_f32_16x16x32_bf16 v[240:243], v[192:195], a[52:55], v[240:243]
  s_waitcnt lgkmcnt(3)
  s_mov_b32 s13, 59392
  buffer_load_dwordx4 v75, s[44:47], s13 offen sc1 lds
  v_mfma_f32_16x16x32_bf16 v[208:211], v[196:199], a[56:59], v[208:211]
  ds_read_b128 v[172:175], v45 offset:24576
  s_add_u32 m0, s97, 63488
  v_mfma_f32_16x16x32_bf16 v[232:235], v[196:199], a[60:63], v[232:235]
  ds_read_b128 v[176:179], v45 offset:26624
  v_mfma_f32_16x16x32_bf16 v[212:215], v[200:203], a[56:59], v[212:215]
  s_mov_b32 s13, 63488
  buffer_load_dwordx4 v75, s[44:47], s13 offen sc1 lds
  v_mfma_f32_16x16x32_bf16 v[236:239], v[200:203], a[60:63], v[236:239]
  ds_read_b128 v[180:183], v45 offset:28672
  s_add_u32 m0, s97, 67584
  v_mfma_f32_16x16x32_bf16 v[216:219], v[204:207], a[56:59], v[216:219]
  v_mfma_f32_16x16x32_bf16 v[240:243], v[204:207], a[60:63], v[240:243]
  s_waitcnt lgkmcnt(3)
  s_mov_b32 s13, 67584
  buffer_load_dwordx4 v75, s[44:47], s13 offen sc1 lds
  v_mfma_f32_16x16x32_bf16 v[208:211], v[160:163], a[64:67], v[208:211]
  ds_read_b128 v[184:187], v44 offset:30720
  s_add_u32 m0, s97, 71680
  v_mfma_f32_16x16x32_bf16 v[232:235], v[160:163], a[68:71], v[232:235]
  ds_read_b128 v[188:191], v44 offset:32768
  v_mfma_f32_16x16x32_bf16 v[212:215], v[164:167], a[64:67], v[212:215]
  s_mov_b32 s13, 71680
  buffer_load_dwordx4 v75, s[44:47], s13 offen sc1 lds
  v_mfma_f32_16x16x32_bf16 v[236:239], v[164:167], a[68:71], v[236:239]
  ds_read_b128 v[192:195], v44 offset:34816
  s_add_u32 m0, s97, 75776
  v_mfma_f32_16x16x32_bf16 v[216:219], v[168:171], a[64:67], v[216:219]
  v_mfma_f32_16x16x32_bf16 v[240:243], v[168:171], a[68:71], v[240:243]
  s_waitcnt lgkmcnt(3)
  s_mov_b32 s13, 75776
  buffer_load_dwordx4 v75, s[44:47], s13 offen sc1 lds
  v_mfma_f32_16x16x32_bf16 v[208:211], v[172:175], a[72:75], v[208:211]
  ds_read_b128 v[196:199], v45 offset:30720
  s_add_u32 m0, s97, 79872
  v_mfma_f32_16x16x32_bf16 v[232:235], v[172:175], a[76:79], v[232:235]
  ds_read_b128 v[200:203], v45 offset:32768
  v_mfma_f32_16x16x32_bf16 v[212:215], v[176:179], a[72:75], v[212:215]
  s_mov_b32 s13, 79872
  buffer_load_dwordx4 v75, s[44:47], s13 offen sc1 lds
  v_mfma_f32_16x16x32_bf16 v[236:239], v[176:179], a[76:79], v[236:239]
  ds_read_b128 v[204:207], v45 offset:34816
  s_add_u32 m0, s97, 83968
  v_mfma_f32_16x16x32_bf16 v[216:219], v[180:183], a[72:75], v[216:219]
  v_mfma_f32_16x16x32_bf16 v[240:243], v[180:183], a[76:79], v[240:243]
  s_waitcnt lgkmcnt(3)
  s_mov_b32 s13, 83968
  buffer_load_dwordx4 v75, s[44:47], s13 offen sc1 lds
  v_mfma_f32_16x16x32_bf16 v[208:211], v[184:187], a[80:83], v[208:211]
  ds_read_b128 v[160:163], v44 offset:36864
  s_add_u32 m0, s97, 88064
  v_mfma_f32_16x16x32_bf16 v[232:235], v[184:187], a[84:87], v[232:235]
  ds_read_b128 v[164:167], v44 offset:38912
  v_mfma_f32_16x16x32_bf16 v[212:215], v[188:191], a[80:83], v[212:215]
  s_mov_b32 s13, 88064
  buffer_load_dwordx4 v75, s[44:47], s13 offen sc1 lds
  v_mfma_f32_16x16x32_bf16 v[236:239], v[188:191], a[84:87], v[236:239]
  ds_read_b128 v[168:171], v44 offset:40960
  s_add_u32 m0, s97, 92160
  v_mfma_f32_16x16x32_bf16 v[216:219], v[192:195], a[80:83], v[216:219]
  v_mfma_f32_16x16x32_bf16 v[240:243], v[192:195], a[84:87], v[240:243]
  s_waitcnt lgkmcnt(3)
  s_mov_b32 s13, 92160
  buffer_load_dwordx4 v75, s[44:47], s13 offen sc1 lds
  v_mfma_f32_16x16x32_bf16 v[208:211], v[196:199], a[88:91], v[208:211]
  ds_read_b128 v[172:175], v45 offset:36864
  s_add_u32 m0, s97, 96256
  v_mfma_f32_16x16x32_bf16 v[232:235], v[196:199], a[92:95], v[232:235]
  ds_read_b128 v[176:179], v45 offset:38912
  v_mfma_f32_16x16x32_bf16 v[212:215], v[200:203], a[88:91], v[212:215]
  s_mov_b32 s13, 96256
  buffer_load_dwordx4 v75, s[44:47], s13 offen sc1 lds
  v_mfma_f32_16x16x32_bf16 v[236:239], v[200:203], a[92:95], v[236:239]
  ds_read_b128 v[180:183], v45 offset:40960
  s_add_u32 m0, s97, 100352
  s_waitcnt vmcnt(11)
  v_mfma_f32_16x16x32_bf16 v[216:219], v[204:207], a[88:91], v[216:219]
  s_mov_b32 s83, 300000
L_pollc_42:
  v_bitop3_b32 v149, v125, v127, v148 bitop3:0x7e
  v_bitop3_b32 v150, v129, v131, v148 bitop3:0x7e
  v_or_b32 v149, v149, v150
  v_bitop3_b32 v150, v133, v135, v148 bitop3:0x7e
  v_or_b32 v149, v149, v150
  v_bitop3_b32 v150, v137, v139, v148 bitop3:0x7e
  v_or_b32 v149, v149, v150
  v_bitop3_b32 v150, v141, v143, v148 bitop3:0x7e
  v_or_b32 v149, v149, v150
  v_bitop3_b32 v150, v145, v147, v148 bitop3:0x7e
  v_or_b32 v149, v149, v150
  v_cmp_ne_u32 vcc, 0, v149
  s_sub_u32 s83, s83, 1
  s_cselect_b64 vcc, 0, vcc
  s_cmp_lg_u64 vcc, 0
  s_cbranch_scc1 L_poll_41
  v_mfma_f32_16x16x32_bf16 v[240:243], v[204:207], a[92:95], v[240:243]
  s_waitcnt lgkmcnt(3)
  s_mov_b32 s13, 100352
  buffer_load_dwordx4 v75, s[44:47], s13 offen sc1 lds
  v_mfma_f32_16x16x32_bf16 v[208:211], v[160:163], a[96:99], v[208:211]
  ds_read_b128 v[184:187], v44 offset:43008
  s_add_u32 m0, s97, 104448
  v_add_f32_dpp v124, v124, v124 row_ror:8 row_mask:0xf bank_mask:0x3
  v_mfma_f32_16x16x32_bf16 v[232:235], v[160:163], a[100:103], v[232:235]
  ds_read_b128 v[188:191], v44 offset:45056
  v_add_f32_dpp v128, v128, v128 row_ror:8 row_mask:0xf bank_mask:0x3
  v_add_f32_dpp v132, v132, v132 row_ror:8 row_mask:0xf bank_mask:0x3
  v_mfma_f32_16x16x32_bf16 v[212:215], v[164:167], a[96:99], v[212:215]
  s_mov_b32 s13, 104448
  buffer_load_dwordx4 v75, s[44:47], s13 offen sc1 lds
  v_mfma_f32_16x16x32_bf16 v[236:239], v[164:167], a[100:103], v[236:239]
  ds_read_b128 v[192:195], v44 offset:47104
  s_add_u32 m0, s97, 108544
  v_add_f32_dpp v126, v126, v126 row_ror:8 row_mask:0xf bank_mask:0x3
  v_mfma_f32_16x16x32_bf16 v[216:219], v[168:171], a[96:99], v[216:219]
  v_add_f32_dpp v130, v130, v130 row_ror:8 row_mask:0xf bank_mask:0x3
  v_add_f32_dpp v134, v134, v134 row_ror:8 row_mask:0xf bank_mask:0x3
  v_mfma_f32_16x16x32_bf16 v[240:243], v[168:171], a[100:103], v[240:243]
  s_waitcnt lgkmcnt(3)
  s_mov_b32 s13, 108544
  buffer_load_dwordx4 v75, s[44:47], s13 offen sc1 lds
  v_mfma_f32_16x16x32_bf16 v[208:211], v[172:175], a[104:107], v[208:211]
  ds_read_b128 v[196:199], v45 offset:43008
  v_add_f32_dpp v124, v136, v136 row_ror:8 row_mask:0xf bank_mask:0xc
  v_add_f32_dpp v128, v140, v140 row_ror:8 row_mask:0xf bank_mask:0xc
  v_mfma_f32_16x16x32_bf16 v[232:235], v[172:175], a[108:111], v[232:235]
  ds_read_b128 v[200:203], v45 offset:45056
  v_add_f32_dpp v132, v144, v144 row_ror:8 row_mask:0xf bank_mask:0xc
  v_add_f32_dpp v126, v138, v138 row_ror:8 row_mask:0xf bank_mask:0xc
  v_mfma_f32_16x16x32_bf16 v[212:215], v[176:179], a[104:107], v[212:215]
  ds_read_b128 v[204:207], v45 offset:47104
  v_add_f32_dpp v130, v142, v142 row_ror:8 row_mask:0xf bank_mask:0xc
  v_add_f32_dpp v134, v146, v146 row_ror:8 row_mask:0xf bank_mask:0xc
  v_mfma_f32_16x16x32_bf16 v[236:239], v[176:179], a[108:111], v[236:239]
  v_add_f32_dpp v124, v124, v124 row_half_mirror row_mask:0xf bank_mask:0x5
  v_add_f32_dpp v132, v132, v132 row_half_mirror row_mask:0xf bank_mask:0xf
  v_mfma_f32_16x16x32_bf16 v[216:219], v[180:183], a[104:107], v[216:219]
  v_add_f32_dpp v126, v126, v126 row_half_mirror row_mask:0xf bank_mask:0x5
  v_add_f32_dpp v134, v134, v134 row_half_mirror row_mask:0xf bank_mask:0xf
  v_mfma_f32_16x16x32_bf16 v[240:243], v[180:183], a[108:111], v[240:243]
  ds_read_b128 v[160:163], v44 offset:49152
  s_waitcnt lgkmcnt(4)
  v_add_f32_dpp v124, v128, v128 row_half_mirror row_mask:0xf bank_mask:0xa
  v_mfma_f32_16x16x32_bf16 v[208:211], v[184:187], a[112:115], v[208:211]
  ds_read_b128 v[164:167], v44 offset:51200
  v_add_f32_dpp v126, v130, v130 row_half_mirror row_mask:0xf bank_mask:0xa
  v_add_f32_dpp v132, v132, v132 quad_perm:[1,0,3,2] row_mask:0xf bank_mask:0xf
  v_mfma_f32_16x16x32_bf16 v[232:235], v[184:187], a[116:119], v[232:235]
  ds_read_b128 v[168:171], v44 offset:53248
  v_add_f32_dpp v134, v134, v134 quad_perm:[1,0,3,2] row_mask:0xf bank_mask:0xf
  v_add_f32_dpp v124, v124, v124 quad_perm:[1,0,3,2] row_mask:0xf bank_mask:0xf
  v_mfma_f32_16x16x32_bf16 v[212:215], v[188:191], a[112:115], v[212:215]
  v_add_f32_dpp v126, v126, v126 quad_perm:[1,0,3,2] row_mask:0xf bank_mask:0xf
  v_add_f32_dpp v132, v132, v132 quad_perm:[2,3,0,1] row_mask:0xf bank_mask:0xf
  v_mfma_f32_16x16x32_bf16 v[236:239], v[188:191], a[116:119], v[236:239]
  v_add_f32_dpp v134, v134, v134 quad_perm:[2,3,0,1] row_mask:0xf bank_mask:0xf
  v_add_f32_dpp v124, v124, v124 quad_perm:[2,3,0,1] row_mask:0xf bank_mask:0xf
  v_mfma_f32_16x16x32_bf16 v[216:219], v[192:195], a[112:115], v[216:219]
  v_add_f32_dpp v126, v126, v126 quad_perm:[2,3,0,1] row_mask:0xf bank_mask:0xf
  v_mul_f32 v156, 0x3ae38e39, v124
  v_mfma_f32_16x16x32_bf16 v[240:243], v[192:195], a[116:119], v[240:243]
  s_waitcnt lgkmcnt(3)
  ds_read_b128 v[172:175], v45 offset:49152
  v_mul_f32 v157, 0x3ae38e39, v126
  v_mfma_f32_16x16x32_bf16 v[208:211], v[196:199], a[120:123], v[208:211]
  ds_read_b128 v[176:179], v45 offset:51200
  v_mul_f32 v158, 0x3ae38e39, v132
  v_mfma_f32_16x16x32_bf16 v[232:235], v[196:199], a[124:127], v[232:235]
  ds_read_b128 v[180:183], v45 offset:53248
  v_mul_f32 v159, 0x3ae38e39, v134
  v_mfma_f32_16x16x32_bf16 v[212:215], v[200:203], a[120:123], v[212:215]
  v_fma_f32 v157, -v156, v156, v157
  v_fma_f32 v159, -v158, v158, v159
  v_mfma_f32_16x16x32_bf16 v[236:239], v[200:203], a[124:127], v[236:239]
  v_max_f32 v157, 0, v157
  v_max_f32 v159, 0, v159
  v_mfma_f32_16x16x32_bf16 v[216:219], v[204:207], a[120:123], v[216:219]
  v_add_f32 v157, 0x3727c5ac, v157
  v_add_f32 v159, 0x3727c5ac, v159
  v_mfma_f32_16x16x32_bf16 v[240:243], v[204:207], a[124:127], v[240:243]
  v_rsq_f32 v157, v157
  v_rsq_f32 v159, v159
  v_add_f32 v62, v62, v156
  v_add_f32 v63, v63, v158
  v_cndmask_b32 v124, v157, v159, s[26:27]
  v_cndmask_b32 v125, v156, v158, s[26:27]
  v_mul_f32 v125, v125, v124
  s_mov_b64 exec, s[40:41]
  ds_write2_b32 v68, v124, v125 offset0:0 offset1:2
  s_mov_b64 exec, -1
  s_waitcnt vmcnt(8)
  s_waitcnt lgkmcnt(0)
  s_barrier
  v_mfma_f32_16x16x32_bf16 v[208:211], v[160:163], a[128:131], v[208:211]
  ds_read_b128 v[184:187], v46 offset:6144
  v_mfma_f32_16x16x32_bf16 v[232:235], v[160:163], a[132:135], v[232:235]
  ds_read_b128 v[188:191], v46 offset:8192
  v_mfma_f32_16x16x32_bf16 v[212:215], v[164:167], a[128:131], v[212:215]
  ds_read_b128 v[192:195], v46 offset:10240
  v_mfma_f32_16x16x32_bf16 v[236:239], v[164:167], a[132:135], v[236:239]
  v_mfma_f32_16x16x32_bf16 v[216:219], v[168:171], a[128:131], v[216:219]
  v_mfma_f32_16x16x32_bf16 v[240:243], v[168:171], a[132:135], v[240:243]
  ds_read_b128 v[196:199], v47 offset:6144
  v_mfma_f32_16x16x32_bf16 v[208:211], v[172:175], a[136:139], v[208:211]
  ds_read_b128 v[200:203], v47 offset:8192
  v_mfma_f32_16x16x32_bf16 v[232:235], v[172:175], a[140:143], v[232:235]
  ds_read_b128 v[204:207], v47 offset:10240
  v_mfma_f32_16x16x32_bf16 v[212:215], v[176:179], a[136:139], v[212:215]
  v_mfma_f32_16x16x32_bf16 v[236:239], v[176:179], a[140:143], v[236:239]
  v_mfma_f32_16x16x32_bf16 v[216:219], v[180:183], a[136:139], v[216:219]
  v_mfma_f32_16x16x32_bf16 v[240:243], v[180:183], a[140:143], v[240:243]
  s_waitcnt lgkmcnt(3)
  ds_read_b128 v[160:163], v46 offset:12288
  v_mfma_f32_16x16x32_bf16 v[220:223], v[184:187], a[0:3], 0
  ds_read_b128 v[164:167], v46 offset:14336
  v_mfma_f32_16x16x32_bf16 v[244:247], v[184:187], a[4:7], 0
  ds_read_b128 v[168:171], v46 offset:16384
  v_mfma_f32_16x16x32_bf16 v[224:227], v[188:191], a[0:3], 0
  ds_read_b128 v[124:127], v73 offset:0
  v_mfma_f32_16x16x32_bf16 v[248:251], v[188:191], a[4:7], 0
  ds_read_b128 v[128:131], v73 offset:16
  v_mfma_f32_16x16x32_bf16 v[228:231], v[192:195], a[0:3], 0
  ds_read_b128 v[132:135], v73 offset:32
  v_mfma_f32_16x16x32_bf16 v[252:255], v[192:195], a[4:7], 0
  s_waitcnt lgkmcnt(6)
  ds_read_b128 v[172:175], v47 offset:12288
  v_mfma_f32_16x16x32_bf16 v[220:223], v[196:199], a[8:11], v[220:223]
  ds_read_b128 v[176:179], v47 offset:14336
  v_mfma_f32_16x16x32_bf16 v[244:247], v[196:199], a[12:15], v[244:247]
  ds_read_b128 v[180:183], v47 offset:16384
  v_mfma_f32_16x16x32_bf16 v[224:227], v[200:203], a[8:11], v[224:227]
  ds_read_b128 v[136:139], v73 offset:48
  v_mfma_f32_16x16x32_bf16 v[248:251], v[200:203], a[12:15], v[248:251]
  ds_read_b128 v[140:143], v73 offset:64
  v_mfma_f32_16x16x32_bf16 v[228:231], v[204:207], a[8:11], v[228:231]
  ds_read_b128 v[144:147], v73 offset:80
  v_mfma_f32_16x16x32_bf16 v[252:255], v[204:207], a[12:15], v[252:255]
  s_waitcnt lgkmcnt(9)
  ds_read_b128 v[184:187], v46 offset:18432
  s_waitcnt lgkmcnt(9)
  v_mul_f32 v208, v208, v124
  v_mfma_f32_16x16x32_bf16 v[220:223], v[160:163], a[16:19], v[220:223]
  ds_read_b128 v[188:191], v46 offset:20480
  v_mul_f32 v232, v232, v124
  v_mfma_f32_16x16x32_bf16 v[244:247], v[160:163], a[20:23], v[244:247]
  ds_read_b128 v[192:195], v46 offset:22528
  v_fma_f32 v208, -v126, v60, v208
  v_mfma_f32_16x16x32_bf16 v[224:227], v[164:167], a[16:19], v[224:227]
  v_fma_f32 v232, -v126, v61, v232
  v_mul_f32 v209, v209, v125
  v_mfma_f32_16x16x32_bf16 v[248:251], v[164:167], a[20:23], v[248:251]
  v_mul_f32 v233, v233, v125
  v_fma_f32 v209, -v127, v60, v209
  v_mfma_f32_16x16x32_bf16 v[228:231], v[168:171], a[16:19], v[228:231]
  v_fma_f32 v233, -v127, v61, v233
  ds_read_b128 v[124:127], v73 offset:96
  v_mfma_f32_16x16x32_bf16 v[252:255], v[168:171], a[20:23], v[252:255]
  s_waitcnt lgkmcnt(7)
  ds_read_b128 v[196:199], v47 offset:18432
  v_mfma_f32_16x16x32_bf16 v[220:223], v[172:175], a[24:27], v[220:223]
  v_mul_f32 v210, v210, v128
  ds_read_b128 v[200:203], v47 offset:20480
  v_mfma_f32_16x16x32_bf16 v[244:247], v[172:175], a[28:31], v[244:247]
  v_mul_f32 v234, v234, v128
  ds_read_b128 v[204:207], v47 offset:22528
  v_mfma_f32_16x16x32_bf16 v[224:227], v[176:179], a[24:27], v[224:227]
  v_fma_f32 v210, -v130, v60, v210
  v_fma_f32 v234, -v130, v61, v234
  v_mfma_f32_16x16x32_bf16 v[248:251], v[176:179], a[28:31], v[248:251]
  v_mul_f32 v211, v211, v129
  v_mul_f32 v235, v235, v129
  v_mfma_f32_16x16x32_bf16 v[228:231], v[180:183], a[24:27], v[228:231]
  v_fma_f32 v211, -v131, v60, v211
  v_fma_f32 v235, -v131, v61, v235
  v_mfma_f32_16x16x32_bf16 v[252:255], v[180:183], a[28:31], v[252:255]
  s_waitcnt lgkmcnt(4)
  ds_read_b128 v[160:163], v46 offset:24576
  v_mfma_f32_16x16x32_bf16 v[220:223], v[184:187], a[32:35], v[220:223]
  ds_read_b128 v[164:167], v46 offset:26624
  v_mfma_f32_16x16x32_bf16 v[244:247], v[184:187], a[36:39], v[244:247]
  ds_read_b128 v[168:171], v46 offset:28672
  v_mfma_f32_16x16x32_bf16 v[224:227], v[188:191], a[32:35], v[224:227]
  ds_read_b128 v[128:131], v73 offset:112
  v_fma_f32 v152, v208, v48, v210
  v_mfma_f32_16x16x32_bf16 v[248:251], v[188:191], a[36:39], v[248:251]
  v_fma_f32 v154, v232, v48, v234
  v_fma_f32 v152, -v232, v49, v152
  v_mfma_f32_16x16x32_bf16 v[228:231], v[192:195], a[32:35], v[228:231]
  v_fmac_f32 v154, v208, v49
  v_fma_f32 v153, v209, v48, v211
  v_mfma_f32_16x16x32_bf16 v[252:255], v[192:195], a[36:39], v[252:255]
  s_waitcnt lgkmcnt(4)
  ds_read_b128 v[172:175], v47 offset:24576
  v_fma_f32 v155, v233, v48, v235
  v_mfma_f32_16x16x32_bf16 v[220:223], v[196:199], a[40:43], v[220:223]
  ds_read_b128 v[176:179], v47 offset:26624
  v_fma_f32 v153, -v233, v49, v153
  v_mfma_f32_16x16x32_bf16 v[244:247], v[196:199], a[44:47], v[244:247]
  ds_read_b128 v[180:183], v47 offset:28672
  v_fmac_f32 v155, v209, v49
  v_mfma_f32_16x16x32_bf16 v[224:227], v[200:203], a[40:43], v[224:227]
  v_mul_f32 v212, v212, v132
  v_mul_f32 v236, v236, v132
  v_mfma_f32_16x16x32_bf16 v[248:251], v[200:203], a[44:47], v[248:251]
  v_fma_f32 v212, -v134, v60, v212
  v_fma_f32 v236, -v134, v61, v236
  v_mfma_f32_16x16x32_bf16 v[228:231], v[204:207], a[40:43], v[228:231]
  v_mul_f32 v213, v213, v133
  v_mul_f32 v237, v237, v133
  v_mfma_f32_16x16x32_bf16 v[252:255], v[204:207], a[44:47], v[252:255]
  s_waitcnt vmcnt(0)
  s_barrier
  s_waitcnt lgkmcnt(4)
  v_mfma_f32_16x16x32_bf16 v[220:223], v[160:163], a[48:51], v[220:223]
  s_cmp_eq_u32 s78, 0
  s_cbranch_scc1 L_slow_43
  s_lshl2_add_u32 s93, s77, s10
  s_add_u32 s93, s93, 160
  s_mov_b64 exec, 1
  buffer_store_dword v2, v10, s[44:47], s93 offen
  s_mov_b64 exec, -1
L_back_44:
  v_mfma_f32_16x16x32_bf16 v[244:247], v[160:163], a[52:55], v[244:247]
  ds_read_b128 v[184:187], v46 offset:30720
  v_fma_f32 v213, -v135, v60, v213
  v_fma_f32 v237, -v135, v61, v237
  v_mfma_f32_16x16x32_bf16 v[224:227], v[164:167], a[48:51], v[224:227]
  ds_read_b128 v[188:191], v46 offset:32768
  v_mfma_f32_16x16x32_bf16 v[248:251], v[164:167], a[52:55], v[248:251]
  ds_read_b128 v[192:195], v46 offset:34816
  v_mfma_f32_16x16x32_bf16 v[228:231], v[168:171], a[48:51], v[228:231]
  ds_read_b128 v[132:135], v73 offset:128
  v_fma_f32 v148, v152, v48, v212
  v_fma_f32 v150, v154, v48, v236
  v_mfma_f32_16x16x32_bf16 v[252:255], v[168:171], a[52:55], v[252:255]
  s_waitcnt lgkmcnt(4)
  ds_read_b128 v[196:199], v47 offset:30720
  v_fma_f32 v148, -v154, v49, v148
  v_mfma_f32_16x16x32_bf16 v[220:223], v[172:175], a[56:59], v[220:223]
  ds_read_b128 v[200:203], v47 offset:32768
  v_fmac_f32 v150, v152, v49
  v_mfma_f32_16x16x32_bf16 v[244:247], v[172:175], a[60:63], v[244:247]
  ds_read_b128 v[204:207], v47 offset:34816
  v_fma_f32 v149, v153, v48, v213
  v_mfma_f32_16x16x32_bf16 v[224:227], v[176:179], a[56:59], v[224:227]
  v_fma_f32 v151, v155, v48, v237
  v_fma_f32 v149, -v155, v49, v149
  v_mfma_f32_16x16x32_bf16 v[248:251], v[176:179], a[60:63], v[248:251]
  v_fmac_f32 v151, v153, v49
  v_mul_f32 v214, v214, v136
  v_mfma_f32_16x16x32_bf16 v[228:231], v[180:183], a[56:59], v[228:231]
  v_mul_f32 v238, v238, v136
  v_fma_f32 v214, -v138, v60, v214
  v_mfma_f32_16x16x32_bf16 v[252:255], v[180:183], a[60:63], v[252:255]
  ds_read_b128 v[160:163], v46 offset:36864
  v_fma_f32 v238, -v138, v61, v238
  v_mul_f32 v215, v215, v137
  s_waitcnt lgkmcnt(5)
  v_mfma_f32_16x16x32_bf16 v[220:223], v[184:187], a[64:67], v[220:223]
  ds_read_b128 v[164:167], v46 offset:38912
  v_mul_f32 v239, v239, v137
  v_fma_f32 v215, -v139, v60, v215
  v_mfma_f32_16x16x32_bf16 v[244:247], v[184:187], a[68:71], v[244:247]
  ds_read_b128 v[168:171], v46 offset:40960
  v_fma_f32 v239, -v139, v61, v239
  v_mfma_f32_16x16x32_bf16 v[224:227], v[188:191], a[64:67], v[224:227]
  ds_read_b128 v[136:139], v73 offset:144
  v_fma_f32 v152, v148, v48, v214
  v_fma_f32 v154, v150, v48, v238
  v_mfma_f32_16x16x32_bf16 v[248:251], v[188:191], a[68:71], v[248:251]
  v_fma_f32 v152, -v150, v49, v152
  v_fmac_f32 v154, v148, v49
  v_mfma_f32_16x16x32_bf16 v[228:231], v[192:195], a[64:67], v[228:231]
  v_fma_f32 v153, v149, v48, v215
  v_fma_f32 v155, v151, v48, v239
  v_mfma_f32_16x16x32_bf16 v[252:255], v[192:195], a[68:71], v[252:255]
  s_waitcnt lgkmcnt(4)
  ds_read_b128 v[172:175], v47 offset:36864
  v_fma_f32 v153, -v151, v49, v153
  v_mfma_f32_16x16x32_bf16 v[220:223], v[196:199], a[72:75], v[220:223]
  ds_read_b128 v[176:179], v47 offset:38912
  v_fmac_f32 v155, v149, v49
  v_mfma_f32_16x16x32_bf16 v[244:247], v[196:199], a[76:79], v[244:247]
  ds_read_b128 v[180:183], v47 offset:40960
  v_mul_f32 v216, v216, v140
  v_mfma_f32_16x16x32_bf16 v[224:227], v[200:203], a[72:75], v[224:227]
  v_mul_f32 v240, v240, v140
  v_fma_f32 v216, -v142, v60, v216
  v_mfma_f32_16x16x32_bf16 v[248:251], v[200:203], a[76:79], v[248:251]
  v_fma_f32 v240, -v142, v61, v240
  v_mul_f32 v217, v217, v141
  v_mfma_f32_16x16x32_bf16 v[228:231], v[204:207], a[72:75], v[228:231]
  v_mul_f32 v241, v241, v141
  v_fma_f32 v217, -v143, v60, v217
  v_mfma_f32_16x16x32_bf16 v[252:255], v[204:207], a[76:79], v[252:255]
  s_waitcnt lgkmcnt(4)
  ds_read_b128 v[184:187], v46 offset:43008
  v_fma_f32 v241, -v143, v61, v241
  v_mfma_f32_16x16x32_bf16 v[220:223], v[160:163], a[80:83], v[220:223]
  ds_read_b128 v[188:191], v46 offset:45056
  v_mfma_f32_16x16x32_bf16 v[244:247], v[160:163], a[84:87], v[244:247]
  ds_read_b128 v[192:195], v46 offset:47104
  v_mfma_f32_16x16x32_bf16 v[224:227], v[164:167], a[80:83], v[224:227]
  ds_read_b128 v[140:143], v73 offset:160
  v_fma_f32 v148, v152, v48, v216
  v_mfma_f32_16x16x32_bf16 v[248:251], v[164:167], a[84:87], v[248:251]
  v_fma_f32 v150, v154, v48, v240
  v_fma_f32 v148, -v154, v49, v148
  v_mfma_f32_16x16x32_bf16 v[228:231], v[168:171], a[80:83], v[228:231]
  v_fmac_f32 v150, v152, v49
  v_fma_f32 v149, v153, v48, v217
  v_mfma_f32_16x16x32_bf16 v[252:255], v[168:171], a[84:87], v[252:255]
  s_waitcnt lgkmcnt(4)
  ds_read_b128 v[196:199], v47 offset:43008
  v_fma_f32 v151, v155, v48, v241
  v_mfma_f32_16x16x32_bf16 v[220:223], v[172:175], a[88:91], v[220:223]
  ds_read_b128 v[200:203], v47 offset:45056
  v_fma_f32 v149, -v155, v49, v149
  v_mfma_f32_16x16x32_bf16 v[244:247], v[172:175], a[92:95], v[244:247]
  ds_read_b128 v[204:207], v47 offset:47104
  v_fmac_f32 v151, v153, v49
  v_mfma_f32_16x16x32_bf16 v[224:227], v[176:179], a[88:91], v[224:227]
  v_mul_f32 v218, v218, v144
  v_mul_f32 v242, v242, v144
  v_mfma_f32_16x16x32_bf16 v[248:251], v[176:179], a[92:95], v[248:251]
  v_fma_f32 v218, -v146, v60, v218
  v_fma_f32 v242, -v146, v61, v242
  v_mfma_f32_16x16x32_bf16 v[228:231], v[180:183], a[88:91], v[228:231]
  v_mul_f32 v219, v219, v145
  v_mul_f32 v243, v243, v145
  v_mfma_f32_16x16x32_bf16 v[252:255], v[180:183], a[92:95], v[252:255]
  s_waitcnt lgkmcnt(4)
  ds_read_b128 v[160:163], v46 offset:49152
  v_fma_f32 v219, -v147, v60, v219
  v_mfma_f32_16x16x32_bf16 v[220:223], v[184:187], a[96:99], v[220:223]
  ds_read_b128 v[164:167], v46 offset:51200
  v_fma_f32 v243, -v147, v61, v243
  v_mfma_f32_16x16x32_bf16 v[244:247], v[184:187], a[100:103], v[244:247]
  ds_read_b128 v[168:171], v46 offset:53248
  v_mfma_f32_16x16x32_bf16 v[224:227], v[188:191], a[96:99], v[224:227]
  ds_read_b128 v[144:147], v73 offset:176
  v_fma_f32 v152, v148, v48, v218
  v_mfma_f32_16x16x32_bf16 v[248:251], v[188:191], a[100:103], v[248:251]
  v_fma_f32 v154, v150, v48, v242
  v_fma_f32 v152, -v150, v49, v152
  v_mfma_f32_16x16x32_bf16 v[228:231], v[192:195], a[96:99], v[228:231]
  v_fmac_f32 v154, v148, v49
  v_fma_f32 v153, v149, v48, v219
  v_mfma_f32_16x16x32_bf16 v[252:255], v[192:195], a[100:103], v[252:255]
  s_waitcnt lgkmcnt(4)
  ds_read_b128 v[172:175], v47 offset:49152
  v_fma_f32 v155, v151, v48, v243
  v_mfma_f32_16x16x32_bf16 v[220:223], v[196:199], a[104:107], v[220:223]
  ds_read_b128 v[176:179], v47 offset:51200
  v_fma_f32 v153, -v151, v49, v153
  v_mfma_f32_16x16x32_bf16 v[244:247], v[196:199], a[108:111], v[244:247]
  ds_read_b128 v[180:183], v47 offset:53248
  v_fmac_f32 v155, v149, v49
  v_mfma_f32_16x16x32_bf16 v[224:227], v[200:203], a[104:107], v[224:227]
  v_mfma_f32_16x16x32_bf16 v[248:251], v[200:203], a[108:111], v[248:251]
  v_mfma_f32_16x16x32_bf16 v[228:231], v[204:207], a[104:107], v[228:231]
  v_mfma_f32_16x16x32_bf16 v[252:255], v[204:207], a[108:111], v[252:255]
  s_waitcnt lgkmcnt(4)
  ds_read_b128 v[184:187], v46 offset:55296
  v_mfma_f32_16x16x32_bf16 v[220:223], v[160:163], a[112:115], v[220:223]
  ds_read_b128 v[188:191], v46 offset:57344
  v_mfma_f32_16x16x32_bf16 v[244:247], v[160:163], a[116:119], v[244:247]
  ds_read_b128 v[192:195], v46 offset:59392
  v_mfma_f32_16x16x32_bf16 v[224:227], v[164:167], a[112:115], v[224:227]
  v_mfma_f32_16x16x32_bf16 v[248:251], v[164:167], a[116:119], v[248:251]
  v_mfma_f32_16x16x32_bf16 v[228:231], v[168:171], a[112:115], v[228:231]
  v_mfma_f32_16x16x32_bf16 v[252:255], v[168:171], a[116:119], v[252:255]
  s_waitcnt lgkmcnt(3)
  ds_read_b128 v[196:199], v47 offset:55296
  v_mfma_f32_16x16x32_bf16 v[220:223], v[172:175], a[120:123], v[220:223]
  ds_read_b128 v[200:203], v47 offset:57344
  v_mfma_f32_16x16x32_bf16 v[244:247], v[172:175], a[124:127], v[244:247]
  ds_read_b128 v[204:207], v47 offset:59392
  v_mfma_f32_16x16x32_bf16 v[224:227], v[176:179], a[120:123], v[224:227]
  v_mfma_f32_16x16x32_bf16 v[248:251], v[176:179], a[124:127], v[248:251]
  v_mfma_f32_16x16x32_bf16 v[228:231], v[180:183], a[120:123], v[228:231]
  v_mfma_f32_16x16x32_bf16 v[252:255], v[180:183], a[124:127], v[252:255]
  s_waitcnt lgkmcnt(3)
  v_mfma_f32_16x16x32_bf16 v[220:223], v[184:187], a[128:131], v[220:223]
  v_mfma_f32_16x16x32_bf16 v[244:247], v[184:187], a[132:135], v[244:247]
  v_mfma_f32_16x16x32_bf16 v[224:227], v[188:191], a[128:131], v[224:227]
  v_mfma_f32_16x16x32_bf16 v[248:251], v[188:191], a[132:135], v[248:251]
  v_mfma_f32_16x16x32_bf16 v[228:231], v[192:195], a[128:131], v[228:231]
  v_mfma_f32_16x16x32_bf16 v[252:255], v[192:195], a[132:135], v[252:255]
  s_waitcnt lgkmcnt(0)
  v_mfma_f32_16x16x32_bf16 v[220:223], v[196:199], a[136:139], v[220:223]
  v_mfma_f32_16x16x32_bf16 v[244:247], v[196:199], a[140:143], v[244:247]
  v_mfma_f32_16x16x32_bf16 v[224:227], v[200:203], a[136:139], v[224:227]
  v_mfma_f32_16x16x32_bf16 v[248:251], v[200:203], a[140:143], v[248:251]
  v_mfma_f32_16x16x32_bf16 v[228:231], v[204:207], a[136:139], v[228:231]
  v_mfma_f32_16x16x32_bf16 v[252:255], v[204:207], a[140:143], v[252:255]
  s_nop 2
  v_pk_mul_f32 v[220:221], v[220:221], v[124:125]
  v_pk_mul_f32 v[244:245], v[244:245], v[124:125]
  v_pk_fma_f32 v[220:221], v[126:127], v[60:61], v[220:221] op_sel:[0,0,0] op_sel_hi:[1,0,1] neg_lo:[1,0,0] neg_hi:[1,0,0]
  v_pk_fma_f32 v[244:245], v[126:127], v[60:61], v[244:245] op_sel:[0,1,0] op_sel_hi:[1,1,1] neg_lo:[1,0,0] neg_hi:[1,0,0]
  v_pk_fma_f32 v[148:149], v[152:153], v[48:49], v[220:221] op_sel:[0,0,0] op_sel_hi:[1,0,1]
  v_pk_fma_f32 v[150:151], v[154:155], v[48:49], v[244:245] op_sel:[0,0,0] op_sel_hi:[1,0,1]
  v_pk_fma_f32 v[148:149], v[154:155], v[48:49], v[148:149] op_sel:[0,1,0] op_sel_hi:[1,1,1] neg_lo:[1,0,0] neg_hi:[1,0,0]
  v_pk_fma_f32 v[150:151], v[152:153], v[48:49], v[150:151] op_sel:[0,1,0] op_sel_hi:[1,1,1]
  v_pk_mul_f32 v[222:223], v[222:223], v[128:129]
  v_pk_mul_f32 v[246:247], v[246:247], v[128:129]
  v_pk_fma_f32 v[222:223], v[130:131], v[60:61], v[222:223] op_sel:[0,0,0] op_sel_hi:[1,0,1] neg_lo:[1,0,0] neg_hi:[1,0,0]
  v_pk_fma_f32 v[246:247], v[130:131], v[60:61], v[246:247] op_sel:[0,1,0] op_sel_hi:[1,1,1] neg_lo:[1,0,0] neg_hi:[1,0,0]
  v_pk_fma_f32 v[152:153], v[148:149], v[48:49], v[222:223] op_sel:[0,0,0] op_sel_hi:[1,0,1]
  v_pk_fma_f32 v[154:155], v[150:151], v[48:49], v[246:247] op_sel:[0,0,0] op_sel_hi:[1,0,1]
  v_pk_fma_f32 v[152:153], v[150:151], v[48:49], v[152:153] op_sel:[0,1,0] op_sel_hi:[1,1,1] neg_lo:[1,0,0] neg_hi:[1,0,0]
  v_pk_fma_f32 v[154:155], v[148:149], v[48:49], v[154:155] op_sel:[0,1,0] op_sel_hi:[1,1,1]
  v_pk_mul_f32 v[224:225], v[224:225], v[132:133]
  v_pk_mul_f32 v[248:249], v[248:249], v[132:133]
  v_pk_fma_f32 v[224:225], v[134:135], v[60:61], v[224:225] op_sel:[0,0,0] op_sel_hi:[1,0,1] neg_lo:[1,0,0] neg_hi:[1,0,0]
  v_pk_fma_f32 v[248:249], v[134:135], v[60:61], v[248:249] op_sel:[0,1,0] op_sel_hi:[1,1,1] neg_lo:[1,0,0] neg_hi:[1,0,0]
  v_pk_fma_f32 v[148:149], v[152:153], v[48:49], v[224:225] op_sel:[0,0,0] op_sel_hi:[1,0,1]
  v_pk_fma_f32 v[150:151], v[154:155], v[48:49], v[248:249] op_sel:[0,0,0] op_sel_hi:[1,0,1]
  v_pk_fma_f32 v[148:149], v[154:155], v[48:49], v[148:149] op_sel:[0,1,0] op_sel_hi:[1,1,1] neg_lo:[1,0,0] neg_hi:[1,0,0]
  v_pk_fma_f32 v[150:151], v[152:153], v[48:49], v[150:151] op_sel:[0,1,0] op_sel_hi:[1,1,1]
  v_pk_mul_f32 v[226:227], v[226:227], v[136:137]
  v_pk_mul_f32 v[250:251], v[250:251], v[136:137]
  v_pk_fma_f32 v[226:227], v[138:139], v[60:61], v[226:227] op_sel:[0,0,0] op_sel_hi:[1,0,1] neg_lo:[1,0,0] neg_hi:[1,0,0]
  v_pk_fma_f32 v[250:251], v[138:139], v[60:61], v[250:251] op_sel:[0,1,0] op_sel_hi:[1,1,1] neg_lo:[1,0,0] neg_hi:[1,0,0]
  v_pk_fma_f32 v[152:153], v[148:149], v[48:49], v[226:227] op_sel:[0,0,0] op_sel_hi:[1,0,1]
  v_pk_fma_f32 v[154:155], v[150:151], v[48:49], v[250:251] op_sel:[0,0,0] op_sel_hi:[1,0,1]
  v_pk_fma_f32 v[152:153], v[150:151], v[48:49], v[152:153] op_sel:[0,1,0] op_sel_hi:[1,1,1] neg_lo:[1,0,0] neg_hi:[1,0,0]
  v_pk_fma_f32 v[154:155], v[148:149], v[48:49], v[154:155] op_sel:[0,1,0] op_sel_hi:[1,1,1]
  v_pk_mul_f32 v[228:229], v[228:229], v[140:141]
  v_pk_mul_f32 v[252:253], v[252:253], v[140:141]
  v_pk_fma_f32 v[228:229], v[142:143], v[60:61], v[228:229] op_sel:[0,0,0] op_sel_hi:[1,0,1] neg_lo:[1,0,0] neg_hi:[1,0,0]
  v_pk_fma_f32 v[252:253], v[142:143], v[60:61], v[252:253] op_sel:[0,1,0] op_sel_hi:[1,1,1] neg_lo:[1,0,0] neg_hi:[1,0,0]
  v_pk_fma_f32 v[148:149], v[152:153], v[48:49], v[228:229] op_sel:[0,0,0] op_sel_hi:[1,0,1]
  v_pk_fma_f32 v[150:151], v[154:155], v[48:49], v[252:253] op_sel:[0,0,0] op_sel_hi:[1,0,1]
  v_pk_fma_f32 v[148:149], v[154:155], v[48:49], v[148:149] op_sel:[0,1,0] op_sel_hi:[1,1,1] neg_lo:[1,0,0] neg_hi:[1,0,0]
  v_pk_fma_f32 v[150:151], v[152:153], v[48:49], v[150:151] op_sel:[0,1,0] op_sel_hi:[1,1,1]
  v_pk_mul_f32 v[230:231], v[230:231], v[144:145]
  v_pk_mul_f32 v[254:255], v[254:255], v[144:145]
  v_pk_fma_f32 v[230:231], v[146:147], v[60:61], v[230:231] op_sel:[0,0,0] op_sel_hi:[1,0,1] neg_lo:[1,0,0] neg_hi:[1,0,0]
  v_pk_fma_f32 v[254:255], v[146:147], v[60:61], v[254:255] op_sel:[0,1,0] op_sel_hi:[1,1,1] neg_lo:[1,0,0] neg_hi:[1,0,0]
  v_pk_fma_f32 v[152:153], v[148:149], v[48:49], v[230:231] op_sel:[0,0,0] op_sel_hi:[1,0,1]
  v_pk_fma_f32 v[154:155], v[150:151], v[48:49], v[254:255] op_sel:[0,0,0] op_sel_hi:[1,0,1]
  v_pk_fma_f32 v[152:153], v[150:151], v[48:49], v[152:153] op_sel:[0,1,0] op_sel_hi:[1,1,1] neg_lo:[1,0,0] neg_hi:[1,0,0]
  v_pk_fma_f32 v[154:155], v[148:149], v[48:49], v[154:155] op_sel:[0,1,0] op_sel_hi:[1,1,1]
  v_mov_b32 v160, v152
  v_mov_b32 v161, v154
  v_mov_b32 v162, v153
  v_mov_b32 v163, v155
  v_pk_fma_f32 v[148:149], v[160:161], v[50:51], v[162:163] op_sel:[0,0,0] op_sel_hi:[1,0,1]
  v_pk_fma_f32 v[148:149], v[160:161], v[50:51], v[148:149] op_sel:[1,1,0] op_sel_hi:[0,1,1] neg_lo:[1,0,0]
  v_mov_b64 v[150:151], v[148:149]
  v_mov_b32 v13, v2
  v_mov_b32 v15, v2
  v_permlane16_swap_b32 v148, v150
  v_permlane16_swap_b32 v149, v151
  s_lshl_b32 s93, s99, 13
  v_mov_b64 v[152:153], v[148:149]
  v_mov_b64 v[154:155], v[150:151]
  s_add_u32 s93, s93, 360448
  v_permlane32_swap_b32 v148, v152
  v_permlane32_swap_b32 v149, v153
  v_permlane32_swap_b32 v150, v154
  v_permlane32_swap_b32 v151, v155
  v_pk_fma_f32 v[150:151], v[148:149], v[52:53], v[150:151] op_sel:[0,0,0] op_sel_hi:[1,0,1]
  v_pk_fma_f32 v[150:151], v[148:149], v[52:53], v[150:151] op_sel:[1,1,0] op_sel_hi:[0,1,1] neg_lo:[1,0,0]
  v_pk_fma_f32 v[152:153], v[150:151], v[52:53], v[152:153] op_sel:[0,0,0] op_sel_hi:[1,0,1]
  v_pk_fma_f32 v[152:153], v[150:151], v[52:53], v[152:153] op_sel:[1,1,0] op_sel_hi:[0,1,1] neg_lo:[1,0,0]
  v_pk_fma_f32 v[154:155], v[152:153], v[52:53], v[154:155] op_sel:[0,0,0] op_sel_hi:[1,0,1]
  v_pk_fma_f32 v[154:155], v[152:153], v[52:53], v[154:155] op_sel:[1,1,0] op_sel_hi:[0,1,1] neg_lo:[1,0,0]
  v_mov_b32 v12, v154
  v_mov_b32 v14, v155
  buffer_store_dwordx4 v[12:15], v69, s[44:47], s93 offen sc1
  v_mov_b32 v162, 0
  v_mov_b32 v163, 0
  v_cmp_eq_u32 vcc, 1, v6
  s_nop 1
  v_cndmask_b32 v162, v162, v148, vcc
  v_cndmask_b32 v163, v163, v149, vcc
  v_cmp_eq_u32 vcc, 2, v6
  s_nop 1
  v_cndmask_b32 v162, v162, v150, vcc
  v_cndmask_b32 v163, v163, v151, vcc
  v_cmp_eq_u32 vcc, 3, v6
  s_nop 1
  v_cndmask_b32 v162, v162, v152, vcc
  v_cndmask_b32 v163, v163, v153, vcc
  s_lshl_b32 s94, s76, 8
  s_add_u32 s94, s94, 27808
  v_lshl_add_u32 v12, v5, 2, s94
  v_cmp_gt_u32 vcc, 9, v5
  s_nop 1
  v_cndmask_b32 v12, v7, v12, vcc
  buffer_load_dword v13, v12, s[44:47], 0 offen sc1
  v_mov_b64_dpp v[14:15], v[156:157] row_newbcast:0 row_mask:0xf bank_mask:0xf
  v_pk_add_f32 v[16:17], v[16:17], v[14:15] op_sel:[0,0] op_sel_hi:[1,0] neg_lo:[0,1] neg_hi:[0,1]
  v_pk_add_f32 v[18:19], v[18:19], v[14:15] op_sel:[0,0] op_sel_hi:[1,0] neg_lo:[0,1] neg_hi:[0,1]
  v_pk_fma_f32 v[124:125], v[40:41], v[14:15], 1.0 op_sel:[0,1,0] op_sel_hi:[1,1,0]
  v_pk_fma_f32 v[126:127], v[42:43], v[14:15], 1.0 op_sel:[0,1,0] op_sel_hi:[1,1,0]
  v_pk_mul_f32 v[16:17], v[16:17], v[124:125]
  v_pk_mul_f32 v[18:19], v[18:19], v[126:127]
  v_mov_b64_dpp v[14:15], v[156:157] row_newbcast:4 row_mask:0xf bank_mask:0xf
  v_pk_add_f32 v[20:21], v[20:21], v[14:15] op_sel:[0,0] op_sel_hi:[1,0] neg_lo:[0,1] neg_hi:[0,1]
  v_pk_add_f32 v[22:23], v[22:23], v[14:15] op_sel:[0,0] op_sel_hi:[1,0] neg_lo:[0,1] neg_hi:[0,1]
  v_pk_fma_f32 v[124:125], v[40:41], v[14:15], 1.0 op_sel:[0,1,0] op_sel_hi:[1,1,0]
  v_pk_fma_f32 v[126:127], v[42:43], v[14:15], 1.0 op_sel:[0,1,0] op_sel_hi:[1,1,0]
  v_pk_mul_f32 v[20:21], v[20:21], v[124:125]
  v_pk_mul_f32 v[22:23], v[22:23], v[126:127]
  v_mov_b64_dpp v[14:15], v[158:159] row_newbcast:0 row_mask:0xf bank_mask:0xf
  v_pk_add_f32 v[24:25], v[24:25], v[14:15] op_sel:[0,0] op_sel_hi:[1,0] neg_lo:[0,1] neg_hi:[0,1]
  v_pk_add_f32 v[26:27], v[26:27], v[14:15] op_sel:[0,0] op_sel_hi:[1,0] neg_lo:[0,1] neg_hi:[0,1]
  v_pk_fma_f32 v[124:125], v[40:41], v[14:15], 1.0 op_sel:[0,1,0] op_sel_hi:[1,1,0]
  v_pk_fma_f32 v[126:127], v[42:43], v[14:15], 1.0 op_sel:[0,1,0] op_sel_hi:[1,1,0]
  v_pk_mul_f32 v[24:25], v[24:25], v[124:125]
  v_pk_mul_f32 v[26:27], v[26:27], v[126:127]
  v_mov_b64_dpp v[14:15], v[156:157] row_newbcast:8 row_mask:0xf bank_mask:0xf
  v_pk_add_f32 v[28:29], v[28:29], v[14:15] op_sel:[0,0] op_sel_hi:[1,0] neg_lo:[0,1] neg_hi:[0,1]
  v_pk_add_f32 v[30:31], v[30:31], v[14:15] op_sel:[0,0] op_sel_hi:[1,0] neg_lo:[0,1] neg_hi:[0,1]
  v_pk_fma_f32 v[124:125], v[40:41], v[14:15], 1.0 op_sel:[0,1,0] op_sel_hi:[1,1,0]
  v_pk_fma_f32 v[126:127], v[42:43], v[14:15], 1.0 op_sel:[0,1,0] op_sel_hi:[1,1,0]
  v_pk_mul_f32 v[28:29], v[28:29], v[124:125]
  v_pk_mul_f32 v[30:31], v[30:31], v[126:127]
  v_mov_b64_dpp v[14:15], v[156:157] row_newbcast:12 row_mask:0xf bank_mask:0xf
  v_pk_add_f32 v[32:33], v[32:33], v[14:15] op_sel:[0,0] op_sel_hi:[1,0] neg_lo:[0,1] neg_hi:[0,1]
  v_pk_add_f32 v[34:35], v[34:35], v[14:15] op_sel:[0,0] op_sel_hi:[1,0] neg_lo:[0,1] neg_hi:[0,1]
  v_pk_fma_f32 v[124:125], v[40:41], v[14:15], 1.0 op_sel:[0,1,0] op_sel_hi:[1,1,0]
  v_pk_fma_f32 v[126:127], v[42:43], v[14:15], 1.0 op_sel:[0,1,0] op_sel_hi:[1,1,0]
  v_pk_mul_f32 v[32:33], v[32:33], v[124:125]
  v_pk_mul_f32 v[34:35], v[34:35], v[126:127]
  v_mov_b64_dpp v[14:15], v[158:159] row_newbcast:8 row_mask:0xf bank_mask:0xf
  v_pk_add_f32 v[36:37], v[36:37], v[14:15] op_sel:[0,0] op_sel_hi:[1,0] neg_lo:[0,1] neg_hi:[0,1]
  v_pk_add_f32 v[38:39], v[38:39], v[14:15] op_sel:[0,0] op_sel_hi:[1,0] neg_lo:[0,1] neg_hi:[0,1]
  v_pk_fma_f32 v[124:125], v[40:41], v[14:15], 1.0 op_sel:[0,1,0] op_sel_hi:[1,1,0]
  v_pk_fma_f32 v[126:127], v[42:43], v[14:15], 1.0 op_sel:[0,1,0] op_sel_hi:[1,1,0]
  v_pk_mul_f32 v[36:37], v[36:37], v[124:125]
  v_pk_mul_f32 v[38:39], v[38:39], v[126:127]
  s_lshl_b32 s93, s99, 13
  s_add_u32 s93, s93, 360448
  v_add_u32 v154, s93, v70
  v_subrev_u32 v153, 5120, v154
  v_cmp_le_i32 vcc, 5120, v70
  s_nop 1
  v_cndmask_b32 v153, v7, v153, vcc
  v_cndmask_b32 v159, 0, v2, vcc
  v_subrev_u32 v152, 4096, v154
  v_cmp_le_i32 vcc, 4096, v70
  s_nop 1
  v_cndmask_b32 v152, v7, v152, vcc
  v_cndmask_b32 v158, 0, v2, vcc
  v_subrev_u32 v151, 3072, v154
  v_cmp_le_i32 vcc, 3072, v70
  s_nop 1
  v_cndmask_b32 v151, v7, v151, vcc
  v_cndmask_b32 v157, 0, v2, vcc
  v_subrev_u32 v150, 2048, v154
  v_cmp_le_i32 vcc, 2048, v70
  s_nop 1
  v_cndmask_b32 v150, v7, v150, vcc
  v_cndmask_b32 v156, 0, v2, vcc
  v_subrev_u32 v149, 1024, v154
  v_cmp_le_i32 vcc, 1024, v70
  s_nop 1
  v_cndmask_b32 v149, v7, v149, vcc
  v_cndmask_b32 v155, 0, v2, vcc
  v_subrev_u32 v148, 0, v154
  v_cmp_le_i32 vcc, 0, v70
  s_nop 1
  v_cndmask_b32 v148, v7, v148, vcc
  v_cndmask_b32 v154, 0, v2, vcc
  buffer_load_dwordx4 v[124:127], v148, s[44:47], 0 offen sc1
  buffer_load_dwordx4 v[128:131], v149, s[44:47], 0 offen sc1
  buffer_load_dwordx4 v[132:135], v150, s[44:47], 0 offen sc1
  buffer_load_dwordx4 v[136:139], v151, s[44:47], 0 offen sc1
  buffer_load_dwordx4 v[140:143], v152, s[44:47], 0 offen sc1
  buffer_load_dwordx4 v[144:147], v153, s[44:47], 0 offen sc1
  s_mov_b32 s83, 300000
  s_waitcnt vmcnt(6)
L_pollc_46:
  v_cmp_ne_u32 vcc, v13, v67
  s_sub_u32 s83, s83, 1
  s_cselect_b64 vcc, 0, vcc
  s_cmp_lg_u64 vcc, 0
  s_cbranch_scc1 L_poll_45
  s_mov_b32 s83, 300000
  s_waitcnt vmcnt(0)
L_pollc_48:
  v_bitop3_b32 v12, v125, v127, v154 bitop3:0x7e
  v_bitop3_b32 v13, v129, v131, v155 bitop3:0x7e
  v_or_b32 v12, v12, v13
  v_bitop3_b32 v13, v133, v135, v156 bitop3:0x7e
  v_or_b32 v12, v12, v13
  v_bitop3_b32 v13, v137, v139, v157 bitop3:0x7e
  v_or_b32 v12, v12, v13
  v_bitop3_b32 v13, v141, v143, v158 bitop3:0x7e
  v_or_b32 v12, v12, v13
  v_bitop3_b32 v13, v145, v147, v159 bitop3:0x7e
  v_or_b32 v12, v12, v13
  v_cmp_ne_u32 vcc, 0, v12
  s_sub_u32 s83, s83, 1
  s_cselect_b64 vcc, 0, vcc
  s_cmp_lg_u64 vcc, 0
  s_cbranch_scc1 L_poll_47
  v_mov_b32 v125, v126
  v_mov_b32 v129, v130
  v_mov_b32 v133, v134
  v_mov_b32 v137, v138
  v_mov_b32 v141, v142
  v_mov_b32 v145, v146
  v_pk_fma_f32 v[140:141], v[144:145], v[54:55], v[140:141] op_sel:[0,0,0] op_sel_hi:[1,0,1]
  v_pk_fma_f32 v[140:141], v[144:145], v[54:55], v[140:141] op_sel:[1,1,0] op_sel_hi:[0,1,1] neg_lo:[1,0,0]
  v_pk_fma_f32 v[136:137], v[140:141], v[54:55], v[136:137] op_sel:[0,0,0] op_sel_hi:[1,0,1]
  v_pk_fma_f32 v[136:137], v[140:141], v[54:55], v[136:137] op_sel:[1,1,0] op_sel_hi:[0,1,1] neg_lo:[1,0,0]
  v_pk_fma_f32 v[132:133], v[136:137], v[54:55], v[132:133] op_sel:[0,0,0] op_sel_hi:[1,0,1]
  v_pk_fma_f32 v[132:133], v[136:137], v[54:55], v[132:133] op_sel:[1,1,0] op_sel_hi:[0,1,1] neg_lo:[1,0,0]
  v_pk_fma_f32 v[128:129], v[132:133], v[54:55], v[128:129] op_sel:[0,0,0] op_sel_hi:[1,0,1]
  v_pk_fma_f32 v[128:129], v[132:133], v[54:55], v[128:129] op_sel:[1,1,0] op_sel_hi:[0,1,1] neg_lo:[1,0,0]
  v_pk_fma_f32 v[124:125], v[128:129], v[54:55], v[124:125] op_sel:[0,0,0] op_sel_hi:[1,0,1]
  v_pk_fma_f32 v[124:125], v[128:129], v[54:55], v[124:125] op_sel:[1,1,0] op_sel_hi:[0,1,1] neg_lo:[1,0,0]
  v_pk_mul_f32 v[12:13], v[124:125], v[56:57] op_sel:[0,0] op_sel_hi:[1,0]
  v_pk_fma_f32 v[12:13], v[124:125], v[56:57], v[12:13] op_sel:[1,1,0] op_sel_hi:[0,1,1] neg_lo:[1,0,0]
  v_mov_b64 v[14:15], v[12:13]
  s_nop 1
  v_permlane32_swap_b32 v12, v14
  v_permlane32_swap_b32 v13, v15
  v_pk_add_f32 v[12:13], v[12:13], v[14:15]
  v_mov_b64 v[14:15], v[12:13]
  s_nop 1
  v_permlane16_swap_b32 v12, v14
  v_permlane16_swap_b32 v13, v15
  v_pk_add_f32 v[12:13], v[12:13], v[14:15]
  v_pk_fma_f32 v[162:163], v[12:13], v[58:59], v[162:163] op_sel:[0,0,0] op_sel_hi:[1,0,1]
  v_pk_fma_f32 v[162:163], v[12:13], v[58:59], v[162:163] op_sel:[1,1,0] op_sel_hi:[0,1,1] neg_lo:[1,0,0]
  v_pk_fma_f32 v[160:161], v[162:163], v[50:51], v[160:161] op_sel:[0,0,0] op_sel_hi:[1,0,1]
  v_pk_fma_f32 v[160:161], v[162:163], v[50:51], v[160:161] op_sel:[1,1,0] op_sel_hi:[0,1,1] neg_lo:[1,0,0]
  v_mov_b32 v12, v162
  v_mov_b32 v13, v160
  v_mov_b32 v14, v163
  v_mov_b32 v15, v161
  s_mul_i32 s95, s76, 216
  s_add_u32 s95, s95, s99
  s_lshl_b32 s95, s95, 10
  v_pk_fma_f32 v[208:209], v[12:13], v[48:49], v[208:209] op_sel:[0,0,0] op_sel_hi:[1,0,1]
  v_pk_fma_f32 v[232:233], v[14:15], v[48:49], v[232:233] op_sel:[0,0,0] op_sel_hi:[1,0,1]
  v_pk_fma_f32 v[208:209], v[14:15], v[48:49], v[208:209] op_sel:[0,1,0] op_sel_hi:[1,1,1] neg_lo:[1,0,0] neg_hi:[1,0,0]
  v_pk_fma_f32 v[232:233], v[12:13], v[48:49], v[232:233] op_sel:[0,1,0] op_sel_hi:[1,1,1]
  v_cvt_pk_bf16_f32 v148, v208, v232
  v_cvt_pk_bf16_f32 v149, v209, v233
  ds_write_b32 v71, v148 offset:0
  ds_write_b32 v71, v149 offset:64
  v_pk_fma_f32 v[210:211], v[208:209], v[48:49], v[210:211] op_sel:[0,0,0] op_sel_hi:[1,0,1]
  v_pk_fma_f32 v[234:235], v[232:233], v[48:49], v[234:235] op_sel:[0,0,0] op_sel_hi:[1,0,1]
  v_pk_fma_f32 v[210:211], v[232:233], v[48:49], v[210:211] op_sel:[0,1,0] op_sel_hi:[1,1,1] neg_lo:[1,0,0] neg_hi:[1,0,0]
  v_pk_fma_f32 v[234:235], v[208:209], v[48:49], v[234:235] op_sel:[0,1,0] op_sel_hi:[1,1,1]
  v_cvt_pk_bf16_f32 v150, v210, v234
  v_cvt_pk_bf16_f32 v151, v211, v235
  ds_write_b32 v71, v150 offset:128
  ds_write_b32 v71, v151 offset:192
  ds_read_b128 v[124:127], v72 offset:0
  v_pk_fma_f32 v[212:213], v[210:211], v[48:49], v[212:213] op_sel:[0,0,0] op_sel_hi:[1,0,1]
  v_pk_fma_f32 v[236:237], v[234:235], v[48:49], v[236:237] op_sel:[0,0,0] op_sel_hi:[1,0,1]
  v_pk_fma_f32 v[212:213], v[234:235], v[48:49], v[212:213] op_sel:[0,1,0] op_sel_hi:[1,1,1] neg_lo:[1,0,0] neg_hi:[1,0,0]
  v_pk_fma_f32 v[236:237], v[210:211], v[48:49], v[236:237] op_sel:[0,1,0] op_sel_hi:[1,1,1]
  v_cvt_pk_bf16_f32 v148, v212, v236
  v_cvt_pk_bf16_f32 v149, v213, v237
  ds_write_b32 v71, v148 offset:1024
  ds_write_b32 v71, v149 offset:1088
  v_pk_fma_f32 v[214:215], v[212:213], v[48:49], v[214:215] op_sel:[0,0,0] op_sel_hi:[1,0,1]
  v_pk_fma_f32 v[238:239], v[236:237], v[48:49], v[238:239] op_sel:[0,0,0] op_sel_hi:[1,0,1]
  v_pk_fma_f32 v[214:215], v[236:237], v[48:49], v[214:215] op_sel:[0,1,0] op_sel_hi:[1,1,1] neg_lo:[1,0,0] neg_hi:[1,0,0]
  v_pk_fma_f32 v[238:239], v[212:213], v[48:49], v[238:239] op_sel:[0,1,0] op_sel_hi:[1,1,1]
  v_cvt_pk_bf16_f32 v150, v214, v238
  v_cvt_pk_bf16_f32 v151, v215, v239
  ds_write_b32 v71, v150 offset:1152
  ds_write_b32 v71, v151 offset:1216
  ds_read_b128 v[128:131], v72 offset:1024
  v_pk_fma_f32 v[216:217], v[214:215], v[48:49], v[216:217] op_sel:[0,0,0] op_sel_hi:[1,0,1]
  v_pk_fma_f32 v[240:241], v[238:239], v[48:49], v[240:241] op_sel:[0,0,0] op_sel_hi:[1,0,1]
  v_pk_fma_f32 v[216:217], v[238:239], v[48:49], v[216:217] op_sel:[0,1,0] op_sel_hi:[1,1,1] neg_lo:[1,0,0] neg_hi:[1,0,0]
  v_pk_fma_f32 v[240:241], v[214:215], v[48:49], v[240:241] op_sel:[0,1,0] op_sel_hi:[1,1,1]
  v_cvt_pk_bf16_f32 v148, v216, v240
  v_cvt_pk_bf16_f32 v149, v217, v241
  ds_write_b32 v71, v148 offset:2048
  ds_write_b32 v71, v149 offset:2112
  v_pk_fma_f32 v[218:219], v[216:217], v[48:49], v[218:219] op_sel:[0,0,0] op_sel_hi:[1,0,1]
  v_pk_fma_f32 v[242:243], v[240:241], v[48:49], v[242:243] op_sel:[0,0,0] op_sel_hi:[1,0,1]
  v_pk_fma_f32 v[218:219], v[240:241], v[48:49], v[218:219] op_sel:[0,1,0] op_sel_hi:[1,1,1] neg_lo:[1,0,0] neg_hi:[1,0,0]
  v_pk_fma_f32 v[242:243], v[216:217], v[48:49], v[242:243] op_sel:[0,1,0] op_sel_hi:[1,1,1]
  v_cvt_pk_bf16_f32 v150, v218, v242
  v_cvt_pk_bf16_f32 v151, v219, v243
  ds_write_b32 v71, v150 offset:2176
  ds_write_b32 v71, v151 offset:2240
  ds_read_b128 v[132:135], v72 offset:2048
  v_pk_fma_f32 v[220:221], v[218:219], v[48:49], v[220:221] op_sel:[0,0,0] op_sel_hi:[1,0,1]
  v_pk_fma_f32 v[244:245], v[242:243], v[48:49], v[244:245] op_sel:[0,0,0] op_sel_hi:[1,0,1]
  v_pk_fma_f32 v[220:221], v[242:243], v[48:49], v[220:221] op_sel:[0,1,0] op_sel_hi:[1,1,1] neg_lo:[1,0,0] neg_hi:[1,0,0]
  v_pk_fma_f32 v[244:245], v[218:219], v[48:49], v[244:245] op_sel:[0,1,0] op_sel_hi:[1,1,1]
  v_cvt_pk_bf16_f32 v148, v220, v244
  v_cvt_pk_bf16_f32 v149, v221, v245
  ds_write_b32 v71, v148 offset:3072
  ds_write_b32 v71, v149 offset:3136
  v_pk_fma_f32 v[222:223], v[220:221], v[48:49], v[222:223] op_sel:[0,0,0] op_sel_hi:[1,0,1]
  v_pk_fma_f32 v[246:247], v[244:245], v[48:49], v[246:247] op_sel:[0,0,0] op_sel_hi:[1,0,1]
  v_pk_fma_f32 v[222:223], v[244:245], v[48:49], v[222:223] op_sel:[0,1,0] op_sel_hi:[1,1,1] neg_lo:[1,0,0] neg_hi:[1,0,0]
  v_pk_fma_f32 v[246:247], v[220:221], v[48:49], v[246:247] op_sel:[0,1,0] op_sel_hi:[1,1,1]
  v_cvt_pk_bf16_f32 v150, v222, v246
  v_cvt_pk_bf16_f32 v151, v223, v247
  s_waitcnt lgkmcnt(2)
  s_cmp_eq_u32 s78, 0
  s_cbranch_scc1 L_slow_49
  s_add_u32 s94, s95, 7077888
  buffer_store_dwordx4 v[124:127], v4, s[44:47], s94 offen
  s_add_u32 s94, s95, 7114752
  buffer_store_dwordx4 v[128:131], v4, s[44:47], s94 offen
  s_add_u32 s94, s95, 7151616
  buffer_store_dwordx4 v[132:135], v4, s[44:47], s94 offen
L_back_50:
  ds_write_b32 v71, v150 offset:3200
  ds_write_b32 v71, v151 offset:3264
  ds_read_b128 v[136:139], v72 offset:3072
  v_pk_fma_f32 v[224:225], v[222:223], v[48:49], v[224:225] op_sel:[0,0,0] op_sel_hi:[1,0,1]
  v_pk_fma_f32 v[248:249], v[246:247], v[48:49], v[248:249] op_sel:[0,0,0] op_sel_hi:[1,0,1]
  v_pk_fma_f32 v[224:225], v[246:247], v[48:49], v[224:225] op_sel:[0,1,0] op_sel_hi:[1,1,1] neg_lo:[1,0,0] neg_hi:[1,0,0]
  v_pk_fma_f32 v[248:249], v[222:223], v[48:49], v[248:249] op_sel:[0,1,0] op_sel_hi:[1,1,1]
  v_cvt_pk_bf16_f32 v148, v224, v248
  v_cvt_pk_bf16_f32 v149, v225, v249
  ds_write_b32 v71, v148 offset:4096
  ds_write_b32 v71, v149 offset:4160
  v_pk_fma_f32 v[226:227], v[224:225], v[48:49], v[226:227] op_sel:[0,0,0] op_sel_hi:[1,0,1]
  v_pk_fma_f32 v[250:251], v[248:249], v[48:49], v[250:251] op_sel:[0,0,0] op_sel_hi:[1,0,1]
  v_pk_fma_f32 v[226:227], v[248:249], v[48:49], v[226:227] op_sel:[0,1,0] op_sel_hi:[1,1,1] neg_lo:[1,0,0] neg_hi:[1,0,0]
  v_pk_fma_f32 v[250:251], v[224:225], v[48:49], v[250:251] op_sel:[0,1,0] op_sel_hi:[1,1,1]
  v_cvt_pk_bf16_f32 v150, v226, v250
  v_cvt_pk_bf16_f32 v151, v227, v251
  ds_write_b32 v71, v150 offset:4224
  ds_write_b32 v71, v151 offset:4288
  ds_read_b128 v[140:143], v72 offset:4096
  v_pk_fma_f32 v[228:229], v[226:227], v[48:49], v[228:229] op_sel:[0,0,0] op_sel_hi:[1,0,1]
  v_pk_fma_f32 v[252:253], v[250:251], v[48:49], v[252:253] op_sel:[0,0,0] op_sel_hi:[1,0,1]
  v_pk_fma_f32 v[228:229], v[250:251], v[48:49], v[228:229] op_sel:[0,1,0] op_sel_hi:[1,1,1] neg_lo:[1,0,0] neg_hi:[1,0,0]
  v_pk_fma_f32 v[252:253], v[226:227], v[48:49], v[252:253] op_sel:[0,1,0] op_sel_hi:[1,1,1]
  v_cvt_pk_bf16_f32 v148, v228, v252
  v_cvt_pk_bf16_f32 v149, v229, v253
  ds_write_b32 v71, v148 offset:5120
  ds_write_b32 v71, v149 offset:5184
  v_pk_fma_f32 v[230:231], v[228:229], v[48:49], v[230:231] op_sel:[0,0,0] op_sel_hi:[1,0,1]
  v_pk_fma_f32 v[254:255], v[252:253], v[48:49], v[254:255] op_sel:[0,0,0] op_sel_hi:[1,0,1]
  v_pk_fma_f32 v[230:231], v[252:253], v[48:49], v[230:231] op_sel:[0,1,0] op_sel_hi:[1,1,1] neg_lo:[1,0,0] neg_hi:[1,0,0]
  v_pk_fma_f32 v[254:255], v[228:229], v[48:49], v[254:255] op_sel:[0,1,0] op_sel_hi:[1,1,1]
  v_cvt_pk_bf16_f32 v150, v230, v254
  v_cvt_pk_bf16_f32 v151, v231, v255
  ds_write_b32 v71, v150 offset:5248
  ds_write_b32 v71, v151 offset:5312
  ds_read_b128 v[144:147], v72 offset:5120
  s_lshl2_add_u32 s93, s76, s79
  s_lshl4_add_u32 s93, s93, s77
  s_lshl_b32 s93, s93, 2
  s_add_u32 s93, s93, 22016
  s_waitcnt lgkmcnt(0)
  s_cmp_eq_u32 s78, 0
  s_cbranch_scc1 L_slow_51
  s_add_u32 s94, s95, 7188480
  buffer_store_dwordx4 v[136:139], v4, s[44:47], s94 offen
  s_add_u32 s94, s95, 7225344
  buffer_store_dwordx4 v[140:143], v4, s[44:47], s94 offen
  s_add_u32 s94, s95, 7262208
  buffer_store_dwordx4 v[144:147], v4, s[44:47], s94 offen
L_back_52:
  s_add_u32 s5, s93, 11264
  s_waitcnt vmcnt(3)
  s_cmp_eq_u32 s78, 0
  s_cbranch_scc1 L_slow_53
  s_mov_b64 exec, 1
  buffer_store_dword v2, v10, s[44:47], s93 offen
  s_mov_b64 exec, -1
L_back_54:
  s_lshl2_add_u32 s94, s76, s79
  s_lshl_b32 s94, s94, 6
  s_add_u32 s94, s94, 22016
  v_lshl_add_u32 v12, v5, 2, s94
  v_cmp_gt_u32 vcc, 9, v5
  s_nop 1
  v_cndmask_b32 v12, v7, v12, vcc
  s_mul_i32 s94, s76, 216
  s_add_u32 s94, s94, s79
  s_lshl_b32 s94, s94, 10
  s_add_u32 s22, s94, 7077888
  s_mov_b32 s12, 11264
  buffer_load_dword v13, v12, s[44:47], 0 offen sc1
  s_waitcnt vmcnt(2)
  s_cmp_eq_u32 s78, 0
  s_cbranch_scc1 L_slow_55
  s_mov_b64 exec, 1
  buffer_store_dword v2, v10, s[44:47], s5 offen
  s_mov_b64 exec, -1
L_back_56:
  s_mov_b32 s83, 300000
  s_waitcnt vmcnt(1)
L_pollc_60:
  v_cmp_ne_u32 vcc, v13, v67
  s_sub_u32 s83, s83, 1
  s_cselect_b64 vcc, 0, vcc
  s_cmp_lg_u64 vcc, 0
  s_cbranch_scc1 L_poll_59
  buffer_load_dwordx4 v[252:255], v4, s[44:47], s22 offen sc1
  s_add_u32 s22, s22, 4096
  buffer_load_dwordx4 v[248:251], v4, s[44:47], s22 offen sc1
  s_add_u32 s22, s22, 4096
  buffer_load_dwordx4 v[244:247], v4, s[44:47], s22 offen sc1
  s_add_u32 s22, s22, 4096
  buffer_load_dwordx4 v[240:243], v4, s[44:47], s22 offen sc1
  s_add_u32 s22, s22, 4096
  buffer_load_dwordx4 v[236:239], v4, s[44:47], s22 offen sc1
  s_add_u32 s22, s22, 4096
  buffer_load_dwordx4 v[232:235], v4, s[44:47], s22 offen sc1
  s_add_u32 s22, s22, 4096
  s_waitcnt vmcnt(5)
  v_mfma_f32_16x16x32_bf16 v[188:191], a[144:147], v[252:255], 0
  s_waitcnt vmcnt(4)
  v_mfma_f32_16x16x32_bf16 v[184:187], a[148:151], v[252:255], 0
  v_mfma_f32_16x16x32_bf16 v[180:183], a[152:155], v[252:255], 0
  v_mfma_f32_16x16x32_bf16 v[176:179], a[156:159], v[252:255], 0
  buffer_load_dwordx4 v[228:231], v4, s[44:47], s22 offen sc1
  s_add_u32 s22, s22, 4096
  v_mfma_f32_16x16x32_bf16 v[188:191], a[160:163], v[248:251], v[188:191]
  s_waitcnt vmcnt(4)
  v_mfma_f32_16x16x32_bf16 v[184:187], a[164:167], v[248:251], v[184:187]
  v_mfma_f32_16x16x32_bf16 v[180:183], a[168:171], v[248:251], v[180:183]
  v_mfma_f32_16x16x32_bf16 v[176:179], a[172:175], v[248:251], v[176:179]
  buffer_load_dwordx4 v[224:227], v4, s[44:47], s22 offen sc1
  s_add_u32 s22, s22, 4096
  v_mfma_f32_16x16x32_bf16 v[188:191], a[176:179], v[244:247], v[188:191]
  s_waitcnt vmcnt(4)
  v_mfma_f32_16x16x32_bf16 v[184:187], a[180:183], v[244:247], v[184:187]
  v_mfma_f32_16x16x32_bf16 v[180:183], a[184:187], v[244:247], v[180:183]
  v_mfma_f32_16x16x32_bf16 v[176:179], a[188:191], v[244:247], v[176:179]
  buffer_load_dwordx4 v[220:223], v4, s[44:47], s22 offen sc1
  s_add_u32 s22, s22, 4096
  v_mfma_f32_16x16x32_bf16 v[188:191], a[192:195], v[240:243], v[188:191]
  s_waitcnt vmcnt(4)
  v_mfma_f32_16x16x32_bf16 v[184:187], a[196:199], v[240:243], v[184:187]
  v_mfma_f32_16x16x32_bf16 v[180:183], a[200:203], v[240:243], v[180:183]
  buffer_load_dword v14, v12, s[44:47], s12 offen sc1
  s_lshl2_add_u32 s93, s81, s79
  s_cmp_lg_u32 s93, 756
  s_cselect_b64 exec, 0, 1
  buffer_store_dword v2, v10, s[44:47], 0 offen sc1
  s_mov_b64 exec, -1
  v_mfma_f32_16x16x32_bf16 v[176:179], a[204:207], v[240:243], v[176:179]
  buffer_load_dwordx4 v[216:219], v4, s[44:47], s22 offen sc1
  s_add_u32 s22, s22, 4096
  v_mfma_f32_16x16x32_bf16 v[188:191], a[208:211], v[236:239], v[188:191]
  s_waitcnt vmcnt(6)
  v_mfma_f32_16x16x32_bf16 v[184:187], a[212:215], v[236:239], v[184:187]
  v_mfma_f32_16x16x32_bf16 v[180:183], a[216:219], v[236:239], v[180:183]
  v_mfma_f32_16x16x32_bf16 v[176:179], a[220:223], v[236:239], v[176:179]
  buffer_load_dwordx4 v[212:215], v4, s[44:47], s22 offen sc1
  s_add_u32 s22, s22, 4096
  v_mfma_f32_16x16x32_bf16 v[188:191], a[224:227], v[232:235], v[188:191]
  s_waitcnt vmcnt(6)
  v_mfma_f32_16x16x32_bf16 v[184:187], a[228:231], v[232:235], v[184:187]
  v_mfma_f32_16x16x32_bf16 v[180:183], a[232:235], v[232:235], v[180:183]
  v_mfma_f32_16x16x32_bf16 v[176:179], a[236:239], v[232:235], v[176:179]
  buffer_load_dwordx4 v[208:211], v4, s[44:47], s22 offen sc1
  s_add_u32 s22, s22, 4096
  v_mfma_f32_16x16x32_bf16 v[188:191], a[240:243], v[228:231], v[188:191]
  s_waitcnt vmcnt(6)
  v_mfma_f32_16x16x32_bf16 v[184:187], a[244:247], v[228:231], v[184:187]
  v_mfma_f32_16x16x32_bf16 v[180:183], a[248:251], v[228:231], v[180:183]
  v_mfma_f32_16x16x32_bf16 v[176:179], a[252:255], v[228:231], v[176:179]
  buffer_load_dwordx4 v[204:207], v4, s[44:47], s22 offen sc1
  s_add_u32 s22, s22, 4096
  v_mfma_f32_16x16x32_bf16 v[188:191], v[76:79], v[224:227], v[188:191]
  s_waitcnt vmcnt(6)
  v_mfma_f32_16x16x32_bf16 v[184:187], v[80:83], v[224:227], v[184:187]
  v_mfma_f32_16x16x32_bf16 v[180:183], v[84:87], v[224:227], v[180:183]
  v_mfma_f32_16x16x32_bf16 v[176:179], v[88:91], v[224:227], v[176:179]
  buffer_load_dwordx4 v[200:203], v4, s[44:47], s22 offen sc1
  s_add_u32 s22, s22, 4096
  v_mfma_f32_16x16x32_bf16 v[188:191], v[92:95], v[220:223], v[188:191]
  v_mfma_f32_16x16x32_bf16 v[184:187], v[96:99], v[220:223], v[184:187]
  v_mfma_f32_16x16x32_bf16 v[180:183], v[100:103], v[220:223], v[180:183]
  v_mfma_f32_16x16x32_bf16 v[176:179], v[104:107], v[220:223], v[176:179]
  buffer_load_dwordx4 v[196:199], v4, s[44:47], s22 offen sc1
  s_add_u32 s22, s22, 4096
  s_mov_b32 s83, 300000
  s_waitcnt vmcnt(7)
L_pollc_58:
  v_cmp_ne_u32 vcc, v14, v67
  s_sub_u32 s83, s83, 1
  s_cselect_b64 vcc, 0, vcc
  s_cmp_lg_u64 vcc, 0
  s_cbranch_scc1 L_poll_57
  s_barrier
  s_waitcnt vmcnt(5)
  v_mfma_f32_16x16x32_bf16 v[172:175], a[144:147], v[216:219], 0
  s_waitcnt vmcnt(4)
  ds_write_b128 v122, v[188:191] offset:17408
  v_mfma_f32_16x16x32_bf16 v[168:171], a[148:151], v[216:219], 0
  v_mfma_f32_16x16x32_bf16 v[164:167], a[152:155], v[216:219], 0
  v_mfma_f32_16x16x32_bf16 v[160:163], a[156:159], v[216:219], 0
  buffer_load_dwordx4 v[192:195], v4, s[44:47], s22 offen sc1
  s_add_u32 s22, s22, 4096
  v_mfma_f32_16x16x32_bf16 v[172:175], a[160:163], v[212:215], v[172:175]
  s_waitcnt vmcnt(4)
  ds_write_b128 v122, v[184:187] offset:17472
  v_mfma_f32_16x16x32_bf16 v[168:171], a[164:167], v[212:215], v[168:171]
  v_mfma_f32_16x16x32_bf16 v[164:167], a[168:171], v[212:215], v[164:167]
  v_mfma_f32_16x16x32_bf16 v[160:163], a[172:175], v[212:215], v[160:163]
  buffer_load_dwordx4 v[252:255], v4, s[44:47], s22 offen sc1
  s_add_u32 s22, s22, 4096
  v_mfma_f32_16x16x32_bf16 v[172:175], a[176:179], v[208:211], v[172:175]
  s_waitcnt vmcnt(4)
  ds_write_b128 v122, v[180:183] offset:17536
  v_mfma_f32_16x16x32_bf16 v[168:171], a[180:183], v[208:211], v[168:171]
  v_mfma_f32_16x16x32_bf16 v[164:167], a[184:187], v[208:211], v[164:167]
  v_mfma_f32_16x16x32_bf16 v[160:163], a[188:191], v[208:211], v[160:163]
  buffer_load_dwordx4 v[248:251], v4, s[44:47], s22 offen sc1
  s_add_u32 s22, s22, 4096
  v_mfma_f32_16x16x32_bf16 v[172:175], a[192:195], v[204:207], v[172:175]
  s_waitcnt vmcnt(4)
  ds_write_b128 v122, v[176:179] offset:17600
  v_mfma_f32_16x16x32_bf16 v[168:171], a[196:199], v[204:207], v[168:171]
  v_mfma_f32_16x16x32_bf16 v[164:167], a[200:203], v[204:207], v[164:167]
  v_mfma_f32_16x16x32_bf16 v[160:163], a[204:207], v[204:207], v[160:163]
  buffer_load_dwordx4 v[244:247], v4, s[44:47], s22 offen sc1
  s_add_u32 s22, s22, 4096
  v_mfma_f32_16x16x32_bf16 v[172:175], a[208:211], v[200:203], v[172:175]
  s_waitcnt vmcnt(4)
  v_mfma_f32_16x16x32_bf16 v[168:171], a[212:215], v[200:203], v[168:171]
  v_mfma_f32_16x16x32_bf16 v[164:167], a[216:219], v[200:203], v[164:167]
  v_mfma_f32_16x16x32_bf16 v[160:163], a[220:223], v[200:203], v[160:163]
  buffer_load_dwordx4 v[240:243], v4, s[44:47], s22 offen sc1
  s_add_u32 s22, s22, 4096
  v_mfma_f32_16x16x32_bf16 v[172:175], a[224:227], v[196:199], v[172:175]
  s_waitcnt vmcnt(4)
  v_mfma_f32_16x16x32_bf16 v[168:171], a[228:231], v[196:199], v[168:171]
  v_mfma_f32_16x16x32_bf16 v[164:167], a[232:235], v[196:199], v[164:167]
  v_mfma_f32_16x16x32_bf16 v[160:163], a[236:239], v[196:199], v[160:163]
  buffer_load_dwordx4 v[236:239], v4, s[44:47], s22 offen sc1
  s_add_u32 s22, s22, 4096
  v_mfma_f32_16x16x32_bf16 v[172:175], a[240:243], v[192:195], v[172:175]
  s_waitcnt vmcnt(4)
  v_mfma_f32_16x16x32_bf16 v[168:171], a[244:247], v[192:195], v[168:171]
  v_mfma_f32_16x16x32_bf16 v[164:167], a[248:251], v[192:195], v[164:167]
  v_mfma_f32_16x16x32_bf16 v[160:163], a[252:255], v[192:195], v[160:163]
  buffer_load_dwordx4 v[232:235], v4, s[44:47], s22 offen sc1
  s_add_u32 s22, s22, 4096
  v_mfma_f32_16x16x32_bf16 v[172:175], v[76:79], v[252:255], v[172:175]
  s_waitcnt vmcnt(4)
  v_mfma_f32_16x16x32_bf16 v[168:171], v[80:83], v[252:255], v[168:171]
  v_mfma_f32_16x16x32_bf16 v[164:167], v[84:87], v[252:255], v[164:167]
  v_mfma_f32_16x16x32_bf16 v[160:163], v[88:91], v[252:255], v[160:163]
  buffer_load_dwordx4 v[228:231], v4, s[44:47], s22 offen sc1
  s_add_u32 s22, s22, 4096
  v_mfma_f32_16x16x32_bf16 v[172:175], v[92:95], v[248:251], v[172:175]
  v_mfma_f32_16x16x32_bf16 v[168:171], v[96:99], v[248:251], v[168:171]
  v_mfma_f32_16x16x32_bf16 v[164:167], v[100:103], v[248:251], v[164:167]
  v_mfma_f32_16x16x32_bf16 v[160:163], v[104:107], v[248:251], v[160:163]
  buffer_load_dwordx4 v[224:227], v4, s[44:47], s22 offen sc1
  s_add_u32 s22, s22, 4096
  s_waitcnt vmcnt(5)
  v_mfma_f32_16x16x32_bf16 v[188:191], a[144:147], v[244:247], 0
  s_waitcnt vmcnt(4)
  ds_write_b128 v122, v[172:175] offset:34816
  v_mfma_f32_16x16x32_bf16 v[184:187], a[148:151], v[244:247], 0
  v_mfma_f32_16x16x32_bf16 v[180:183], a[152:155], v[244:247], 0
  v_mfma_f32_16x16x32_bf16 v[176:179], a[156:159], v[244:247], 0
  buffer_load_dwordx4 v[220:223], v4, s[44:47], s22 offen sc1
  s_add_u32 s22, s22, 4096
  v_mfma_f32_16x16x32_bf16 v[188:191], a[160:163], v[240:243], v[188:191]
  s_waitcnt vmcnt(4)
  ds_write_b128 v122, v[168:171] offset:34880
  v_mfma_f32_16x16x32_bf16 v[184:187], a[164:167], v[240:243], v[184:187]
  v_mfma_f32_16x16x32_bf16 v[180:183], a[168:171], v[240:243], v[180:183]
  v_mfma_f32_16x16x32_bf16 v[176:179], a[172:175], v[240:243], v[176:179]
  buffer_load_dwordx4 v[216:219], v4, s[44:47], s22 offen sc1
  s_add_u32 s22, s22, 4096
  v_mfma_f32_16x16x32_bf16 v[188:191], a[176:179], v[236:239], v[188:191]
  s_waitcnt vmcnt(4)
  ds_write_b128 v122, v[164:167] offset:34944
  v_mfma_f32_16x16x32_bf16 v[184:187], a[180:183], v[236:239], v[184:187]
  v_mfma_f32_16x16x32_bf16 v[180:183], a[184:187], v[236:239], v[180:183]
  v_mfma_f32_16x16x32_bf16 v[176:179], a[188:191], v[236:239], v[176:179]
  buffer_load_dwordx4 v[212:215], v4, s[44:47], s22 offen sc1
  s_add_u32 s22, s22, 4096
  v_mfma_f32_16x16x32_bf16 v[188:191], a[192:195], v[232:235], v[188:191]
  s_waitcnt vmcnt(4)
  ds_write_b128 v122, v[160:163] offset:35008
  v_mfma_f32_16x16x32_bf16 v[184:187], a[196:199], v[232:235], v[184:187]
  v_mfma_f32_16x16x32_bf16 v[180:183], a[200:203], v[232:235], v[180:183]
  v_mfma_f32_16x16x32_bf16 v[176:179], a[204:207], v[232:235], v[176:179]
  buffer_load_dwordx4 v[208:211], v4, s[44:47], s22 offen sc1
  s_add_u32 s22, s22, 4096
  v_mfma_f32_16x16x32_bf16 v[188:191], a[208:211], v[228:231], v[188:191]
  s_waitcnt vmcnt(4)
  v_mfma_f32_16x16x32_bf16 v[184:187], a[212:215], v[228:231], v[184:187]
  v_mfma_f32_16x16x32_bf16 v[180:183], a[216:219], v[228:231], v[180:183]
  v_mfma_f32_16x16x32_bf16 v[176:179], a[220:223], v[228:231], v[176:179]
  buffer_load_dwordx4 v[204:207], v4, s[44:47], s22 offen sc1
  s_add_u32 s22, s22, 4096
  v_mfma_f32_16x16x32_bf16 v[188:191], a[224:227], v[224:227], v[188:191]
  s_waitcnt vmcnt(4)
  v_mfma_f32_16x16x32_bf16 v[184:187], a[228:231], v[224:227], v[184:187]
  v_mfma_f32_16x16x32_bf16 v[180:183], a[232:235], v[224:227], v[180:183]
  v_mfma_f32_16x16x32_bf16 v[176:179], a[236:239], v[224:227], v[176:179]
  buffer_load_dwordx4 v[200:203], v4, s[44:47], s22 offen sc1
  s_add_u32 s22, s22, 4096
  v_mfma_f32_16x16x32_bf16 v[188:191], a[240:243], v[220:223], v[188:191]
  s_waitcnt vmcnt(4)
  v_mfma_f32_16x16x32_bf16 v[184:187], a[244:247], v[220:223], v[184:187]
  v_mfma_f32_16x16x32_bf16 v[180:183], a[248:251], v[220:223], v[180:183]
  v_mfma_f32_16x16x32_bf16 v[176:179], a[252:255], v[220:223], v[176:179]
  buffer_load_dwordx4 v[196:199], v4, s[44:47], s22 offen sc1
  s_add_u32 s22, s22, 4096
  v_mfma_f32_16x16x32_bf16 v[188:191], v[76:79], v[216:219], v[188:191]
  s_waitcnt vmcnt(4)
  v_mfma_f32_16x16x32_bf16 v[184:187], v[80:83], v[216:219], v[184:187]
  v_mfma_f32_16x16x32_bf16 v[180:183], v[84:87], v[216:219], v[180:183]
  v_mfma_f32_16x16x32_bf16 v[176:179], v[88:91], v[216:219], v[176:179]
  buffer_load_dwordx4 v[192:195], v4, s[44:47], s22 offen sc1
  s_add_u32 s22, s22, 4096
  v_mfma_f32_16x16x32_bf16 v[188:191], v[92:95], v[212:215], v[188:191]
  v_mfma_f32_16x16x32_bf16 v[184:187], v[96:99], v[212:215], v[184:187]
  v_mfma_f32_16x16x32_bf16 v[180:183], v[100:103], v[212:215], v[180:183]
  v_mfma_f32_16x16x32_bf16 v[176:179], v[104:107], v[212:215], v[176:179]
  buffer_load_dwordx4 v[252:255], v4, s[44:47], s22 offen sc1
  s_add_u32 s22, s22, 4096
  s_waitcnt lgkmcnt(0)
  s_barrier
  s_waitcnt vmcnt(5)
  v_mfma_f32_16x16x32_bf16 v[172:175], a[144:147], v[208:211], 0
  s_waitcnt vmcnt(4)
  ds_read_b128 v[136:139], v123 offset:17408
  v_mfma_f32_16x16x32_bf16 v[168:171], a[148:151], v[208:211], 0
  ds_read_b128 v[140:143], v123 offset:21760
  v_mfma_f32_16x16x32_bf16 v[164:167], a[152:155], v[208:211], 0
  ds_read_b128 v[144:147], v123 offset:26112
  v_mfma_f32_16x16x32_bf16 v[160:163], a[156:159], v[208:211], 0
  buffer_load_dwordx4 v[248:251], v4, s[44:47], s22 offen sc1
  s_add_u32 s22, s22, 4096
  v_mfma_f32_16x16x32_bf16 v[172:175], a[160:163], v[204:207], v[172:175]
  s_waitcnt vmcnt(4)
  ds_read_b128 v[148:151], v123 offset:30464
  v_mfma_f32_16x16x32_bf16 v[168:171], a[164:167], v[204:207], v[168:171]
  ds_write_b128 v120, v[188:191] offset:0
  v_mfma_f32_16x16x32_bf16 v[164:167], a[168:171], v[204:207], v[164:167]
  v_mfma_f32_16x16x32_bf16 v[160:163], a[172:175], v[204:207], v[160:163]
  buffer_load_dwordx4 v[244:247], v4, s[44:47], s22 offen sc1
  s_add_u32 s22, s22, 4096
  v_mfma_f32_16x16x32_bf16 v[172:175], a[176:179], v[200:203], v[172:175]
  s_waitcnt vmcnt(4)
  s_waitcnt lgkmcnt(4)
  v_add_f32 v16, v16, v136
  v_mfma_f32_16x16x32_bf16 v[168:171], a[180:183], v[200:203], v[168:171]
  v_add_f32 v17, v17, v137
  v_add_f32 v18, v18, v138
  v_mfma_f32_16x16x32_bf16 v[164:167], a[184:187], v[200:203], v[164:167]
  v_add_f32 v19, v19, v139
  ds_read_b128 v[136:139], v123 offset:34816
  v_mfma_f32_16x16x32_bf16 v[160:163], a[188:191], v[200:203], v[160:163]
  buffer_load_dwordx4 v[240:243], v4, s[44:47], s22 offen sc1
  s_add_u32 s22, s22, 4096
  v_mfma_f32_16x16x32_bf16 v[172:175], a[192:195], v[196:199], v[172:175]
  s_waitcnt vmcnt(4)
  s_waitcnt lgkmcnt(4)
  v_add_f32 v16, v16, v140
  v_add_f32 v17, v17, v141
  v_mfma_f32_16x16x32_bf16 v[168:171], a[196:199], v[196:199], v[168:171]
  v_add_f32 v18, v18, v142
  v_add_f32 v19, v19, v143
  v_mfma_f32_16x16x32_bf16 v[164:167], a[200:203], v[196:199], v[164:167]
  ds_read_b128 v[140:143], v123 offset:39168
  s_waitcnt lgkmcnt(4)
  v_add_f32 v16, v16, v144
  v_add_f32 v17, v17, v145
  v_mfma_f32_16x16x32_bf16 v[160:163], a[204:207], v[196:199], v[160:163]
  buffer_load_dwordx4 v[236:239], v4, s[44:47], s22 offen sc1
  s_add_u32 s22, s22, 4096
  v_mfma_f32_16x16x32_bf16 v[172:175], a[208:211], v[192:195], v[172:175]
  s_waitcnt vmcnt(4)
  v_add_f32 v18, v18, v146
  v_add_f32 v19, v19, v147
  v_mfma_f32_16x16x32_bf16 v[168:171], a[212:215], v[192:195], v[168:171]
  ds_read_b128 v[144:147], v123 offset:43520
  s_waitcnt lgkmcnt(4)
  v_add_f32 v16, v16, v148
  v_add_f32 v17, v17, v149
  v_mfma_f32_16x16x32_bf16 v[164:167], a[216:219], v[192:195], v[164:167]
  v_add_f32 v18, v18, v150
  v_add_f32 v19, v19, v151
  v_mfma_f32_16x16x32_bf16 v[160:163], a[220:223], v[192:195], v[160:163]
  buffer_load_dwordx4 v[232:235], v4, s[44:47], s22 offen sc1
  s_add_u32 s22, s22, 4096
  v_mfma_f32_16x16x32_bf16 v[172:175], a[224:227], v[252:255], v[172:175]
  s_waitcnt vmcnt(4)
  ds_read_b128 v[148:151], v123 offset:47872
  v_add_f32 v124, v16, v17
  v_mfma_f32_16x16x32_bf16 v[168:171], a[228:231], v[252:255], v[168:171]
  v_mul_f32 v130, v16, v16
  v_add_f32 v124, v124, v18
  v_mfma_f32_16x16x32_bf16 v[164:167], a[232:235], v[252:255], v[164:167]
  v_fmac_f32 v130, v17, v17
  v_add_f32 v124, v124, v19
  v_mfma_f32_16x16x32_bf16 v[160:163], a[236:239], v[252:255], v[160:163]
  buffer_load_dwordx4 v[228:231], v4, s[44:47], s22 offen sc1
  s_add_u32 s22, s22, 4096
  v_mfma_f32_16x16x32_bf16 v[172:175], a[240:243], v[248:251], v[172:175]
  s_waitcnt vmcnt(4)
  v_fmac_f32 v130, v18, v18
  v_fmac_f32 v130, v19, v19
  v_mfma_f32_16x16x32_bf16 v[168:171], a[244:247], v[248:251], v[168:171]
  s_waitcnt lgkmcnt(3)
  v_add_f32 v20, v20, v136
  v_add_f32 v21, v21, v137
  v_mfma_f32_16x16x32_bf16 v[164:167], a[248:251], v[248:251], v[164:167]
  v_add_f32 v22, v22, v138
  v_add_f32 v23, v23, v139
  v_mfma_f32_16x16x32_bf16 v[160:163], a[252:255], v[248:251], v[160:163]
  buffer_load_dwordx4 v[224:227], v4, s[44:47], s22 offen sc1
  s_add_u32 s22, s22, 4096
  v_mfma_f32_16x16x32_bf16 v[172:175], v[76:79], v[244:247], v[172:175]
  s_waitcnt vmcnt(4)
  s_waitcnt lgkmcnt(2)
  v_add_f32 v20, v20, v140
  v_add_f32 v21, v21, v141
  v_mfma_f32_16x16x32_bf16 v[168:171], v[80:83], v[244:247], v[168:171]
  v_add_f32 v22, v22, v142
  v_add_f32 v23, v23, v143
  v_mfma_f32_16x16x32_bf16 v[164:167], v[84:87], v[244:247], v[164:167]
  s_waitcnt lgkmcnt(1)
  v_add_f32 v20, v20, v144
  v_add_f32 v21, v21, v145
  v_mfma_f32_16x16x32_bf16 v[160:163], v[88:91], v[244:247], v[160:163]
  buffer_load_dwordx4 v[220:223], v4, s[44:47], s22 offen sc1
  s_add_u32 s22, s22, 4096
  v_mfma_f32_16x16x32_bf16 v[172:175], v[92:95], v[240:243], v[172:175]
  v_add_f32 v22, v22, v146
  v_add_f32 v23, v23, v147
  v_mfma_f32_16x16x32_bf16 v[168:171], v[96:99], v[240:243], v[168:171]
  s_waitcnt lgkmcnt(0)
  v_add_f32 v20, v20, v148
  v_add_f32 v21, v21, v149
  v_mfma_f32_16x16x32_bf16 v[164:167], v[100:103], v[240:243], v[164:167]
  v_add_f32 v22, v22, v150
  v_add_f32 v23, v23, v151
  v_mfma_f32_16x16x32_bf16 v[160:163], v[104:107], v[240:243], v[160:163]
  buffer_load_dwordx4 v[216:219], v4, s[44:47], s22 offen sc1
  s_add_u32 s22, s22, 4096
  ds_write_b128 v120, v[184:187] offset:64
  ds_write_b128 v120, v[180:183] offset:128
  ds_write_b128 v120, v[176:179] offset:192
  s_waitcnt lgkmcnt(0)
  s_barrier
  s_waitcnt vmcnt(5)
  v_mfma_f32_16x16x32_bf16 v[188:191], a[144:147], v[236:239], 0
  s_waitcnt vmcnt(4)
  v_add_f32 v125, v20, v21
  v_mul_f32 v131, v20, v20
  v_mfma_f32_16x16x32_bf16 v[184:187], a[148:151], v[236:239], 0
  v_add_f32 v125, v125, v22
  v_fmac_f32 v131, v21, v21
  v_mfma_f32_16x16x32_bf16 v[180:183], a[152:155], v[236:239], 0
  v_add_f32 v125, v125, v23
  v_fmac_f32 v131, v22, v22
  v_mfma_f32_16x16x32_bf16 v[176:179], a[156:159], v[236:239], 0
  buffer_load_dwordx4 v[212:215], v4, s[44:47], s22 offen sc1
  s_add_u32 s22, s22, 4096
  v_mfma_f32_16x16x32_bf16 v[188:191], a[160:163], v[232:235], v[188:191]
  s_waitcnt vmcnt(4)
  v_fmac_f32 v131, v23, v23
  ds_read_b128 v[136:139], v121 offset:0
  v_mfma_f32_16x16x32_bf16 v[184:187], a[164:167], v[232:235], v[184:187]
  v_mfma_f32_16x16x32_bf16 v[180:183], a[168:171], v[232:235], v[180:183]
  ds_read_b128 v[140:143], v121 offset:4352
  v_mfma_f32_16x16x32_bf16 v[176:179], a[172:175], v[232:235], v[176:179]
  buffer_load_dwordx4 v[208:211], v4, s[44:47], s22 offen sc1
  s_add_u32 s22, s22, 4096
  v_mfma_f32_16x16x32_bf16 v[188:191], a[176:179], v[228:231], v[188:191]
  s_waitcnt vmcnt(4)
  ds_read_b128 v[144:147], v121 offset:8704
  v_mfma_f32_16x16x32_bf16 v[184:187], a[180:183], v[228:231], v[184:187]
  ds_read_b128 v[148:151], v121 offset:13056
  v_mfma_f32_16x16x32_bf16 v[180:183], a[184:187], v[228:231], v[180:183]
  ds_write_b128 v120, v[172:175] offset:17408
  v_mfma_f32_16x16x32_bf16 v[176:179], a[188:191], v[228:231], v[176:179]
  buffer_load_dwordx4 v[204:207], v4, s[44:47], s22 offen sc1
  s_add_u32 s22, s22, 4096
  v_mfma_f32_16x16x32_bf16 v[188:191], a[192:195], v[224:227], v[188:191]
  s_waitcnt vmcnt(4)
  v_mfma_f32_16x16x32_bf16 v[184:187], a[196:199], v[224:227], v[184:187]
  s_waitcnt lgkmcnt(4)
  v_add_f32 v24, v24, v136
  v_add_f32 v25, v25, v137
  v_mfma_f32_16x16x32_bf16 v[180:183], a[200:203], v[224:227], v[180:183]
  v_add_f32 v26, v26, v138
  v_add_f32 v27, v27, v139
  v_mfma_f32_16x16x32_bf16 v[176:179], a[204:207], v[224:227], v[176:179]
  buffer_load_dwordx4 v[200:203], v4, s[44:47], s22 offen sc1
  s_add_u32 s22, s22, 4096
  v_mfma_f32_16x16x32_bf16 v[188:191], a[208:211], v[220:223], v[188:191]
  s_waitcnt vmcnt(4)
  s_waitcnt lgkmcnt(3)
  v_add_f32 v24, v24, v140
  v_add_f32 v25, v25, v141
  v_mfma_f32_16x16x32_bf16 v[184:187], a[212:215], v[220:223], v[184:187]
  v_add_f32 v26, v26, v142
  v_add_f32 v27, v27, v143
  v_mfma_f32_16x16x32_bf16 v[180:183], a[216:219], v[220:223], v[180:183]
  s_waitcnt lgkmcnt(2)
  v_add_f32 v24, v24, v144
  v_add_f32 v25, v25, v145
  v_mfma_f32_16x16x32_bf16 v[176:179], a[220:223], v[220:223], v[176:179]
  buffer_load_dwordx4 v[196:199], v4, s[44:47], s22 offen sc1
  s_add_u32 s22, s22, 4096
  v_mfma_f32_16x16x32_bf16 v[188:191], a[224:227], v[216:219], v[188:191]
  s_waitcnt vmcnt(4)
  v_add_f32 v26, v26, v146
  v_add_f32 v27, v27, v147
  v_mfma_f32_16x16x32_bf16 v[184:187], a[228:231], v[216:219], v[184:187]
  s_waitcnt lgkmcnt(1)
  v_add_f32 v24, v24, v148
  v_add_f32 v25, v25, v149
  v_mfma_f32_16x16x32_bf16 v[180:183], a[232:235], v[216:219], v[180:183]
  v_add_f32 v26, v26, v150
  v_add_f32 v27, v27, v151
  v_mfma_f32_16x16x32_bf16 v[176:179], a[236:239], v[216:219], v[176:179]
  buffer_load_dwordx4 v[192:195], v4, s[44:47], s22 offen sc1
  s_add_u32 s22, s22, 4096
  v_mfma_f32_16x16x32_bf16 v[188:191], a[240:243], v[212:215], v[188:191]
  s_waitcnt vmcnt(4)
  v_add_f32 v126, v24, v25
  v_mul_f32 v132, v24, v24
  v_mfma_f32_16x16x32_bf16 v[184:187], a[244:247], v[212:215], v[184:187]
  v_add_f32 v126, v126, v26
  v_fmac_f32 v132, v25, v25
  v_mfma_f32_16x16x32_bf16 v[180:183], a[248:251], v[212:215], v[180:183]
  v_add_f32 v126, v126, v27
  v_fmac_f32 v132, v26, v26
  v_mfma_f32_16x16x32_bf16 v[176:179], a[252:255], v[212:215], v[176:179]
  buffer_load_dwordx4 v[252:255], v4, s[44:47], s22 offen sc1
  s_add_u32 s22, s22, 4096
  v_mfma_f32_16x16x32_bf16 v[188:191], v[76:79], v[208:211], v[188:191]
  s_waitcnt vmcnt(4)
  v_fmac_f32 v132, v27, v27
  v_add_u32 v153, 48, v2
  v_mfma_f32_16x16x32_bf16 v[184:187], v[80:83], v[208:211], v[184:187]
  v_add_u32 v155, 48, v2
  v_add_f32_dpp v124, v124, v124 row_ror:8 row_mask:0xf bank_mask:0xf
  v_mfma_f32_16x16x32_bf16 v[180:183], v[84:87], v[208:211], v[180:183]
  v_add_f32_dpp v125, v125, v125 row_ror:8 row_mask:0xf bank_mask:0xf
  v_add_f32_dpp v126, v126, v126 row_ror:8 row_mask:0xf bank_mask:0xf
  v_mfma_f32_16x16x32_bf16 v[176:179], v[88:91], v[208:211], v[176:179]
  buffer_load_dwordx4 v[248:251], v4, s[44:47], s22 offen sc1
  s_add_u32 s22, s22, 4096
  v_mfma_f32_16x16x32_bf16 v[188:191], v[92:95], v[204:207], v[188:191]
  v_add_f32_dpp v130, v130, v130 row_ror:8 row_mask:0xf bank_mask:0xf
  v_add_f32_dpp v131, v131, v131 row_ror:8 row_mask:0xf bank_mask:0xf
  v_mfma_f32_16x16x32_bf16 v[184:187], v[96:99], v[204:207], v[184:187]
  v_add_f32_dpp v132, v132, v132 row_ror:8 row_mask:0xf bank_mask:0xf
  v_add_f32_dpp v124, v124, v124 row_half_mirror row_mask:0xf bank_mask:0x5
  v_mfma_f32_16x16x32_bf16 v[180:183], v[100:103], v[204:207], v[180:183]
  v_add_f32_dpp v126, v126, v126 row_half_mirror row_mask:0xf bank_mask:0xf
  v_add_f32_dpp v130, v130, v130 row_half_mirror row_mask:0xf bank_mask:0x5
  v_mfma_f32_16x16x32_bf16 v[176:179], v[104:107], v[204:207], v[176:179]
  buffer_load_dwordx4 v[244:247], v4, s[44:47], s22 offen sc1
  s_add_u32 s22, s22, 4096
  ds_write_b128 v120, v[168:171] offset:17472
  ds_write_b128 v120, v[164:167] offset:17536
  ds_write_b128 v120, v[160:163] offset:17600
  s_waitcnt lgkmcnt(0)
  s_barrier
  s_waitcnt vmcnt(5)
  v_mfma_f32_16x16x32_bf16 v[172:175], a[144:147], v[200:203], 0
  s_waitcnt vmcnt(4)
  v_add_f32_dpp v132, v132, v132 row_half_mirror row_mask:0xf bank_mask:0xf
  v_add_f32_dpp v124, v125, v125 row_half_mirror row_mask:0xf bank_mask:0xa
  v_mfma_f32_16x16x32_bf16 v[168:171], a[148:151], v[200:203], 0
  v_add_f32_dpp v130, v131, v131 row_half_mirror row_mask:0xf bank_mask:0xa
  v_add_f32_dpp v126, v126, v126 quad_perm:[1,0,3,2] row_mask:0xf bank_mask:0xf
  v_mfma_f32_16x16x32_bf16 v[164:167], a[152:155], v[200:203], 0
  v_add_f32_dpp v132, v132, v132 quad_perm:[1,0,3,2] row_mask:0xf bank_mask:0xf
  v_add_f32_dpp v124, v124, v124 quad_perm:[1,0,3,2] row_mask:0xf bank_mask:0xf
  v_mfma_f32_16x16x32_bf16 v[160:163], a[156:159], v[200:203], 0
  buffer_load_dwordx4 v[240:243], v4, s[44:47], s22 offen sc1
  s_add_u32 s22, s22, 4096
  v_mfma_f32_16x16x32_bf16 v[172:175], a[160:163], v[196:199], v[172:175]
  s_waitcnt vmcnt(4)
  v_add_f32_dpp v130, v130, v130 quad_perm:[1,0,3,2] row_mask:0xf bank_mask:0xf
  v_add_f32_dpp v126, v126, v126 quad_perm:[2,3,0,1] row_mask:0xf bank_mask:0xf
  v_mfma_f32_16x16x32_bf16 v[168:171], a[164:167], v[196:199], v[168:171]
  v_add_f32_dpp v132, v132, v132 quad_perm:[2,3,0,1] row_mask:0xf bank_mask:0xf
  v_add_f32_dpp v124, v124, v124 quad_perm:[2,3,0,1] row_mask:0xf bank_mask:0xf
  v_mfma_f32_16x16x32_bf16 v[164:167], a[168:171], v[196:199], v[164:167]
  v_add_f32_dpp v130, v130, v130 quad_perm:[2,3,0,1] row_mask:0xf bank_mask:0xf
  v_cndmask_b32 v152, v124, v126, s[26:27]
  v_mfma_f32_16x16x32_bf16 v[160:163], a[172:175], v[196:199], v[160:163]
  buffer_load_dwordx4 v[236:239], v4, s[44:47], s22 offen sc1
  s_add_u32 s22, s22, 4096
  v_mfma_f32_16x16x32_bf16 v[172:175], a[176:179], v[192:195], v[172:175]
  s_waitcnt vmcnt(4)
  v_cndmask_b32 v154, v130, v132, s[26:27]
  s_cmp_eq_u32 s78, 0
  s_cbranch_scc1 L_slow_61
  s_mov_b32 s93, 655360
  s_mov_b32 exec_lo, 0xff00ff
  s_mov_b32 exec_hi, 0xff00ff
  buffer_store_dwordx4 v[152:155], v65, s[44:47], s93 offen
  s_mov_b64 exec, -1
  s_nop 0
L_back_62:
  v_mfma_f32_16x16x32_bf16 v[168:171], a[180:183], v[192:195], v[168:171]
  ds_read_b128 v[136:139], v121 offset:17408
  v_mfma_f32_16x16x32_bf16 v[164:167], a[184:187], v[192:195], v[164:167]
  ds_read_b128 v[140:143], v121 offset:21760
  v_mfma_f32_16x16x32_bf16 v[160:163], a[188:191], v[192:195], v[160:163]
  buffer_load_dwordx4 v[232:235], v4, s[44:47], s22 offen sc1
  s_add_u32 s22, s22, 4096
  v_mfma_f32_16x16x32_bf16 v[172:175], a[192:195], v[252:255], v[172:175]
  s_waitcnt vmcnt(5)
  ds_read_b128 v[144:147], v121 offset:26112
  v_mfma_f32_16x16x32_bf16 v[168:171], a[196:199], v[252:255], v[168:171]
  ds_read_b128 v[148:151], v121 offset:30464
  v_mfma_f32_16x16x32_bf16 v[164:167], a[200:203], v[252:255], v[164:167]
  ds_write_b128 v120, v[188:191] offset:34816
  v_mfma_f32_16x16x32_bf16 v[160:163], a[204:207], v[252:255], v[160:163]
  v_mfma_f32_16x16x32_bf16 v[172:175], a[208:211], v[248:251], v[172:175]
  s_waitcnt vmcnt(4)
  v_mfma_f32_16x16x32_bf16 v[168:171], a[212:215], v[248:251], v[168:171]
  v_mfma_f32_16x16x32_bf16 v[164:167], a[216:219], v[248:251], v[164:167]
  s_waitcnt lgkmcnt(4)
  v_add_f32 v28, v28, v136
  v_add_f32 v29, v29, v137
  v_mfma_f32_16x16x32_bf16 v[160:163], a[220:223], v[248:251], v[160:163]
  v_add_f32 v30, v30, v138
  v_add_f32 v31, v31, v139
  v_mfma_f32_16x16x32_bf16 v[172:175], a[224:227], v[244:247], v[172:175]
  s_waitcnt vmcnt(3)
  s_waitcnt lgkmcnt(3)
  v_add_f32 v28, v28, v140
  v_add_f32 v29, v29, v141
  v_mfma_f32_16x16x32_bf16 v[168:171], a[228:231], v[244:247], v[168:171]
  v_add_f32 v30, v30, v142
  v_add_f32 v31, v31, v143
  v_mfma_f32_16x16x32_bf16 v[164:167], a[232:235], v[244:247], v[164:167]
  s_waitcnt lgkmcnt(2)
  v_add_f32 v28, v28, v144
  v_add_f32 v29, v29, v145
  v_mfma_f32_16x16x32_bf16 v[160:163], a[236:239], v[244:247], v[160:163]
  v_add_f32 v30, v30, v146
  v_add_f32 v31, v31, v147
  v_mfma_f32_16x16x32_bf16 v[172:175], a[240:243], v[240:243], v[172:175]
  s_waitcnt vmcnt(2)
  s_waitcnt lgkmcnt(1)
  v_add_f32 v28, v28, v148
  v_add_f32 v29, v29, v149
  v_mfma_f32_16x16x32_bf16 v[168:171], a[244:247], v[240:243], v[168:171]
  v_add_f32 v30, v30, v150
  v_add_f32 v31, v31, v151
  v_mfma_f32_16x16x32_bf16 v[164:167], a[248:251], v[240:243], v[164:167]
  v_add_f32 v127, v28, v29
  v_mul_f32 v133, v28, v28
  v_mfma_f32_16x16x32_bf16 v[160:163], a[252:255], v[240:243], v[160:163]
  v_add_f32 v127, v127, v30
  v_fmac_f32 v133, v29, v29
  v_mfma_f32_16x16x32_bf16 v[172:175], v[76:79], v[236:239], v[172:175]
  s_waitcnt vmcnt(0)
  v_add_f32 v127, v127, v31
  v_fmac_f32 v133, v30, v30
  v_mfma_f32_16x16x32_bf16 v[168:171], v[80:83], v[236:239], v[168:171]
  v_fmac_f32 v133, v31, v31
  ds_write_b128 v120, v[184:187] offset:34880
  v_mfma_f32_16x16x32_bf16 v[164:167], v[84:87], v[236:239], v[164:167]
  v_mfma_f32_16x16x32_bf16 v[160:163], v[88:91], v[236:239], v[160:163]
  v_mfma_f32_16x16x32_bf16 v[172:175], v[92:95], v[232:235], v[172:175]
  v_mfma_f32_16x16x32_bf16 v[168:171], v[96:99], v[232:235], v[168:171]
  ds_write_b128 v120, v[180:183] offset:34944
  v_mfma_f32_16x16x32_bf16 v[164:167], v[100:103], v[232:235], v[164:167]
  v_mfma_f32_16x16x32_bf16 v[160:163], v[104:107], v[232:235], v[160:163]
  ds_write_b128 v120, v[176:179] offset:35008
  s_mov_b32 s93, 655360
  buffer_load_dwordx4 v[136:139], v66, s[44:47], s93 offen sc1
  s_mov_b32 s93, 659456
  buffer_load_dwordx4 v[140:143], v66, s[44:47], s93 offen sc1
  s_mov_b32 s93, 663552
  buffer_load_dwordx4 v[144:147], v66, s[44:47], s93 offen sc1
  ds_write_b128 v122, v[172:175] offset:0
  ds_write_b128 v122, v[168:171] offset:64
  ds_write_b128 v122, v[164:167] offset:128
  ds_write_b128 v122, v[160:163] offset:192
  s_waitcnt lgkmcnt(0)
  s_barrier
  ds_read_b128 v[252:255], v121 offset:34816
  ds_read_b128 v[248:251], v121 offset:39168
  ds_read_b128 v[244:247], v121 offset:43520
  ds_read_b128 v[240:243], v121 offset:47872
  ds_read_b128 v[236:239], v123 offset:0
  ds_read_b128 v[232:235], v123 offset:4352
  ds_read_b128 v[228:231], v123 offset:8704
  ds_read_b128 v[224:227], v123 offset:13056
  s_waitcnt lgkmcnt(6)
  v_pk_add_f32 v[252:253], v[252:253], v[248:249]
  s_waitcnt lgkmcnt(4)
  v_pk_add_f32 v[244:245], v[244:245], v[240:241]
  v_pk_add_f32 v[32:33], v[32:33], v[252:253]
  v_pk_add_f32 v[32:33], v[32:33], v[244:245]
  v_pk_add_f32 v[254:255], v[254:255], v[250:251]
  v_pk_add_f32 v[246:247], v[246:247], v[242:243]
  v_pk_add_f32 v[34:35], v[34:35], v[254:255]
  v_pk_add_f32 v[34:35], v[34:35], v[246:247]
  v_pk_add_f32 v[188:189], v[32:33], v[34:35]
  v_pk_mul_f32 v[190:191], v[32:33], v[32:33]
  v_add_f32 v128, v188, v189
  v_pk_fma_f32 v[190:191], v[34:35], v[34:35], v[190:191]
  v_add_f32 v134, v190, v191
  s_waitcnt lgkmcnt(2)
  v_pk_add_f32 v[236:237], v[236:237], v[232:233]
  s_waitcnt lgkmcnt(0)
  v_pk_add_f32 v[228:229], v[228:229], v[224:225]
  v_pk_add_f32 v[36:37], v[36:37], v[236:237]
  v_pk_add_f32 v[36:37], v[36:37], v[228:229]
  v_pk_add_f32 v[238:239], v[238:239], v[234:235]
  v_pk_add_f32 v[230:231], v[230:231], v[226:227]
  v_pk_add_f32 v[38:39], v[38:39], v[238:239]
  v_pk_add_f32 v[38:39], v[38:39], v[230:231]
  v_pk_add_f32 v[188:189], v[36:37], v[38:39]
  v_pk_mul_f32 v[190:191], v[36:37], v[36:37]
  v_add_f32 v129, v188, v189
  v_pk_fma_f32 v[190:191], v[38:39], v[38:39], v[190:191]
  v_add_f32 v135, v190, v191
  v_add_u32 v153, 48, v2
  v_add_u32 v155, 48, v2
  v_add_f32_dpp v127, v127, v127 row_ror:8 row_mask:0xf bank_mask:0xf
  v_add_f32_dpp v128, v128, v128 row_ror:8 row_mask:0xf bank_mask:0xf
  v_add_f32_dpp v129, v129, v129 row_ror:8 row_mask:0xf bank_mask:0xf
  v_add_f32_dpp v133, v133, v133 row_ror:8 row_mask:0xf bank_mask:0xf
  v_add_f32_dpp v134, v134, v134 row_ror:8 row_mask:0xf bank_mask:0xf
  v_add_f32_dpp v135, v135, v135 row_ror:8 row_mask:0xf bank_mask:0xf
  v_add_f32_dpp v127, v127, v127 row_half_mirror row_mask:0xf bank_mask:0x5
  v_add_f32_dpp v129, v129, v129 row_half_mirror row_mask:0xf bank_mask:0xf
  v_add_f32_dpp v133, v133, v133 row_half_mirror row_mask:0xf bank_mask:0x5
  v_add_f32_dpp v135, v135, v135 row_half_mirror row_mask:0xf bank_mask:0xf
  v_add_f32_dpp v127, v128, v128 row_half_mirror row_mask:0xf bank_mask:0xa
  v_add_f32_dpp v133, v134, v134 row_half_mirror row_mask:0xf bank_mask:0xa
  v_add_f32_dpp v129, v129, v129 quad_perm:[1,0,3,2] row_mask:0xf bank_mask:0xf
  v_add_f32_dpp v135, v135, v135 quad_perm:[1,0,3,2] row_mask:0xf bank_mask:0xf
  v_add_f32_dpp v127, v127, v127 quad_perm:[1,0,3,2] row_mask:0xf bank_mask:0xf
  v_add_f32_dpp v133, v133, v133 quad_perm:[1,0,3,2] row_mask:0xf bank_mask:0xf
  v_add_f32_dpp v129, v129, v129 quad_perm:[2,3,0,1] row_mask:0xf bank_mask:0xf
  v_add_f32_dpp v135, v135, v135 quad_perm:[2,3,0,1] row_mask:0xf bank_mask:0xf
  v_add_f32_dpp v127, v127, v127 quad_perm:[2,3,0,1] row_mask:0xf bank_mask:0xf
  v_add_f32_dpp v133, v133, v133 quad_perm:[2,3,0,1] row_mask:0xf bank_mask:0xf
  v_cndmask_b32 v152, v127, v129, s[26:27]
  v_cndmask_b32 v154, v133, v135, s[26:27]
  s_cmp_eq_u32 s78, 0
  s_cbranch_scc1 L_slow_63
  s_mov_b32 s93, 655360
  s_mov_b32 exec_lo, 0xff00ff00
  s_mov_b32 exec_hi, 0xff00ff00
  buffer_store_dwordx4 v[152:155], v65, s[44:47], s93 offen
  s_mov_b64 exec, -1
  s_nop 0
L_back_64:
  v_add_u32 v12, 48, v2
  v_cmp_gt_u32 vcc, 9, v5
  s_nop 1
  v_cndmask_b32 v12, 0, v12, vcc
  v_lshlrev_b32 v148, 16, v108
  v_and_b32 v149, 0xffff0000, v108
  v_lshlrev_b32 v150, 16, v109
  v_and_b32 v151, 0xffff0000, v109
  v_lshlrev_b32 v152, 16, v110
  v_and_b32 v153, 0xffff0000, v110
  v_lshlrev_b32 v154, 16, v111
  v_and_b32 v155, 0xffff0000, v111
  v_lshlrev_b32 v156, 16, v112
  v_and_b32 v157, 0xffff0000, v112
  v_lshlrev_b32 v158, 16, v113
  v_and_b32 v159, 0xffff0000, v113
  s_mov_b32 s83, 300000
  s_waitcnt vmcnt(1)
L_pollc_66:
  v_bitop3_b32 v13, v137, v139, v12 bitop3:0x7e
  v_bitop3_b32 v14, v141, v143, v12 bitop3:0x7e
  v_or_b32 v13, v13, v14
  v_bitop3_b32 v14, v145, v147, v12 bitop3:0x7e
  v_or_b32 v13, v13, v14
  v_cmp_ne_u32 vcc, 0, v13
  s_sub_u32 s83, s83, 1
  s_cselect_b64 vcc, 0, vcc
  s_cmp_lg_u64 vcc, 0
  s_cbranch_scc1 L_poll_65
  v_add_f32_dpp v136, v136, v136 row_ror:8 row_mask:0xf bank_mask:0xf
  v_add_f32_dpp v140, v140, v140 row_ror:8 row_mask:0xf bank_mask:0xf
  v_add_f32_dpp v144, v144, v144 row_ror:8 row_mask:0xf bank_mask:0xf
  v_add_f32_dpp v138, v138, v138 row_ror:8 row_mask:0xf bank_mask:0xf
  v_add_f32_dpp v142, v142, v142 row_ror:8 row_mask:0xf bank_mask:0xf
  v_add_f32_dpp v146, v146, v146 row_ror:8 row_mask:0xf bank_mask:0xf
  v_add_f32_dpp v136, v136, v136 row_half_mirror row_mask:0xf bank_mask:0x5
  v_add_f32_dpp v144, v144, v144 row_half_mirror row_mask:0xf bank_mask:0xf
  v_add_f32_dpp v138, v138, v138 row_half_mirror row_mask:0xf bank_mask:0x5
  v_add_f32_dpp v146, v146, v146 row_half_mirror row_mask:0xf bank_mask:0xf
  v_add_f32_dpp v136, v140, v140 row_half_mirror row_mask:0xf bank_mask:0xa
  v_add_f32_dpp v138, v142, v142 row_half_mirror row_mask:0xf bank_mask:0xa
  v_add_f32_dpp v144, v144, v144 quad_perm:[1,0,3,2] row_mask:0xf bank_mask:0xf
  v_add_f32_dpp v146, v146, v146 quad_perm:[1,0,3,2] row_mask:0xf bank_mask:0xf
  v_add_f32_dpp v136, v136, v136 quad_perm:[1,0,3,2] row_mask:0xf bank_mask:0xf
  v_add_f32_dpp v138, v138, v138 quad_perm:[1,0,3,2] row_mask:0xf bank_mask:0xf
  v_add_f32_dpp v144, v144, v144 quad_perm:[2,3,0,1] row_mask:0xf bank_mask:0xf
  v_add_f32_dpp v146, v146, v146 quad_perm:[2,3,0,1] row_mask:0xf bank_mask:0xf
  v_add_f32_dpp v136, v136, v136 quad_perm:[2,3,0,1] row_mask:0xf bank_mask:0xf
  v_add_f32_dpp v138, v138, v138 quad_perm:[2,3,0,1] row_mask:0xf bank_mask:0xf
  v_mul_f32 v160, 0x3ae38e39, v136
  v_mul_f32 v161, 0x3ae38e39, v138
  v_mul_f32 v162, 0x3ae38e39, v144
  v_mul_f32 v163, 0x3ae38e39, v146
  v_fma_f32 v161, -v160, v160, v161
  v_fma_f32 v163, -v162, v162, v163
  v_max_f32 v161, 0, v161
  v_max_f32 v163, 0, v163
  v_add_f32 v161, 0x3727c5ac, v161
  v_add_f32 v163, 0x3727c5ac, v163
  v_rsq_f32 v161, v161
  v_rsq_f32 v163, v163
  v_add_f32_dpp v62, v160, v62 quad_perm:[0,1,2,3] row_mask:0xf bank_mask:0x3
  v_add_f32_dpp v63, v162, v63 quad_perm:[0,1,2,3] row_mask:0xf bank_mask:0x3
  s_mov_b32 s93, 667648
  buffer_load_dwordx4 v[124:127], v66, s[44:47], s93 offen sc1
  s_mov_b32 s93, 671744
  buffer_load_dwordx4 v[128:131], v66, s[44:47], s93 offen sc1
  s_mov_b32 s93, 675840
  buffer_load_dwordx4 v[132:135], v66, s[44:47], s93 offen sc1
  v_mov_b64_dpp v[136:137], v[160:161] row_newbcast:0 row_mask:0xf bank_mask:0xf
  v_mov_b32_dpp v138, v62 row_newbcast:0 row_mask:0xf bank_mask:0xf
  v_mov_b64_dpp v[140:141], v[160:161] row_newbcast:4 row_mask:0xf bank_mask:0xf
  v_mov_b32_dpp v142, v62 row_newbcast:4 row_mask:0xf bank_mask:0xf
  v_mov_b64_dpp v[144:145], v[162:163] row_newbcast:0 row_mask:0xf bank_mask:0xf
  v_mov_b32_dpp v146, v63 row_newbcast:0 row_mask:0xf bank_mask:0xf
  v_pk_add_f32 v[16:17], v[16:17], v[136:137] op_sel:[0,0] op_sel_hi:[1,0] neg_lo:[0,1] neg_hi:[0,1]
  v_pk_fma_f32 v[148:149], v[148:149], v[136:137], 1.0 op_sel:[0,1,0] op_sel_hi:[1,1,0]
  v_pk_add_f32 v[18:19], v[18:19], v[136:137] op_sel:[0,0] op_sel_hi:[1,0] neg_lo:[0,1] neg_hi:[0,1]
  v_pk_fma_f32 v[150:151], v[150:151], v[136:137], 1.0 op_sel:[0,1,0] op_sel_hi:[1,1,0]
  v_pk_fma_f32 v[16:17], v[16:17], v[148:149], v[138:139] op_sel:[0,0,0] op_sel_hi:[1,1,0]
  v_pk_fma_f32 v[18:19], v[18:19], v[150:151], v[138:139] op_sel:[0,0,0] op_sel_hi:[1,1,0]
  s_movk_i32 s93, 0
  buffer_store_dwordx4 v[16:19], v64, s[68:71], s93 offen
  v_pk_add_f32 v[20:21], v[20:21], v[140:141] op_sel:[0,0] op_sel_hi:[1,0] neg_lo:[0,1] neg_hi:[0,1]
  v_pk_fma_f32 v[152:153], v[152:153], v[140:141], 1.0 op_sel:[0,1,0] op_sel_hi:[1,1,0]
  v_pk_add_f32 v[22:23], v[22:23], v[140:141] op_sel:[0,0] op_sel_hi:[1,0] neg_lo:[0,1] neg_hi:[0,1]
  v_pk_fma_f32 v[154:155], v[154:155], v[140:141], 1.0 op_sel:[0,1,0] op_sel_hi:[1,1,0]
  v_pk_fma_f32 v[20:21], v[20:21], v[152:153], v[142:143] op_sel:[0,0,0] op_sel_hi:[1,1,0]
  v_pk_fma_f32 v[22:23], v[22:23], v[154:155], v[142:143] op_sel:[0,0,0] op_sel_hi:[1,1,0]
  s_movk_i32 s93, 4608
  buffer_store_dwordx4 v[20:23], v64, s[68:71], s93 offen
  v_pk_add_f32 v[24:25], v[24:25], v[144:145] op_sel:[0,0] op_sel_hi:[1,0] neg_lo:[0,1] neg_hi:[0,1]
  v_pk_fma_f32 v[156:157], v[156:157], v[144:145], 1.0 op_sel:[0,1,0] op_sel_hi:[1,1,0]
  v_pk_add_f32 v[26:27], v[26:27], v[144:145] op_sel:[0,0] op_sel_hi:[1,0] neg_lo:[0,1] neg_hi:[0,1]
  v_pk_fma_f32 v[158:159], v[158:159], v[144:145], 1.0 op_sel:[0,1,0] op_sel_hi:[1,1,0]
  v_pk_fma_f32 v[24:25], v[24:25], v[156:157], v[146:147] op_sel:[0,0,0] op_sel_hi:[1,1,0]
  v_pk_fma_f32 v[26:27], v[26:27], v[158:159], v[146:147] op_sel:[0,0,0] op_sel_hi:[1,1,0]
  s_movk_i32 s93, 9216
  buffer_store_dwordx4 v[24:27], v64, s[68:71], s93 offen
  v_lshlrev_b32 v136, 16, v114
  v_and_b32 v137, 0xffff0000, v114
  v_lshlrev_b32 v138, 16, v115
  v_and_b32 v139, 0xffff0000, v115
  v_lshlrev_b32 v140, 16, v116
  v_and_b32 v141, 0xffff0000, v116
  v_lshlrev_b32 v142, 16, v117
  v_and_b32 v143, 0xffff0000, v117
  v_lshlrev_b32 v144, 16, v118
  v_and_b32 v145, 0xffff0000, v118
  v_lshlrev_b32 v146, 16, v119
  v_and_b32 v147, 0xffff0000, v119
  s_mov_b32 s83, 300000
  s_waitcnt vmcnt(3)
L_pollc_68:
  v_bitop3_b32 v13, v125, v127, v12 bitop3:0x7e
  v_bitop3_b32 v14, v129, v131, v12 bitop3:0x7e
  v_or_b32 v13, v13, v14
  v_bitop3_b32 v14, v133, v135, v12 bitop3:0x7e
  v_or_b32 v13, v13, v14
  v_cmp_ne_u32 vcc, 0, v13
  s_sub_u32 s83, s83, 1
  s_cselect_b64 vcc, 0, vcc
  s_cmp_lg_u64 vcc, 0
  s_cbranch_scc1 L_poll_67
  v_add_f32_dpp v124, v124, v124 row_ror:8 row_mask:0xf bank_mask:0xf
  v_add_f32_dpp v128, v128, v128 row_ror:8 row_mask:0xf bank_mask:0xf
  v_add_f32_dpp v132, v132, v132 row_ror:8 row_mask:0xf bank_mask:0xf
  v_add_f32_dpp v126, v126, v126 row_ror:8 row_mask:0xf bank_mask:0xf
  v_add_f32_dpp v130, v130, v130 row_ror:8 row_mask:0xf bank_mask:0xf
  v_add_f32_dpp v134, v134, v134 row_ror:8 row_mask:0xf bank_mask:0xf
  v_add_f32_dpp v124, v124, v124 row_half_mirror row_mask:0xf bank_mask:0x5
  v_add_f32_dpp v132, v132, v132 row_half_mirror row_mask:0xf bank_mask:0xf
  v_add_f32_dpp v126, v126, v126 row_half_mirror row_mask:0xf bank_mask:0x5
  v_add_f32_dpp v134, v134, v134 row_half_mirror row_mask:0xf bank_mask:0xf
  v_add_f32_dpp v124, v128, v128 row_half_mirror row_mask:0xf bank_mask:0xa
  v_add_f32_dpp v126, v130, v130 row_half_mirror row_mask:0xf bank_mask:0xa
  v_add_f32_dpp v132, v132, v132 quad_perm:[1,0,3,2] row_mask:0xf bank_mask:0xf
  v_add_f32_dpp v134, v134, v134 quad_perm:[1,0,3,2] row_mask:0xf bank_mask:0xf
  v_add_f32_dpp v124, v124, v124 quad_perm:[1,0,3,2] row_mask:0xf bank_mask:0xf
  v_add_f32_dpp v126, v126, v126 quad_perm:[1,0,3,2] row_mask:0xf bank_mask:0xf
  v_add_f32_dpp v132, v132, v132 quad_perm:[2,3,0,1] row_mask:0xf bank_mask:0xf
  v_add_f32_dpp v134, v134, v134 quad_perm:[2,3,0,1] row_mask:0xf bank_mask:0xf
  v_add_f32_dpp v124, v124, v124 quad_perm:[2,3,0,1] row_mask:0xf bank_mask:0xf
  v_add_f32_dpp v126, v126, v126 quad_perm:[2,3,0,1] row_mask:0xf bank_mask:0xf
  v_mul_f32 v148, 0x3ae38e39, v124
  v_mul_f32 v149, 0x3ae38e39, v126
  v_mul_f32 v150, 0x3ae38e39, v132
  v_mul_f32 v151, 0x3ae38e39, v134
  v_fma_f32 v149, -v148, v148, v149
  v_fma_f32 v151, -v150, v150, v151
  v_max_f32 v149, 0, v149
  v_max_f32 v151, 0, v151
  v_add_f32 v149, 0x3727c5ac, v149
  v_add_f32 v151, 0x3727c5ac, v151
  v_rsq_f32 v149, v149
  v_rsq_f32 v151, v151
  v_add_f32_dpp v62, v148, v62 quad_perm:[0,1,2,3] row_mask:0xf bank_mask:0xc
  v_add_f32_dpp v63, v150, v63 quad_perm:[0,1,2,3] row_mask:0xf bank_mask:0xc
  v_mov_b64_dpp v[124:125], v[148:149] row_newbcast:8 row_mask:0xf bank_mask:0xf
  v_mov_b32_dpp v126, v62 row_newbcast:8 row_mask:0xf bank_mask:0xf
  v_mov_b64_dpp v[128:129], v[148:149] row_newbcast:12 row_mask:0xf bank_mask:0xf
  v_mov_b32_dpp v130, v62 row_newbcast:12 row_mask:0xf bank_mask:0xf
  v_mov_b64_dpp v[132:133], v[150:151] row_newbcast:8 row_mask:0xf bank_mask:0xf
  v_mov_b32_dpp v134, v63 row_newbcast:8 row_mask:0xf bank_mask:0xf
  v_pk_add_f32 v[28:29], v[28:29], v[124:125] op_sel:[0,0] op_sel_hi:[1,0] neg_lo:[0,1] neg_hi:[0,1]
  v_pk_fma_f32 v[136:137], v[136:137], v[124:125], 1.0 op_sel:[0,1,0] op_sel_hi:[1,1,0]
  v_pk_add_f32 v[30:31], v[30:31], v[124:125] op_sel:[0,0] op_sel_hi:[1,0] neg_lo:[0,1] neg_hi:[0,1]
  v_pk_fma_f32 v[138:139], v[138:139], v[124:125], 1.0 op_sel:[0,1,0] op_sel_hi:[1,1,0]
  v_pk_fma_f32 v[28:29], v[28:29], v[136:137], v[126:127] op_sel:[0,0,0] op_sel_hi:[1,1,0]
  v_pk_fma_f32 v[30:31], v[30:31], v[138:139], v[126:127] op_sel:[0,0,0] op_sel_hi:[1,1,0]
  s_movk_i32 s93, 13824
  buffer_store_dwordx4 v[28:31], v64, s[68:71], s93 offen
  v_pk_add_f32 v[32:33], v[32:33], v[128:129] op_sel:[0,0] op_sel_hi:[1,0] neg_lo:[0,1] neg_hi:[0,1]
  v_pk_fma_f32 v[140:141], v[140:141], v[128:129], 1.0 op_sel:[0,1,0] op_sel_hi:[1,1,0]
  v_pk_add_f32 v[34:35], v[34:35], v[128:129] op_sel:[0,0] op_sel_hi:[1,0] neg_lo:[0,1] neg_hi:[0,1]
  v_pk_fma_f32 v[142:143], v[142:143], v[128:129], 1.0 op_sel:[0,1,0] op_sel_hi:[1,1,0]
  v_pk_fma_f32 v[32:33], v[32:33], v[140:141], v[130:131] op_sel:[0,0,0] op_sel_hi:[1,1,0]
  v_pk_fma_f32 v[34:35], v[34:35], v[142:143], v[130:131] op_sel:[0,0,0] op_sel_hi:[1,1,0]
  s_movk_i32 s93, 18432
  buffer_store_dwordx4 v[32:35], v64, s[68:71], s93 offen
  v_pk_add_f32 v[36:37], v[36:37], v[132:133] op_sel:[0,0] op_sel_hi:[1,0] neg_lo:[0,1] neg_hi:[0,1]
  v_pk_fma_f32 v[144:145], v[144:145], v[132:133], 1.0 op_sel:[0,1,0] op_sel_hi:[1,1,0]
  v_pk_add_f32 v[38:39], v[38:39], v[132:133] op_sel:[0,0] op_sel_hi:[1,0] neg_lo:[0,1] neg_hi:[0,1]
  v_pk_fma_f32 v[146:147], v[146:147], v[132:133], 1.0 op_sel:[0,1,0] op_sel_hi:[1,1,0]
  v_pk_fma_f32 v[36:37], v[36:37], v[144:145], v[134:135] op_sel:[0,0,0] op_sel_hi:[1,1,0]
  v_pk_fma_f32 v[38:39], v[38:39], v[146:147], v[134:135] op_sel:[0,0,0] op_sel_hi:[1,1,0]
  s_movk_i32 s93, 23040
  buffer_store_dwordx4 v[36:39], v64, s[68:71], s93 offen
  s_branch L_fin
  s_waitcnt vmcnt(0) lgkmcnt(0)
  s_nop 7
  s_nop 3
L_aux:
  s_waitcnt lgkmcnt(0)
  s_load_dword s80, s[42:43], 0
  s_mov_b64 s[44:45], s[42:43]
  s_mov_b32 s46, 0x10000000
  s_mov_b32 s47, 0x20000
  s_sub_u32 s76, s81, 198
  s_mul_i32 s90, s79, 58
  s_add_u32 s90, s90, s76
  s_lshl2_add_u32 s84, s76, s79
  s_mul_i32 s93, s84, 57
  s_lshr_b32 s88, s93, 10
  s_mul_i32 s85, s90, 171
  s_lshr_b32 s85, s85, 9
  s_mul_i32 s94, s88, 18
  s_sub_u32 s87, s84, s94
  s_mul_i32 s94, s85, 3
  s_sub_u32 s86, s90, s94
  s_add_u32 s86, s86, 6
  s_mov_b64 s[52:53], s[18:19]
  s_mov_b32 s54, 0xa2000
  s_mov_b32 s55, 0x20000
  s_mov_b64 s[56:57], s[20:21]
  s_mov_b32 s58, 0xa2000
  s_mov_b32 s59, 0x20000
  v_and_b32 v16, 31, v1
  s_lshl_b32 s93, s87, 6
  v_lshl_add_u32 v20, v16, 1, s93
  global_load_ushort v24, v20, s[10:11]
  global_load_ushort v25, v20, s[12:13]
  global_load_ushort v26, v20, s[22:23]
  v_lshrrev_b32 v18, 2, v1
  v_mul_u32_u24 v18, 1152, v18
  v_and_b32 v17, 3, v1
  v_lshl_add_u32 v18, v17, 4, v18
  s_mul_i32 s94, s88, 55296
  s_add_u32 s94, s94, s93
  s_add_u32 s95, s94, 0
  buffer_load_dwordx4 v[28:31], v18, s[52:55], s95 offen
  buffer_load_dwordx4 v[32:35], v18, s[56:59], s95 offen
  s_add_u32 s95, s94, 18432
  buffer_load_dwordx4 v[36:39], v18, s[52:55], s95 offen
  buffer_load_dwordx4 v[40:43], v18, s[56:59], s95 offen
  s_add_u32 s95, s94, 36864
  buffer_load_dwordx4 v[44:47], v18, s[52:55], s95 offen
  buffer_load_dwordx4 v[48:51], v18, s[56:59], s95 offen
  s_mov_b64 s[60:61], s[28:29]
  s_mov_b32 s62, 0x240000
  s_mov_b32 s63, 0x20000
  s_mov_b64 s[64:65], s[30:31]
  s_mov_b32 s66, 0x240000
  s_mov_b32 s67, 0x20000
  v_lshrrev_b32 v21, 5, v1
  s_mul_i32 s93, s85, 55296
  s_lshl_b32 s94, s86, 7
  s_add_u32 s93, s93, s94
  v_mul_u32_u24 v22, 27648, v21
  v_lshl_add_u32 v22, v16, 2, v22
  v_add_u32 v22, s93, v22
  v_subrev_u32 v23, 3456, v22
  s_lshl_b32 s94, s86, 9
  v_lshl_add_u32 v19, v16, 4, s94
  global_load_dwordx4 v[56:59], v19, s[32:33]
  s_waitcnt lgkmcnt(0)
  s_mul_i32 s80, s80, 0x9E3779B1
  s_add_u32 s80, s80, 0x7F4A7C15
  v_mov_b32 v2, s80
  s_mul_i32 s89, s79, 8192
  s_add_u32 s89, s89, 65536
  s_waitcnt vmcnt(9)
  v_lshlrev_b32 v24, 16, v24
  s_waitcnt vmcnt(8)
  v_lshlrev_b32 v25, 16, v25
  s_waitcnt vmcnt(7)
  v_lshlrev_b32 v26, 16, v26
  v_mul_f32 v26, 0x3fb8aa3b, v26
  v_exp_f32 v26, v26
  s_nop 0
  v_cvt_pk_bf16_f32 v26, v26, v26
  v_lshlrev_b32 v26, 16, v26
  v_mul_f32 v112, v26, v24
  v_mul_f32 v113, v26, v25
  v_mul_f32 v112, 0x3fb8aa3b, v112
  v_exp_f32 v112, v112
  v_mul_f32 v113, 0.15915494, v113
  v_rndne_f32 v114, v113
  v_sub_f32 v113, v113, v114
  v_cos_f32 v114, v113
  v_sin_f32 v115, v113
  v_mul_f32 v54, v112, v114
  v_mul_f32 v55, v112, v115
  v_add_f32 v112, -1.0, v54
  v_mov_b32 v113, v55
  v_mul_f32 v114, v24, v24
  v_fmac_f32 v114, v25, v25
  v_rcp_f32 v114, v114
  v_sub_f32 v25, 0, v25
  v_pk_mul_f32 v[116:117], v[112:113], v[24:25] op_sel:[0,0] op_sel_hi:[1,0]
  v_pk_fma_f32 v[116:117], v[112:113], v[24:25], v[116:117] op_sel:[1,1,0] op_sel_hi:[0,1,1] neg_lo:[1,0,0]
  v_mul_f32 v116, v116, v114
  v_mul_f32 v117, v117, v114
  v_add_f32 v116, v116, v116
  v_add_f32 v117, v117, v117
  v_lshl_add_u32 v19, v16, 3, s89
  ds_write_b64 v19, v[116:117] offset:6144
  v_lshl_add_u32 v19, v17, 6, s89
  ds_read_b128 v[120:123], v19 offset:6144
  ds_read_b128 v[124:127], v19 offset:6160
  ds_read_b128 v[128:131], v19 offset:6176
  ds_read_b128 v[132:135], v19 offset:6192
  v_lshrrev_b32 v19, 2, v1
  v_lshlrev_b32 v19, 4, v19
  v_lshl_add_u32 v24, v17, 9, v19
  v_add_u32 v24, s89, v24
  v_add_u32 v25, s89, v4
  s_waitcnt vmcnt(6)
  v_lshlrev_b32 v112, 16, v28
  s_waitcnt vmcnt(5)
  v_lshlrev_b32 v113, 16, v32
  s_waitcnt lgkmcnt(3)
  v_pk_mul_f32 v[114:115], v[112:113], v[120:121] op_sel:[0,0] op_sel_hi:[1,0]
  v_pk_fma_f32 v[114:115], v[112:113], v[120:121], v[114:115] op_sel:[1,1,0] op_sel_hi:[0,1,1] neg_lo:[1,0,0]
  v_cvt_pk_bf16_f32 v136, v114, -v115
  v_and_b32 v112, 0xffff0000, v28
  v_and_b32 v113, 0xffff0000, v32
  v_pk_mul_f32 v[114:115], v[112:113], v[122:123] op_sel:[0,0] op_sel_hi:[1,0]
  v_pk_fma_f32 v[114:115], v[112:113], v[122:123], v[114:115] op_sel:[1,1,0] op_sel_hi:[0,1,1] neg_lo:[1,0,0]
  buffer_load_dword v60, v23, s[60:63], 0 offen offset:0
  v_cvt_pk_bf16_f32 v137, v114, -v115
  v_lshlrev_b32 v112, 16, v29
  v_lshlrev_b32 v113, 16, v33
  s_waitcnt lgkmcnt(2)
  v_pk_mul_f32 v[114:115], v[112:113], v[124:125] op_sel:[0,0] op_sel_hi:[1,0]
  v_pk_fma_f32 v[114:115], v[112:113], v[124:125], v[114:115] op_sel:[1,1,0] op_sel_hi:[0,1,1] neg_lo:[1,0,0]
  v_cvt_pk_bf16_f32 v138, v114, -v115
  v_and_b32 v112, 0xffff0000, v29
  v_and_b32 v113, 0xffff0000, v33
  v_pk_mul_f32 v[114:115], v[112:113], v[126:127] op_sel:[0,0] op_sel_hi:[1,0]
  v_pk_fma_f32 v[114:115], v[112:113], v[126:127], v[114:115] op_sel:[1,1,0] op_sel_hi:[0,1,1] neg_lo:[1,0,0]
  v_cvt_pk_bf16_f32 v139, v114, -v115
  v_lshlrev_b32 v112, 16, v30
  v_lshlrev_b32 v113, 16, v34
  s_waitcnt lgkmcnt(1)
  v_pk_mul_f32 v[114:115], v[112:113], v[128:129] op_sel:[0,0] op_sel_hi:[1,0]
  v_pk_fma_f32 v[114:115], v[112:113], v[128:129], v[114:115] op_sel:[1,1,0] op_sel_hi:[0,1,1] neg_lo:[1,0,0]
  v_cvt_pk_bf16_f32 v140, v114, -v115
  v_and_b32 v112, 0xffff0000, v30
  v_and_b32 v113, 0xffff0000, v34
  v_pk_mul_f32 v[114:115], v[112:113], v[130:131] op_sel:[0,0] op_sel_hi:[1,0]
  v_pk_fma_f32 v[114:115], v[112:113], v[130:131], v[114:115] op_sel:[1,1,0] op_sel_hi:[0,1,1] neg_lo:[1,0,0]
  v_cvt_pk_bf16_f32 v141, v114, -v115
  v_lshlrev_b32 v112, 16, v31
  v_lshlrev_b32 v113, 16, v35
  buffer_load_dword v61, v23, s[60:63], 0 offen offset:1152
  s_waitcnt lgkmcnt(0)
  v_pk_mul_f32 v[114:115], v[112:113], v[132:133] op_sel:[0,0] op_sel_hi:[1,0]
  v_pk_fma_f32 v[114:115], v[112:113], v[132:133], v[114:115] op_sel:[1,1,0] op_sel_hi:[0,1,1] neg_lo:[1,0,0]
  v_cvt_pk_bf16_f32 v142, v114, -v115
  v_and_b32 v112, 0xffff0000, v31
  v_and_b32 v113, 0xffff0000, v35
  v_pk_mul_f32 v[114:115], v[112:113], v[134:135] op_sel:[0,0] op_sel_hi:[1,0]
  v_pk_fma_f32 v[114:115], v[112:113], v[134:135], v[114:115] op_sel:[1,1,0] op_sel_hi:[0,1,1] neg_lo:[1,0,0]
  v_cvt_pk_bf16_f32 v143, v114, -v115
  ds_write_b128 v24, v[136:139] offset:0
  ds_write_b128 v24, v[140:143] offset:256
  ds_read_b128 v[144:147], v25 offset:0
  ds_read_b128 v[148:151], v25 offset:1024
  s_waitcnt vmcnt(6)
  v_lshlrev_b32 v112, 16, v36
  s_waitcnt vmcnt(5)
  v_lshlrev_b32 v113, 16, v40
  v_pk_mul_f32 v[114:115], v[112:113], v[120:121] op_sel:[0,0] op_sel_hi:[1,0]
  v_pk_fma_f32 v[114:115], v[112:113], v[120:121], v[114:115] op_sel:[1,1,0] op_sel_hi:[0,1,1] neg_lo:[1,0,0]
  v_cvt_pk_bf16_f32 v136, v114, -v115
  v_and_b32 v112, 0xffff0000, v36
  v_and_b32 v113, 0xffff0000, v40
  v_pk_mul_f32 v[114:115], v[112:113], v[122:123] op_sel:[0,0] op_sel_hi:[1,0]
  v_pk_fma_f32 v[114:115], v[112:113], v[122:123], v[114:115] op_sel:[1,1,0] op_sel_hi:[0,1,1] neg_lo:[1,0,0]
  v_cvt_pk_bf16_f32 v137, v114, -v115
  v_lshlrev_b32 v112, 16, v37
  buffer_load_dword v62, v23, s[60:63], 0 offen offset:2304
  v_lshlrev_b32 v113, 16, v41
  v_pk_mul_f32 v[114:115], v[112:113], v[124:125] op_sel:[0,0] op_sel_hi:[1,0]
  v_pk_fma_f32 v[114:115], v[112:113], v[124:125], v[114:115] op_sel:[1,1,0] op_sel_hi:[0,1,1] neg_lo:[1,0,0]
  v_cvt_pk_bf16_f32 v138, v114, -v115
  v_and_b32 v112, 0xffff0000, v37
  v_and_b32 v113, 0xffff0000, v41
  v_pk_mul_f32 v[114:115], v[112:113], v[126:127] op_sel:[0,0] op_sel_hi:[1,0]
  v_pk_fma_f32 v[114:115], v[112:113], v[126:127], v[114:115] op_sel:[1,1,0] op_sel_hi:[0,1,1] neg_lo:[1,0,0]
  v_cvt_pk_bf16_f32 v139, v114, -v115
  v_lshlrev_b32 v112, 16, v38
  v_lshlrev_b32 v113, 16, v42
  v_pk_mul_f32 v[114:115], v[112:113], v[128:129] op_sel:[0,0] op_sel_hi:[1,0]
  v_pk_fma_f32 v[114:115], v[112:113], v[128:129], v[114:115] op_sel:[1,1,0] op_sel_hi:[0,1,1] neg_lo:[1,0,0]
  v_cvt_pk_bf16_f32 v140, v114, -v115
  v_and_b32 v112, 0xffff0000, v38
  v_and_b32 v113, 0xffff0000, v42
  v_pk_mul_f32 v[114:115], v[112:113], v[130:131] op_sel:[0,0] op_sel_hi:[1,0]
  v_pk_fma_f32 v[114:115], v[112:113], v[130:131], v[114:115] op_sel:[1,1,0] op_sel_hi:[0,1,1] neg_lo:[1,0,0]
  v_cvt_pk_bf16_f32 v141, v114, -v115
  v_lshlrev_b32 v112, 16, v39
  v_lshlrev_b32 v113, 16, v43
  v_pk_mul_f32 v[114:115], v[112:113], v[132:133] op_sel:[0,0] op_sel_hi:[1,0]
  v_pk_fma_f32 v[114:115], v[112:113], v[132:133], v[114:115] op_sel:[1,1,0] op_sel_hi:[0,1,1] neg_lo:[1,0,0]
  s_mov_b32 s5, 0
  buffer_load_dword v63, v22, s[60:63], s5 offen offset:0
  buffer_load_dword v87, v22, s[64:67], s5 offen offset:0
  buffer_load_dword v64, v22, s[60:63], s5 offen offset:1152
  buffer_load_dword v88, v22, s[64:67], s5 offen offset:1152
  buffer_load_dword v65, v22, s[60:63], s5 offen offset:2304
  buffer_load_dword v89, v22, s[64:67], s5 offen offset:2304
  v_cvt_pk_bf16_f32 v142, v114, -v115
  v_and_b32 v112, 0xffff0000, v39
  v_and_b32 v113, 0xffff0000, v43
  v_pk_mul_f32 v[114:115], v[112:113], v[134:135] op_sel:[0,0] op_sel_hi:[1,0]
  v_pk_fma_f32 v[114:115], v[112:113], v[134:135], v[114:115] op_sel:[1,1,0] op_sel_hi:[0,1,1] neg_lo:[1,0,0]
  v_cvt_pk_bf16_f32 v143, v114, -v115
  ds_write_b128 v24, v[136:139] offset:2048
  ds_write_b128 v24, v[140:143] offset:2304
  ds_read_b128 v[152:155], v25 offset:2048
  ds_read_b128 v[156:159], v25 offset:3072
  s_waitcnt vmcnt(11)
  v_lshlrev_b32 v112, 16, v44
  s_waitcnt vmcnt(10)
  v_lshlrev_b32 v113, 16, v48
  v_pk_mul_f32 v[114:115], v[112:113], v[120:121] op_sel:[0,0] op_sel_hi:[1,0]
  v_pk_fma_f32 v[114:115], v[112:113], v[120:121], v[114:115] op_sel:[1,1,0] op_sel_hi:[0,1,1] neg_lo:[1,0,0]
  v_cvt_pk_bf16_f32 v136, v114, -v115
  v_and_b32 v112, 0xffff0000, v44
  v_and_b32 v113, 0xffff0000, v48
  v_pk_mul_f32 v[114:115], v[112:113], v[122:123] op_sel:[0,0] op_sel_hi:[1,0]
  v_pk_fma_f32 v[114:115], v[112:113], v[122:123], v[114:115] op_sel:[1,1,0] op_sel_hi:[0,1,1] neg_lo:[1,0,0]
  v_cvt_pk_bf16_f32 v137, v114, -v115
  v_lshlrev_b32 v112, 16, v45
  v_lshlrev_b32 v113, 16, v49
  v_pk_mul_f32 v[114:115], v[112:113], v[124:125] op_sel:[0,0] op_sel_hi:[1,0]
  s_mov_b32 s5, 3456
  buffer_load_dword v66, v22, s[60:63], s5 offen offset:0
  buffer_load_dword v90, v22, s[64:67], s5 offen offset:0
  buffer_load_dword v67, v22, s[60:63], s5 offen offset:1152
  buffer_load_dword v91, v22, s[64:67], s5 offen offset:1152
  buffer_load_dword v68, v22, s[60:63], s5 offen offset:2304
  buffer_load_dword v92, v22, s[64:67], s5 offen offset:2304
  v_pk_fma_f32 v[114:115], v[112:113], v[124:125], v[114:115] op_sel:[1,1,0] op_sel_hi:[0,1,1] neg_lo:[1,0,0]
  v_cvt_pk_bf16_f32 v138, v114, -v115
  v_and_b32 v112, 0xffff0000, v45
  v_and_b32 v113, 0xffff0000, v49
  v_pk_mul_f32 v[114:115], v[112:113], v[126:127] op_sel:[0,0] op_sel_hi:[1,0]
  v_pk_fma_f32 v[114:115], v[112:113], v[126:127], v[114:115] op_sel:[1,1,0] op_sel_hi:[0,1,1] neg_lo:[1,0,0]
  v_cvt_pk_bf16_f32 v139, v114, -v115
  v_lshlrev_b32 v112, 16, v46
  v_lshlrev_b32 v113, 16, v50
  v_pk_mul_f32 v[114:115], v[112:113], v[128:129] op_sel:[0,0] op_sel_hi:[1,0]
  v_pk_fma_f32 v[114:115], v[112:113], v[128:129], v[114:115] op_sel:[1,1,0] op_sel_hi:[0,1,1] neg_lo:[1,0,0]
  v_cvt_pk_bf16_f32 v140, v114, -v115
  v_and_b32 v112, 0xffff0000, v46
  v_and_b32 v113, 0xffff0000, v50
  v_pk_mul_f32 v[114:115], v[112:113], v[130:131] op_sel:[0,0] op_sel_hi:[1,0]
  v_pk_fma_f32 v[114:115], v[112:113], v[130:131], v[114:115] op_sel:[1,1,0] op_sel_hi:[0,1,1] neg_lo:[1,0,0]
  v_cvt_pk_bf16_f32 v141, v114, -v115
  v_lshlrev_b32 v112, 16, v47
  v_lshlrev_b32 v113, 16, v51
  v_pk_mul_f32 v[114:115], v[112:113], v[132:133] op_sel:[0,0] op_sel_hi:[1,0]
  v_pk_fma_f32 v[114:115], v[112:113], v[132:133], v[114:115] op_sel:[1,1,0] op_sel_hi:[0,1,1] neg_lo:[1,0,0]
  v_cvt_pk_bf16_f32 v142, v114, -v115
  v_and_b32 v112, 0xffff0000, v47
  v_and_b32 v113, 0xffff0000, v51
  v_pk_mul_f32 v[114:115], v[112:113], v[134:135] op_sel:[0,0] op_sel_hi:[1,0]
  v_pk_fma_f32 v[114:115], v[112:113], v[134:135], v[114:115] op_sel:[1,1,0] op_sel_hi:[0,1,1] neg_lo:[1,0,0]
  v_cvt_pk_bf16_f32 v143, v114, -v115
  ds_write_b128 v24, v[136:139] offset:4096
  ds_write_b128 v24, v[140:143] offset:4352
  ds_read_b128 v[160:163], v25 offset:4096
  ds_read_b128 v[164:167], v25 offset:5120
  s_and_b32 s93, s87, 1
  s_mul_i32 s93, s93, 75776
  s_lshr_b32 s94, s87, 1
  s_lshl_b32 s94, s94, 12
  s_add_u32 s93, s93, s94
  s_add_u32 s93, s93, 5505024
  s_cmp_lt_u32 s84, 216
  s_cselect_b32 s93, s93, 0x40000000
  s_mul_i32 s94, s88, 3
  s_add_u32 s94, s94, 0
  s_lshr_b32 s95, s94, 2
  s_mul_i32 s95, s95, 151552
  s_and_b32 s94, s94, 3
  s_lshl_b32 s94, s94, 10
  s_add_u32 s94, s94, s95
  s_add_u32 s94, s94, s93
  s_add_u32 s95, s94, 37888
  s_waitcnt lgkmcnt(9)
  buffer_store_dwordx4 v[144:147], v4, s[44:47], s94 offen sc1
  s_waitcnt lgkmcnt(8)
  buffer_store_dwordx4 v[148:151], v4, s[44:47], s95 offen sc1
  s_mul_i32 s94, s88, 3
  s_add_u32 s94, s94, 1
  s_lshr_b32 s95, s94, 2
  s_mul_i32 s95, s95, 151552
  s_and_b32 s94, s94, 3
  s_lshl_b32 s94, s94, 10
  s_add_u32 s94, s94, s95
  s_add_u32 s94, s94, s93
  s_add_u32 s95, s94, 37888
  s_waitcnt lgkmcnt(5)
  buffer_store_dwordx4 v[152:155], v4, s[44:47], s94 offen sc1
  s_waitcnt lgkmcnt(4)
  buffer_store_dwordx4 v[156:159], v4, s[44:47], s95 offen sc1
  s_mul_i32 s94, s88, 3
  s_add_u32 s94, s94, 2
  s_lshr_b32 s95, s94, 2
  s_mul_i32 s95, s95, 151552
  s_and_b32 s94, s94, 3
  s_lshl_b32 s94, s94, 10
  s_add_u32 s94, s94, s95
  s_add_u32 s94, s94, s93
  s_add_u32 s95, s94, 37888
  s_waitcnt lgkmcnt(1)
  buffer_store_dwordx4 v[160:163], v4, s[44:47], s94 offen sc1
  s_waitcnt lgkmcnt(0)
  buffer_store_dwordx4 v[164:167], v4, s[44:47], s95 offen sc1
  s_nop 1
  s_mov_b32 s5, 6912
  buffer_load_dword v69, v22, s[60:63], s5 offen offset:0
  buffer_load_dword v93, v22, s[64:67], s5 offen offset:0
  buffer_load_dword v70, v22, s[60:63], s5 offen offset:1152
  buffer_load_dword v94, v22, s[64:67], s5 offen offset:1152
  buffer_load_dword v71, v22, s[60:63], s5 offen offset:2304
  buffer_load_dword v95, v22, s[64:67], s5 offen offset:2304
  s_mov_b32 s5, 10368
  buffer_load_dword v72, v22, s[60:63], s5 offen offset:0
  buffer_load_dword v96, v22, s[64:67], s5 offen offset:0
  buffer_load_dword v73, v22, s[60:63], s5 offen offset:1152
  buffer_load_dword v97, v22, s[64:67], s5 offen offset:1152
  buffer_load_dword v74, v22, s[60:63], s5 offen offset:2304
  buffer_load_dword v98, v22, s[64:67], s5 offen offset:2304
  s_mov_b32 s5, 13824
  buffer_load_dword v75, v22, s[60:63], s5 offen offset:0
  buffer_load_dword v99, v22, s[64:67], s5 offen offset:0
  buffer_load_dword v76, v22, s[60:63], s5 offen offset:1152
  buffer_load_dword v100, v22, s[64:67], s5 offen offset:1152
  buffer_load_dword v77, v22, s[60:63], s5 offen offset:2304
  buffer_load_dword v101, v22, s[64:67], s5 offen offset:2304
  s_mov_b32 s5, 17280
  buffer_load_dword v78, v22, s[60:63], s5 offen offset:0
  buffer_load_dword v102, v22, s[64:67], s5 offen offset:0
  buffer_load_dword v79, v22, s[60:63], s5 offen offset:1152
  buffer_load_dword v103, v22, s[64:67], s5 offen offset:1152
  buffer_load_dword v80, v22, s[60:63], s5 offen offset:2304
  buffer_load_dword v104, v22, s[64:67], s5 offen offset:2304
  s_mov_b32 s5, 20736
  buffer_load_dword v81, v22, s[60:63], s5 offen offset:0
  buffer_load_dword v105, v22, s[64:67], s5 offen offset:0
  buffer_load_dword v82, v22, s[60:63], s5 offen offset:1152
  buffer_load_dword v106, v22, s[64:67], s5 offen offset:1152
  buffer_load_dword v83, v22, s[60:63], s5 offen offset:2304
  buffer_load_dword v107, v22, s[64:67], s5 offen offset:2304
  s_mov_b32 s5, 24192
  buffer_load_dword v84, v22, s[60:63], s5 offen offset:0
  buffer_load_dword v108, v22, s[64:67], s5 offen offset:0
  buffer_load_dword v85, v22, s[60:63], s5 offen offset:1152
  buffer_load_dword v109, v22, s[64:67], s5 offen offset:1152
  buffer_load_dword v86, v22, s[60:63], s5 offen offset:2304
  buffer_load_dword v110, v22, s[64:67], s5 offen offset:2304
  v_sub_u32 v21, 1, v21
  v_lshlrev_b32 v21, 6, v21
  v_mul_u32_u24 v52, 272, v16
  s_mul_i32 s89, s79, 8704
  v_add3_u32 v52, v52, v21, s89
  s_waitcnt vmcnt(36)
  v_mov_b32 v53, 0x3f803f80
  v_mov_b32 v51, v2
  v_mov_b32 v131, v2
  v_lshlrev_b32 v24, 16, v56
  v_lshlrev_b32 v25, 16, v58
  v_and_b32 v26, 0xffff0000, v56
  v_and_b32 v27, 0xffff0000, v58
  v_lshlrev_b32 v28, 16, v57
  v_lshlrev_b32 v29, 16, v59
  v_and_b32 v30, 0xffff0000, v57
  v_and_b32 v31, 0xffff0000, v59
  v_lshlrev_b32 v32, 16, v60
  v_and_b32 v33, 0xffff0000, v60
  v_lshlrev_b32 v34, 16, v61
  v_and_b32 v35, 0xffff0000, v61
  v_lshlrev_b32 v36, 16, v62
  v_and_b32 v37, 0xffff0000, v62
  v_lshlrev_b32 v38, 16, v63
  v_and_b32 v39, 0xffff0000, v63
  s_lshl_b32 s93, s84, 4
  s_add_u32 s93, s93, 49152
  s_mov_b64 exec, 1
  buffer_store_dword v2, v10, s[44:47], s93 offen sc1
  s_mov_b64 exec, -1
  v_lshlrev_b32 v40, 16, v64
  v_and_b32 v41, 0xffff0000, v64
  v_pk_mul_f32 v[112:113], v[38:39], v[24:25]
  v_pk_mul_f32 v[114:115], v[36:37], v[26:27]
  v_pk_mul_f32 v[116:117], v[34:35], v[28:29]
  v_pk_mul_f32 v[118:119], v[32:33], v[30:31]
  v_pk_mul_f32 v[120:121], v[40:41], v[24:25]
  v_pk_mul_f32 v[122:123], v[38:39], v[26:27]
  v_pk_mul_f32 v[124:125], v[36:37], v[28:29]
  v_pk_mul_f32 v[126:127], v[34:35], v[30:31]
  v_cvt_pk_bf16_f32 v44, v118, v116
  v_cvt_pk_bf16_f32 v45, v119, v117
  v_cvt_pk_bf16_f32 v46, v126, v124
  v_cvt_pk_bf16_f32 v47, v127, v125
  v_dot2_f32_bf16 v44, v44, v53, 0
  v_dot2_f32_bf16 v45, v45, v53, 0
  v_dot2_f32_bf16 v46, v46, v53, 0
  v_dot2_f32_bf16 v47, v47, v53, 0
  v_cvt_pk_bf16_f32 v44, v44, v114
  s_lshl1_add_u32 s93, s82, s4
  s_lshl_b32 s94, s93, 12
  s_add_u32 s72, s34, s94
  s_addc_u32 s73, s35, 0
  s_and_b32 s73, s73, 0xffff
  s_mov_b32 s74, 4096
  s_mov_b32 s75, 0x20000
  v_cvt_pk_bf16_f32 v45, v45, v115
  v_cvt_pk_bf16_f32 v46, v46, v122
  v_cvt_pk_bf16_f32 v47, v47, v123
  v_dot2_f32_bf16 v44, v44, v53, 0
  v_dot2_f32_bf16 v45, v45, v53, 0
  v_dot2_f32_bf16 v46, v46, v53, 0
  v_dot2_f32_bf16 v47, v47, v53, 0
  v_cvt_pk_bf16_f32 v44, v44, v112
  v_cvt_pk_bf16_f32 v45, v45, v113
  v_cvt_pk_bf16_f32 v46, v46, v120
  v_cvt_pk_bf16_f32 v47, v47, v121
  v_dot2_f32_bf16 v44, v44, v53, 0
  v_dot2_f32_bf16 v45, v45, v53, 0
  v_dot2_f32_bf16 v46, v46, v53, 0
  v_dot2_f32_bf16 v47, v47, v53, 0
  v_cvt_pk_bf16_f32 v44, v44, 0
  v_cvt_pk_bf16_f32 v45, 0, v45
  v_cvt_pk_bf16_f32 v46, v46, 0
  v_cvt_pk_bf16_f32 v47, 0, v47
  s_lshl_b32 s94, s82, 2
  v_mov_b32 v254, s94
  global_load_dword v254, v254, s[36:37]
  v_dot2_f32_bf16 v44, v44, v87, 0
  v_dot2_f32_bf16 v45, v45, v87, 0
  v_dot2_f32_bf16 v46, v46, v88, 0
  v_dot2_f32_bf16 v47, v47, v88, 0
  s_nop 1
  v_cvt_pk_bf16_f32 v50, v46, v44
  v_cvt_pk_bf16_f32 v130, v47, v45
  v_lshlrev_b32 v42, 16, v65
  v_and_b32 v43, 0xffff0000, v65
  v_lshlrev_b32 v32, 16, v66
  v_and_b32 v33, 0xffff0000, v66
  v_pk_mul_f32 v[112:113], v[42:43], v[24:25]
  v_pk_mul_f32 v[114:115], v[40:41], v[26:27]
  v_pk_mul_f32 v[116:117], v[38:39], v[28:29]
  v_pk_mul_f32 v[118:119], v[36:37], v[30:31]
  v_pk_mul_f32 v[120:121], v[32:33], v[24:25]
  v_pk_mul_f32 v[122:123], v[42:43], v[26:27]
  v_pk_mul_f32 v[124:125], v[40:41], v[28:29]
  v_pk_mul_f32 v[126:127], v[38:39], v[30:31]
  v_cvt_pk_bf16_f32 v44, v118, v116
  v_cvt_pk_bf16_f32 v45, v119, v117
  v_add_u32 v253, v5, v6
  v_subrev_u32 v253, 16, v253
  v_lshlrev_b32 v253, 2, v253
  buffer_load_dword v253, v253, s[72:75], 0 offen
  v_cvt_pk_bf16_f32 v46, v126, v124
  v_cvt_pk_bf16_f32 v47, v127, v125
  v_dot2_f32_bf16 v44, v44, v53, 0
  v_dot2_f32_bf16 v45, v45, v53, 0
  v_dot2_f32_bf16 v46, v46, v53, 0
  v_dot2_f32_bf16 v47, v47, v53, 0
  v_cvt_pk_bf16_f32 v44, v44, v114
  v_cvt_pk_bf16_f32 v45, v45, v115
  v_cvt_pk_bf16_f32 v46, v46, v122
  v_cvt_pk_bf16_f32 v47, v47, v123
  v_dot2_f32_bf16 v44, v44, v53, 0
  v_dot2_f32_bf16 v45, v45, v53, 0
  v_dot2_f32_bf16 v46, v46, v53, 0
  v_dot2_f32_bf16 v47, v47, v53, 0
  v_cvt_pk_bf16_f32 v44, v44, v112
  v_cvt_pk_bf16_f32 v45, v45, v113
  v_cvt_pk_bf16_f32 v46, v46, v120
  v_cvt_pk_bf16_f32 v47, v47, v121
  v_dot2_f32_bf16 v44, v44, v53, 0
  s_mul_i32 s95, s4, 16656
  s_mul_i32 s96, s3, 8336
  s_add_u32 s96, s96, s95
  s_add_u32 m0, s96, 110656
  s_lshl_b32 s5, s3, 3
  s_add_u32 s5, s5, 0
  v_dot2_f32_bf16 v45, v45, v53, 0
  v_dot2_f32_bf16 v46, v46, v53, 0
  v_dot2_f32_bf16 v47, v47, v53, 0
  v_cvt_pk_bf16_f32 v44, v44, 0
  v_cvt_pk_bf16_f32 v45, 0, v45
  v_cvt_pk_bf16_f32 v46, v46, 0
  v_cvt_pk_bf16_f32 v47, 0, v47
  v_dot2_f32_bf16 v44, v44, v89, 0
  v_dot2_f32_bf16 v45, v45, v89, 0
  v_dot2_f32_bf16 v46, v46, v90, 0
  v_dot2_f32_bf16 v47, v47, v90, 0
  s_nop 1
  v_cvt_pk_bf16_f32 v49, v46, v44
  v_cvt_pk_bf16_f32 v129, v47, v45
  v_lshlrev_b32 v34, 16, v67
  v_and_b32 v35, 0xffff0000, v67
  v_lshlrev_b32 v36, 16, v68
  v_and_b32 v37, 0xffff0000, v68
  v_pk_mul_f32 v[112:113], v[34:35], v[24:25]
  v_pk_mul_f32 v[114:115], v[32:33], v[26:27]
  buffer_load_dwordx4 v4, s[72:75], s5 offen offset:0 lds
  v_pk_mul_f32 v[116:117], v[42:43], v[28:29]
  v_pk_mul_f32 v[118:119], v[40:41], v[30:31]
  v_pk_mul_f32 v[120:121], v[36:37], v[24:25]
  v_pk_mul_f32 v[122:123], v[34:35], v[26:27]
  v_pk_mul_f32 v[124:125], v[32:33], v[28:29]
  v_pk_mul_f32 v[126:127], v[42:43], v[30:31]
  v_cvt_pk_bf16_f32 v44, v118, v116
  v_cvt_pk_bf16_f32 v45, v119, v117
  v_cvt_pk_bf16_f32 v46, v126, v124
  v_cvt_pk_bf16_f32 v47, v127, v125
  v_dot2_f32_bf16 v44, v44, v53, 0
  v_dot2_f32_bf16 v45, v45, v53, 0
  v_dot2_f32_bf16 v46, v46, v53, 0
  v_dot2_f32_bf16 v47, v47, v53, 0
  v_cvt_pk_bf16_f32 v44, v44, v114
  v_cvt_pk_bf16_f32 v45, v45, v115
  v_cvt_pk_bf16_f32 v46, v46, v122
  v_cvt_pk_bf16_f32 v47, v47, v123
  v_dot2_f32_bf16 v44, v44, v53, 0
  v_dot2_f32_bf16 v45, v45, v53, 0
  buffer_load_dwordx4 v4, s[72:75], s5 offen offset:1024 lds
  v_dot2_f32_bf16 v46, v46, v53, 0
  v_dot2_f32_bf16 v47, v47, v53, 0
  v_cvt_pk_bf16_f32 v44, v44, v112
  v_cvt_pk_bf16_f32 v45, v45, v113
  v_cvt_pk_bf16_f32 v46, v46, v120
  v_cvt_pk_bf16_f32 v47, v47, v121
  v_dot2_f32_bf16 v44, v44, v53, 0
  v_dot2_f32_bf16 v45, v45, v53, 0
  v_dot2_f32_bf16 v46, v46, v53, 0
  v_dot2_f32_bf16 v47, v47, v53, 0
  v_cvt_pk_bf16_f32 v44, v44, 0
  v_cvt_pk_bf16_f32 v45, 0, v45
  v_cvt_pk_bf16_f32 v46, v46, 0
  v_cvt_pk_bf16_f32 v47, 0, v47
  v_dot2_f32_bf16 v44, v44, v91, 0
  v_dot2_f32_bf16 v45, v45, v91, 0
  v_dot2_f32_bf16 v46, v46, v92, 0
  v_dot2_f32_bf16 v47, v47, v92, 0
  s_nop 1
  v_cvt_pk_bf16_f32 v48, v46, v44
  buffer_load_dwordx4 v4, s[72:75], s5 offen offset:2048 lds
  v_cvt_pk_bf16_f32 v128, v47, v45
  ds_write_b128 v52, v[48:51] offset:48
  ds_write_b128 v52, v[128:131] offset:176
  s_waitcnt vmcnt(30)
  v_lshlrev_b32 v38, 16, v69
  v_and_b32 v39, 0xffff0000, v69
  v_lshlrev_b32 v40, 16, v70
  v_and_b32 v41, 0xffff0000, v70
  v_pk_mul_f32 v[112:113], v[38:39], v[24:25]
  v_pk_mul_f32 v[114:115], v[36:37], v[26:27]
  v_pk_mul_f32 v[116:117], v[34:35], v[28:29]
  v_pk_mul_f32 v[118:119], v[32:33], v[30:31]
  v_pk_mul_f32 v[120:121], v[40:41], v[24:25]
  v_pk_mul_f32 v[122:123], v[38:39], v[26:27]
  v_pk_mul_f32 v[124:125], v[36:37], v[28:29]
  v_pk_mul_f32 v[126:127], v[34:35], v[30:31]
  v_cvt_pk_bf16_f32 v44, v118, v116
  v_cvt_pk_bf16_f32 v45, v119, v117
  v_cvt_pk_bf16_f32 v46, v126, v124
  buffer_load_dwordx4 v4, s[72:75], s5 offen offset:3072 lds
  v_cvt_pk_bf16_f32 v47, v127, v125
  v_dot2_f32_bf16 v44, v44, v53, 0
  v_dot2_f32_bf16 v45, v45, v53, 0
  v_dot2_f32_bf16 v46, v46, v53, 0
  v_dot2_f32_bf16 v47, v47, v53, 0
  v_cvt_pk_bf16_f32 v44, v44, v114
  v_cvt_pk_bf16_f32 v45, v45, v115
  v_cvt_pk_bf16_f32 v46, v46, v122
  v_cvt_pk_bf16_f32 v47, v47, v123
  v_dot2_f32_bf16 v44, v44, v53, 0
  v_dot2_f32_bf16 v45, v45, v53, 0
  v_dot2_f32_bf16 v46, v46, v53, 0
  v_dot2_f32_bf16 v47, v47, v53, 0
  v_cvt_pk_bf16_f32 v44, v44, v112
  v_cvt_pk_bf16_f32 v45, v45, v113
  v_cvt_pk_bf16_f32 v46, v46, v120
  v_cvt_pk_bf16_f32 v47, v47, v121
  v_dot2_f32_bf16 v44, v44, v53, 0
  v_dot2_f32_bf16 v45, v45, v53, 0
  v_dot2_f32_bf16 v46, v46, v53, 0
  s_mul_i32 s95, s4, 16656
  s_mul_i32 s96, s3, 8320
  s_add_u32 s96, s96, s95
  s_add_u32 m0, s96, 114832
  s_lshl_b32 s5, s3, 3
  s_add_u32 s5, s5, 4
  v_dot2_f32_bf16 v47, v47, v53, 0
  v_cvt_pk_bf16_f32 v44, v44, 0
  v_cvt_pk_bf16_f32 v45, 0, v45
  v_cvt_pk_bf16_f32 v46, v46, 0
  v_cvt_pk_bf16_f32 v47, 0, v47
  v_dot2_f32_bf16 v44, v44, v93, 0
  v_dot2_f32_bf16 v45, v45, v93, 0
  v_dot2_f32_bf16 v46, v46, v94, 0
  v_dot2_f32_bf16 v47, v47, v94, 0
  s_nop 1
  v_cvt_pk_bf16_f32 v50, v46, v44
  v_cvt_pk_bf16_f32 v130, v47, v45
  v_lshlrev_b32 v42, 16, v71
  v_and_b32 v43, 0xffff0000, v71
  v_lshlrev_b32 v32, 16, v72
  v_and_b32 v33, 0xffff0000, v72
  v_pk_mul_f32 v[112:113], v[42:43], v[24:25]
  v_pk_mul_f32 v[114:115], v[40:41], v[26:27]
  v_pk_mul_f32 v[116:117], v[38:39], v[28:29]
  v_pk_mul_f32 v[118:119], v[36:37], v[30:31]
  buffer_load_dwordx4 v4, s[72:75], s5 offen offset:0 lds
  v_pk_mul_f32 v[120:121], v[32:33], v[24:25]
  v_pk_mul_f32 v[122:123], v[42:43], v[26:27]
  v_pk_mul_f32 v[124:125], v[40:41], v[28:29]
  v_pk_mul_f32 v[126:127], v[38:39], v[30:31]
  v_cvt_pk_bf16_f32 v44, v118, v116
  v_cvt_pk_bf16_f32 v45, v119, v117
  v_cvt_pk_bf16_f32 v46, v126, v124
  v_cvt_pk_bf16_f32 v47, v127, v125
  v_dot2_f32_bf16 v44, v44, v53, 0
  v_dot2_f32_bf16 v45, v45, v53, 0
  v_dot2_f32_bf16 v46, v46, v53, 0
  v_dot2_f32_bf16 v47, v47, v53, 0
  v_cvt_pk_bf16_f32 v44, v44, v114
  v_cvt_pk_bf16_f32 v45, v45, v115
  v_cvt_pk_bf16_f32 v46, v46, v122
  v_cvt_pk_bf16_f32 v47, v47, v123
  v_dot2_f32_bf16 v44, v44, v53, 0
  v_dot2_f32_bf16 v45, v45, v53, 0
  v_dot2_f32_bf16 v46, v46, v53, 0
  buffer_load_dwordx4 v4, s[72:75], s5 offen offset:1024 lds
  v_dot2_f32_bf16 v47, v47, v53, 0
  v_cvt_pk_bf16_f32 v44, v44, v112
  v_cvt_pk_bf16_f32 v45, v45, v113
  v_cvt_pk_bf16_f32 v46, v46, v120
  v_cvt_pk_bf16_f32 v47, v47, v121
  v_dot2_f32_bf16 v44, v44, v53, 0
  v_dot2_f32_bf16 v45, v45, v53, 0
  v_dot2_f32_bf16 v46, v46, v53, 0
  v_dot2_f32_bf16 v47, v47, v53, 0
  v_cvt_pk_bf16_f32 v44, v44, 0
  v_cvt_pk_bf16_f32 v45, 0, v45
  v_cvt_pk_bf16_f32 v46, v46, 0
  v_cvt_pk_bf16_f32 v47, 0, v47
  v_dot2_f32_bf16 v44, v44, v95, 0
  v_dot2_f32_bf16 v45, v45, v95, 0
  v_dot2_f32_bf16 v46, v46, v96, 0
  v_dot2_f32_bf16 v47, v47, v96, 0
  s_nop 1
  v_cvt_pk_bf16_f32 v49, v46, v44
  v_cvt_pk_bf16_f32 v129, v47, v45
  v_lshlrev_b32 v34, 16, v73
  buffer_load_dwordx4 v4, s[72:75], s5 offen offset:2048 lds
  v_and_b32 v35, 0xffff0000, v73
  v_lshlrev_b32 v36, 16, v74
  v_and_b32 v37, 0xffff0000, v74
  v_pk_mul_f32 v[112:113], v[34:35], v[24:25]
  v_pk_mul_f32 v[114:115], v[32:33], v[26:27]
  v_pk_mul_f32 v[116:117], v[42:43], v[28:29]
  v_pk_mul_f32 v[118:119], v[40:41], v[30:31]
  v_pk_mul_f32 v[120:121], v[36:37], v[24:25]
  v_pk_mul_f32 v[122:123], v[34:35], v[26:27]
  v_pk_mul_f32 v[124:125], v[32:33], v[28:29]
  v_pk_mul_f32 v[126:127], v[42:43], v[30:31]
  v_cvt_pk_bf16_f32 v44, v118, v116
  v_cvt_pk_bf16_f32 v45, v119, v117
  v_cvt_pk_bf16_f32 v46, v126, v124
  v_cvt_pk_bf16_f32 v47, v127, v125
  v_dot2_f32_bf16 v44, v44, v53, 0
  v_dot2_f32_bf16 v45, v45, v53, 0
  v_dot2_f32_bf16 v46, v46, v53, 0
  v_dot2_f32_bf16 v47, v47, v53, 0
  buffer_load_dwordx4 v4, s[72:75], s5 offen offset:3072 lds
  v_cvt_pk_bf16_f32 v44, v44, v114
  v_cvt_pk_bf16_f32 v45, v45, v115
  v_cvt_pk_bf16_f32 v46, v46, v122
  v_cvt_pk_bf16_f32 v47, v47, v123
  v_dot2_f32_bf16 v44, v44, v53, 0
  v_dot2_f32_bf16 v45, v45, v53, 0
  v_dot2_f32_bf16 v46, v46, v53, 0
  v_dot2_f32_bf16 v47, v47, v53, 0
  v_cvt_pk_bf16_f32 v44, v44, v112
  v_cvt_pk_bf16_f32 v45, v45, v113
  v_cvt_pk_bf16_f32 v46, v46, v120
  v_cvt_pk_bf16_f32 v47, v47, v121
  v_dot2_f32_bf16 v44, v44, v53, 0
  v_dot2_f32_bf16 v45, v45, v53, 0
  v_dot2_f32_bf16 v46, v46, v53, 0
  v_dot2_f32_bf16 v47, v47, v53, 0
  v_cvt_pk_bf16_f32 v44, v44, 0
  v_cvt_pk_bf16_f32 v45, 0, v45
  v_cvt_pk_bf16_f32 v46, v46, 0
  v_cvt_pk_bf16_f32 v47, 0, v47
  v_dot2_f32_bf16 v44, v44, v97, 0
  v_dot2_f32_bf16 v45, v45, v97, 0
  v_dot2_f32_bf16 v46, v46, v98, 0
  v_dot2_f32_bf16 v47, v47, v98, 0
  s_nop 1
  v_cvt_pk_bf16_f32 v48, v46, v44
  v_cvt_pk_bf16_f32 v128, v47, v45
  ds_write_b128 v52, v[48:51] offset:32
  ds_write_b128 v52, v[128:131] offset:160
  s_waitcnt vmcnt(23)
  v_lshlrev_b32 v38, 16, v75
  v_and_b32 v39, 0xffff0000, v75
  v_lshlrev_b32 v40, 16, v76
  v_and_b32 v41, 0xffff0000, v76
  v_pk_mul_f32 v[112:113], v[38:39], v[24:25]
  v_pk_mul_f32 v[114:115], v[36:37], v[26:27]
  v_pk_mul_f32 v[116:117], v[34:35], v[28:29]
  v_pk_mul_f32 v[118:119], v[32:33], v[30:31]
  v_pk_mul_f32 v[120:121], v[40:41], v[24:25]
  v_pk_mul_f32 v[122:123], v[38:39], v[26:27]
  v_pk_mul_f32 v[124:125], v[36:37], v[28:29]
  v_pk_mul_f32 v[126:127], v[34:35], v[30:31]
  v_cvt_pk_bf16_f32 v44, v118, v116
  v_cvt_pk_bf16_f32 v45, v119, v117
  v_cvt_pk_bf16_f32 v46, v126, v124
  v_cvt_pk_bf16_f32 v47, v127, v125
  v_dot2_f32_bf16 v44, v44, v53, 0
  v_dot2_f32_bf16 v45, v45, v53, 0
  v_dot2_f32_bf16 v46, v46, v53, 0
  v_dot2_f32_bf16 v47, v47, v53, 0
  v_cvt_pk_bf16_f32 v44, v44, v114
  v_cvt_pk_bf16_f32 v45, v45, v115
  v_cvt_pk_bf16_f32 v46, v46, v122
  v_cvt_pk_bf16_f32 v47, v47, v123
  v_dot2_f32_bf16 v44, v44, v53, 0
  v_dot2_f32_bf16 v45, v45, v53, 0
  v_dot2_f32_bf16 v46, v46, v53, 0
  v_dot2_f32_bf16 v47, v47, v53, 0
  v_cvt_pk_bf16_f32 v44, v44, v112
  v_cvt_pk_bf16_f32 v45, v45, v113
  v_cvt_pk_bf16_f32 v46, v46, v120
  v_cvt_pk_bf16_f32 v47, v47, v121
  v_dot2_f32_bf16 v44, v44, v53, 0
  v_dot2_f32_bf16 v45, v45, v53, 0
  v_dot2_f32_bf16 v46, v46, v53, 0
  v_dot2_f32_bf16 v47, v47, v53, 0
  v_cvt_pk_bf16_f32 v44, v44, 0
  v_cvt_pk_bf16_f32 v45, 0, v45
  v_cvt_pk_bf16_f32 v46, v46, 0
  v_cvt_pk_bf16_f32 v47, 0, v47
  v_dot2_f32_bf16 v44, v44, v99, 0
  v_dot2_f32_bf16 v45, v45, v99, 0
  v_dot2_f32_bf16 v46, v46, v100, 0
  v_dot2_f32_bf16 v47, v47, v100, 0
  s_nop 1
  v_cvt_pk_bf16_f32 v50, v46, v44
  v_cvt_pk_bf16_f32 v130, v47, v45
  v_lshlrev_b32 v42, 16, v77
  v_and_b32 v43, 0xffff0000, v77
  v_lshlrev_b32 v32, 16, v78
  v_and_b32 v33, 0xffff0000, v78
  v_pk_mul_f32 v[112:113], v[42:43], v[24:25]
  v_pk_mul_f32 v[114:115], v[40:41], v[26:27]
  v_pk_mul_f32 v[116:117], v[38:39], v[28:29]
  v_pk_mul_f32 v[118:119], v[36:37], v[30:31]
  v_pk_mul_f32 v[120:121], v[32:33], v[24:25]
  v_pk_mul_f32 v[122:123], v[42:43], v[26:27]
  v_pk_mul_f32 v[124:125], v[40:41], v[28:29]
  v_pk_mul_f32 v[126:127], v[38:39], v[30:31]
  v_cvt_pk_bf16_f32 v44, v118, v116
  v_cvt_pk_bf16_f32 v45, v119, v117
  v_cvt_pk_bf16_f32 v46, v126, v124
  v_cvt_pk_bf16_f32 v47, v127, v125
  v_dot2_f32_bf16 v44, v44, v53, 0
  v_dot2_f32_bf16 v45, v45, v53, 0
  v_dot2_f32_bf16 v46, v46, v53, 0
  v_dot2_f32_bf16 v47, v47, v53, 0
  v_cvt_pk_bf16_f32 v44, v44, v114
  v_cvt_pk_bf16_f32 v45, v45, v115
  v_cvt_pk_bf16_f32 v46, v46, v122
  v_cvt_pk_bf16_f32 v47, v47, v123
  v_dot2_f32_bf16 v44, v44, v53, 0
  v_dot2_f32_bf16 v45, v45, v53, 0
  v_dot2_f32_bf16 v46, v46, v53, 0
  v_dot2_f32_bf16 v47, v47, v53, 0
  v_cvt_pk_bf16_f32 v44, v44, v112
  v_cvt_pk_bf16_f32 v45, v45, v113
  v_cvt_pk_bf16_f32 v46, v46, v120
  v_cvt_pk_bf16_f32 v47, v47, v121
  v_dot2_f32_bf16 v44, v44, v53, 0
  v_dot2_f32_bf16 v45, v45, v53, 0
  v_dot2_f32_bf16 v46, v46, v53, 0
  v_dot2_f32_bf16 v47, v47, v53, 0
  v_cvt_pk_bf16_f32 v44, v44, 0
  v_cvt_pk_bf16_f32 v45, 0, v45
  v_cvt_pk_bf16_f32 v46, v46, 0
  v_cvt_pk_bf16_f32 v47, 0, v47
  v_dot2_f32_bf16 v44, v44, v101, 0
  v_dot2_f32_bf16 v45, v45, v101, 0
  v_dot2_f32_bf16 v46, v46, v102, 0
  v_dot2_f32_bf16 v47, v47, v102, 0
  s_nop 1
  v_cvt_pk_bf16_f32 v49, v46, v44
  v_cvt_pk_bf16_f32 v129, v47, v45
  v_lshlrev_b32 v34, 16, v79
  v_and_b32 v35, 0xffff0000, v79
  v_lshlrev_b32 v36, 16, v80
  v_and_b32 v37, 0xffff0000, v80
  v_pk_mul_f32 v[112:113], v[34:35], v[24:25]
  v_pk_mul_f32 v[114:115], v[32:33], v[26:27]
  v_pk_mul_f32 v[116:117], v[42:43], v[28:29]
  v_pk_mul_f32 v[118:119], v[40:41], v[30:31]
  v_pk_mul_f32 v[120:121], v[36:37], v[24:25]
  v_pk_mul_f32 v[122:123], v[34:35], v[26:27]
  v_pk_mul_f32 v[124:125], v[32:33], v[28:29]
  v_pk_mul_f32 v[126:127], v[42:43], v[30:31]
  v_cvt_pk_bf16_f32 v44, v118, v116
  v_cvt_pk_bf16_f32 v45, v119, v117
  v_cvt_pk_bf16_f32 v46, v126, v124
  v_cvt_pk_bf16_f32 v47, v127, v125
  v_dot2_f32_bf16 v44, v44, v53, 0
  v_dot2_f32_bf16 v45, v45, v53, 0
  v_dot2_f32_bf16 v46, v46, v53, 0
  v_dot2_f32_bf16 v47, v47, v53, 0
  v_cvt_pk_bf16_f32 v44, v44, v114
  v_cvt_pk_bf16_f32 v45, v45, v115
  v_cvt_pk_bf16_f32 v46, v46, v122
  v_cvt_pk_bf16_f32 v47, v47, v123
  v_dot2_f32_bf16 v44, v44, v53, 0
  v_dot2_f32_bf16 v45, v45, v53, 0
  v_dot2_f32_bf16 v46, v46, v53, 0
  v_dot2_f32_bf16 v47, v47, v53, 0
  v_cvt_pk_bf16_f32 v44, v44, v112
  v_cvt_pk_bf16_f32 v45, v45, v113
  v_cvt_pk_bf16_f32 v46, v46, v120
  v_cvt_pk_bf16_f32 v47, v47, v121
  v_dot2_f32_bf16 v44, v44, v53, 0
  v_dot2_f32_bf16 v45, v45, v53, 0
  v_dot2_f32_bf16 v46, v46, v53, 0
  v_dot2_f32_bf16 v47, v47, v53, 0
  v_cvt_pk_bf16_f32 v44, v44, 0
  v_cvt_pk_bf16_f32 v45, 0, v45
  v_cvt_pk_bf16_f32 v46, v46, 0
  v_cvt_pk_bf16_f32 v47, 0, v47
  v_dot2_f32_bf16 v44, v44, v103, 0
  v_dot2_f32_bf16 v45, v45, v103, 0
  v_dot2_f32_bf16 v46, v46, v104, 0
  v_dot2_f32_bf16 v47, v47, v104, 0
  s_nop 1
  v_cvt_pk_bf16_f32 v48, v46, v44
  v_cvt_pk_bf16_f32 v128, v47, v45
  ds_write_b128 v52, v[48:51] offset:16
  ds_write_b128 v52, v[128:131] offset:144
  s_waitcnt vmcnt(11)
  v_lshlrev_b32 v38, 16, v81
  v_and_b32 v39, 0xffff0000, v81
  v_lshlrev_b32 v40, 16, v82
  v_and_b32 v41, 0xffff0000, v82
  v_pk_mul_f32 v[112:113], v[38:39], v[24:25]
  v_pk_mul_f32 v[114:115], v[36:37], v[26:27]
  v_pk_mul_f32 v[116:117], v[34:35], v[28:29]
  v_pk_mul_f32 v[118:119], v[32:33], v[30:31]
  v_pk_mul_f32 v[120:121], v[40:41], v[24:25]
  v_pk_mul_f32 v[122:123], v[38:39], v[26:27]
  v_pk_mul_f32 v[124:125], v[36:37], v[28:29]
  v_pk_mul_f32 v[126:127], v[34:35], v[30:31]
  v_cvt_pk_bf16_f32 v44, v118, v116
  v_cvt_pk_bf16_f32 v45, v119, v117
  v_cvt_pk_bf16_f32 v46, v126, v124
  v_cvt_pk_bf16_f32 v47, v127, v125
  v_dot2_f32_bf16 v44, v44, v53, 0
  v_dot2_f32_bf16 v45, v45, v53, 0
  v_dot2_f32_bf16 v46, v46, v53, 0
  v_dot2_f32_bf16 v47, v47, v53, 0
  v_cvt_pk_bf16_f32 v44, v44, v114
  v_cvt_pk_bf16_f32 v45, v45, v115
  v_cvt_pk_bf16_f32 v46, v46, v122
  v_cvt_pk_bf16_f32 v47, v47, v123
  v_dot2_f32_bf16 v44, v44, v53, 0
  v_dot2_f32_bf16 v45, v45, v53, 0
  v_dot2_f32_bf16 v46, v46, v53, 0
  v_dot2_f32_bf16 v47, v47, v53, 0
  v_cvt_pk_bf16_f32 v44, v44, v112
  v_cvt_pk_bf16_f32 v45, v45, v113
  v_cvt_pk_bf16_f32 v46, v46, v120
  v_cvt_pk_bf16_f32 v47, v47, v121
  v_dot2_f32_bf16 v44, v44, v53, 0
  v_dot2_f32_bf16 v45, v45, v53, 0
  v_dot2_f32_bf16 v46, v46, v53, 0
  v_dot2_f32_bf16 v47, v47, v53, 0
  v_cvt_pk_bf16_f32 v44, v44, 0
  v_cvt_pk_bf16_f32 v45, 0, v45
  v_cvt_pk_bf16_f32 v46, v46, 0
  v_cvt_pk_bf16_f32 v47, 0, v47
  v_dot2_f32_bf16 v44, v44, v105, 0
  v_dot2_f32_bf16 v45, v45, v105, 0
  v_dot2_f32_bf16 v46, v46, v106, 0
  v_dot2_f32_bf16 v47, v47, v106, 0
  s_nop 1
  v_cvt_pk_bf16_f32 v50, v46, v44
  v_cvt_pk_bf16_f32 v130, v47, v45
  v_lshlrev_b32 v42, 16, v83
  v_and_b32 v43, 0xffff0000, v83
  v_lshlrev_b32 v32, 16, v84
  v_and_b32 v33, 0xffff0000, v84
  v_pk_mul_f32 v[112:113], v[42:43], v[24:25]
  v_pk_mul_f32 v[114:115], v[40:41], v[26:27]
  v_pk_mul_f32 v[116:117], v[38:39], v[28:29]
  v_pk_mul_f32 v[118:119], v[36:37], v[30:31]
  v_pk_mul_f32 v[120:121], v[32:33], v[24:25]
  v_pk_mul_f32 v[122:123], v[42:43], v[26:27]
  v_pk_mul_f32 v[124:125], v[40:41], v[28:29]
  v_pk_mul_f32 v[126:127], v[38:39], v[30:31]
  v_cvt_pk_bf16_f32 v44, v118, v116
  v_cvt_pk_bf16_f32 v45, v119, v117
  v_cvt_pk_bf16_f32 v46, v126, v124
  v_cvt_pk_bf16_f32 v47, v127, v125
  v_dot2_f32_bf16 v44, v44, v53, 0
  v_dot2_f32_bf16 v45, v45, v53, 0
  v_dot2_f32_bf16 v46, v46, v53, 0
  v_dot2_f32_bf16 v47, v47, v53, 0
  v_cvt_pk_bf16_f32 v44, v44, v114
  v_cvt_pk_bf16_f32 v45, v45, v115
  v_cvt_pk_bf16_f32 v46, v46, v122
  v_cvt_pk_bf16_f32 v47, v47, v123
  v_dot2_f32_bf16 v44, v44, v53, 0
  v_dot2_f32_bf16 v45, v45, v53, 0
  v_dot2_f32_bf16 v46, v46, v53, 0
  v_dot2_f32_bf16 v47, v47, v53, 0
  v_cvt_pk_bf16_f32 v44, v44, v112
  v_cvt_pk_bf16_f32 v45, v45, v113
  v_cvt_pk_bf16_f32 v46, v46, v120
  v_cvt_pk_bf16_f32 v47, v47, v121
  v_dot2_f32_bf16 v44, v44, v53, 0
  v_dot2_f32_bf16 v45, v45, v53, 0
  v_dot2_f32_bf16 v46, v46, v53, 0
  v_dot2_f32_bf16 v47, v47, v53, 0
  v_cvt_pk_bf16_f32 v44, v44, 0
  v_cvt_pk_bf16_f32 v45, 0, v45
  v_cvt_pk_bf16_f32 v46, v46, 0
  v_cvt_pk_bf16_f32 v47, 0, v47
  v_dot2_f32_bf16 v44, v44, v107, 0
  v_dot2_f32_bf16 v45, v45, v107, 0
  v_dot2_f32_bf16 v46, v46, v108, 0
  v_dot2_f32_bf16 v47, v47, v108, 0
  s_nop 1
  v_cvt_pk_bf16_f32 v49, v46, v44
  v_cvt_pk_bf16_f32 v129, v47, v45
  v_lshlrev_b32 v34, 16, v85
  v_and_b32 v35, 0xffff0000, v85
  v_lshlrev_b32 v36, 16, v86
  v_and_b32 v37, 0xffff0000, v86
  v_pk_mul_f32 v[112:113], v[34:35], v[24:25]
  v_pk_mul_f32 v[114:115], v[32:33], v[26:27]
  v_pk_mul_f32 v[116:117], v[42:43], v[28:29]
  v_pk_mul_f32 v[118:119], v[40:41], v[30:31]
  v_pk_mul_f32 v[120:121], v[36:37], v[24:25]
  v_pk_mul_f32 v[122:123], v[34:35], v[26:27]
  v_pk_mul_f32 v[124:125], v[32:33], v[28:29]
  v_pk_mul_f32 v[126:127], v[42:43], v[30:31]
  v_cvt_pk_bf16_f32 v44, v118, v116
  v_cvt_pk_bf16_f32 v45, v119, v117
  v_cvt_pk_bf16_f32 v46, v126, v124
  v_cvt_pk_bf16_f32 v47, v127, v125
  v_dot2_f32_bf16 v44, v44, v53, 0
  v_dot2_f32_bf16 v45, v45, v53, 0
  v_dot2_f32_bf16 v46, v46, v53, 0
  v_dot2_f32_bf16 v47, v47, v53, 0
  v_cvt_pk_bf16_f32 v44, v44, v114
  v_cvt_pk_bf16_f32 v45, v45, v115
  v_cvt_pk_bf16_f32 v46, v46, v122
  v_cvt_pk_bf16_f32 v47, v47, v123
  v_dot2_f32_bf16 v44, v44, v53, 0
  v_dot2_f32_bf16 v45, v45, v53, 0
  v_dot2_f32_bf16 v46, v46, v53, 0
  v_dot2_f32_bf16 v47, v47, v53, 0
  v_cvt_pk_bf16_f32 v44, v44, v112
  v_cvt_pk_bf16_f32 v45, v45, v113
  v_cvt_pk_bf16_f32 v46, v46, v120
  v_cvt_pk_bf16_f32 v47, v47, v121
  v_dot2_f32_bf16 v44, v44, v53, 0
  v_dot2_f32_bf16 v45, v45, v53, 0
  v_dot2_f32_bf16 v46, v46, v53, 0
  v_dot2_f32_bf16 v47, v47, v53, 0
  v_cvt_pk_bf16_f32 v44, v44, 0
  v_cvt_pk_bf16_f32 v45, 0, v45
  v_cvt_pk_bf16_f32 v46, v46, 0
  v_cvt_pk_bf16_f32 v47, 0, v47
  v_dot2_f32_bf16 v44, v44, v109, 0
  v_dot2_f32_bf16 v45, v45, v109, 0
  v_dot2_f32_bf16 v46, v46, v110, 0
  v_dot2_f32_bf16 v47, v47, v110, 0
  s_nop 1
  v_cvt_pk_bf16_f32 v48, v46, v44
  v_cvt_pk_bf16_f32 v128, v47, v45
  ds_write_b128 v52, v[48:51] offset:0
  ds_write_b128 v52, v[128:131] offset:128
  v_lshlrev_b32 v24, 4, v6
  v_add3_u32 v24, v24, v4, s89
  ds_read_b128 v[60:63], v24 offset:0
  ds_read_b128 v[64:67], v24 offset:1088
  ds_read_b128 v[68:71], v24 offset:2176
  ds_read_b128 v[72:75], v24 offset:3264
  ds_read_b128 v[76:79], v24 offset:4352
  ds_read_b128 v[80:83], v24 offset:5440
  ds_read_b128 v[84:87], v24 offset:6528
  ds_read_b128 v[88:91], v24 offset:7616
  v_lshrrev_b32 v25, 3, v1
  v_mul_u32_u24 v25, 5504, v25
  v_add_u32 v25, v25, v4
  s_mul_i32 s93, s86, 360448
  s_sub_u32 s94, 43, s85
  s_lshl_b32 s94, s94, 7
  s_add_u32 s93, s93, s94
  s_cmp_lt_u32 s90, 132
  s_cselect_b32 s95, s93, 0x40000000
  s_add_u32 s94, s95, 23068672
  s_waitcnt lgkmcnt(7)
  buffer_store_dwordx4 v[60:63], v25, s[44:47], s94 offen sc1
  s_add_u32 s94, s95, 23113728
  s_waitcnt lgkmcnt(6)
  buffer_store_dwordx4 v[64:67], v25, s[44:47], s94 offen sc1
  s_add_u32 s94, s95, 23158784
  s_waitcnt lgkmcnt(5)
  buffer_store_dwordx4 v[68:71], v25, s[44:47], s94 offen sc1
  s_add_u32 s94, s95, 23203840
  s_waitcnt lgkmcnt(4)
  buffer_store_dwordx4 v[72:75], v25, s[44:47], s94 offen sc1
  s_add_u32 s94, s95, 23248896
  s_waitcnt lgkmcnt(3)
  buffer_store_dwordx4 v[76:79], v25, s[44:47], s94 offen sc1
  s_add_u32 s94, s95, 23293952
  s_waitcnt lgkmcnt(2)
  buffer_store_dwordx4 v[80:83], v25, s[44:47], s94 offen sc1
  s_add_u32 s94, s95, 23339008
  s_waitcnt lgkmcnt(1)
  buffer_store_dwordx4 v[84:87], v25, s[44:47], s94 offen sc1
  s_add_u32 s94, s95, 23384064
  s_waitcnt lgkmcnt(0)
  buffer_store_dwordx4 v[88:91], v25, s[44:47], s94 offen sc1
  s_nop 1
  s_branch L_auxconv3
  s_waitcnt vmcnt(0) lgkmcnt(0)
  s_nop 7
  s_nop 3
L_auxconv2:
  s_barrier
  s_lshl1_add_u32 s93, s82, s4
  s_lshl_b32 s94, s93, 12
  s_add_u32 s72, s34, s94
  s_addc_u32 s73, s35, 0
  s_and_b32 s73, s73, 0xffff
  s_mov_b32 s74, 4096
  s_mov_b32 s75, 0x20000
  s_lshl_b32 s94, s82, 2
  v_mov_b32 v254, s94
  global_load_dword v254, v254, s[36:37]
  v_add_u32 v253, v5, v6
  v_subrev_u32 v253, 16, v253
  v_lshlrev_b32 v253, 2, v253
  buffer_load_dword v253, v253, s[72:75], 0 offen
  s_mul_i32 s95, s4, 16656
  s_mul_i32 s96, s3, 8336
  s_add_u32 s96, s96, s95
  s_add_u32 m0, s96, 110656
  s_lshl_b32 s5, s3, 3
  s_add_u32 s5, s5, 0
  buffer_load_dwordx4 v4, s[72:75], s5 offen offset:0 lds
  buffer_load_dwordx4 v4, s[72:75], s5 offen offset:1024 lds
  buffer_load_dwordx4 v4, s[72:75], s5 offen offset:2048 lds
  buffer_load_dwordx4 v4, s[72:75], s5 offen offset:3072 lds
  s_mul_i32 s95, s4, 16656
  s_mul_i32 s96, s3, 8320
  s_add_u32 s96, s96, s95
  s_add_u32 m0, s96, 114832
  s_lshl_b32 s5, s3, 3
  s_add_u32 s5, s5, 4
  buffer_load_dwordx4 v4, s[72:75], s5 offen offset:0 lds
  buffer_load_dwordx4 v4, s[72:75], s5 offen offset:1024 lds
  buffer_load_dwordx4 v4, s[72:75], s5 offen offset:2048 lds
  buffer_load_dwordx4 v4, s[72:75], s5 offen offset:3072 lds
L_auxconv3:
  s_barrier
  s_lshl1_add_u32 s93, s82, s4
  s_mul_i32 s94, s93, 5632
  s_mul_i32 s96, s3, 2736
  s_add_u32 s94, s94, s96
  s_add_u32 s94, s94, 23068832
  v_add_u32 v251, s94, v4
  s_sub_u32 s93, 44, s3
  v_cmp_gt_u32 vcc, s93, v1
  s_nop 1
  v_cndmask_b32 v252, v7, v251, vcc
  v_cndmask_b32 v250, 0, v2, vcc
  s_sub_u32 s93, 43, s3
  v_cmp_gt_u32 vcc, s93, v1
  s_nop 1
  v_cndmask_b32 v249, v7, v251, vcc
  v_mul_u32_u24 v248, 4160, v6
  v_min_u32 v17, 1, v6
  v_lshl_add_u32 v248, v17, 4, v248
  v_lshl_add_u32 v248, v5, 2, v248
  s_mul_i32 s95, s4, 16656
  s_add_u32 s96, s95, 110592
  v_add_u32 v248, s96, v248
  s_mul_i32 s95, s4, 9280
  s_mul_i32 s96, s3, 4640
  s_add_u32 s96, s96, s95
  v_lshl_add_u32 v231, v1, 3, s96
  v_mul_u32_u24 v230, 12, v1
  s_mul_i32 s95, s4, 9280
  s_mul_i32 s96, s3, 2052
  s_add_u32 s96, s96, s95
  v_add_u32 v230, s96, v230
  v_add_u32 v16, 1, v5
  v_and_b32 v17, 3, v16
  v_mul_u32_u24 v229, 4160, v17
  v_min_u32 v17, 1, v17
  v_lshrrev_b32 v16, 2, v16
  v_add3_u32 v16, v16, v17, v6
  v_lshl_add_u32 v229, v16, 4, v229
  s_mul_i32 s96, s4, 16656
  s_lshl_b32 s94, s3, 8
  s_add_u32 s96, s96, s94
  s_add_u32 s96, s96, 110592
  v_add_u32 v229, s96, v229
  v_and_b32 v16, 1, v5
  v_sub_u32 v16, 1, v16
  v_mul_u32_u24 v228, 4640, v16
  v_lshrrev_b32 v16, 1, v5
  v_lshlrev_b32 v16, 6, v16
  v_sub_u32 v228, v228, v16
  v_lshl_add_u32 v228, v6, 4, v228
  s_mul_i32 s95, s4, 9280
  s_lshl_b32 s94, s3, 8
  s_add_u32 s96, s95, s94
  s_add_u32 s96, s96, 464
  v_add_u32 v228, s96, v228
  s_waitcnt vmcnt(8)
  ds_write_b32 v248, v253
  ds_write_b64 v231, v[10:11] offset:4112
  s_mov_b32 s83, 300000
L_poll_69:
  s_sleep 16
  buffer_load_dwordx4 v[232:235], v251, s[44:47], 0 offen offset:0 sc1
  buffer_load_dwordx4 v[236:239], v251, s[44:47], 0 offen offset:1024 sc1
  buffer_load_dwordx4 v[240:243], v252, s[44:47], 0 offen offset:2048 sc1
  buffer_load_dword v244, v251, s[44:47], 0 offen offset:16 sc1
  buffer_load_dword v245, v251, s[44:47], 0 offen offset:1040 sc1
  buffer_load_dword v246, v249, s[44:47], 0 offen offset:2064 sc1
  s_waitcnt vmcnt(0)
  v_bitop3_b32 v16, v235, v239, v2 bitop3:0x7e
  v_xor_b32 v17, v243, v250
  v_or_b32 v16, v16, v17
  v_cmp_ne_u32 vcc, 0, v16
  s_sub_u32 s83, s83, 1
  s_cselect_b64 vcc, 0, vcc
  s_cmp_lg_u64 vcc, 0
  s_cbranch_scc1 L_poll_69
  ds_write_b32 v230, v232 offset:8
  v_alignbit_b32 v16, v233, v232, 16
  ds_write_b32 v230, v233 offset:12
  v_alignbit_b32 v17, v234, v233, 16
  ds_write_b32 v230, v234 offset:16
  v_alignbit_b32 v18, v244, v234, 16
  ds_write_b32 v230, v16 offset:4648
  ds_write_b32 v230, v17 offset:4652
  ds_write_b32 v230, v18 offset:4656
  ds_write_b32 v230, v236 offset:776
  v_alignbit_b32 v19, v237, v236, 16
  ds_write_b32 v230, v237 offset:780
  v_alignbit_b32 v20, v238, v237, 16
  ds_write_b32 v230, v238 offset:784
  v_alignbit_b32 v21, v245, v238, 16
  ds_write_b32 v230, v19 offset:5416
  ds_write_b32 v230, v20 offset:5420
  ds_write_b32 v230, v21 offset:5424
  v_cmp_gt_u32 vcc, 43, v1
  s_mov_b64 exec, vcc
  ds_write_b32 v230, v240 offset:1544
  v_alignbit_b32 v22, v241, v240, 16
  ds_write_b32 v230, v241 offset:1548
  v_alignbit_b32 v23, v242, v241, 16
  ds_write_b32 v230, v242 offset:1552
  v_alignbit_b32 v24, v246, v242, 16
  ds_write_b32 v230, v22 offset:6184
  ds_write_b32 v230, v23 offset:6188
  ds_write_b32 v230, v24 offset:6192
  s_mov_b64 exec, -1
  s_waitcnt lgkmcnt(0)
  s_barrier
  ds_read_b128 v[48:51], v229 offset:0
  ds_read_b128 v[108:111], v228 offset:0
  ds_read_b128 v[104:107], v228 offset:512
  ds_read_b128 v[100:103], v228 offset:1024
  ds_read_b128 v[96:99], v228 offset:1536
  ds_read_b128 v[92:95], v228 offset:2048
  ds_read_b128 v[88:91], v228 offset:2560
  ds_read_b128 v[84:87], v228 offset:3072
  ds_read_b128 v[80:83], v228 offset:3584
  v_lshlrev_b32 v115, 1, v5
  v_lshl_add_u32 v115, v6, 6, v115
  v_add_u32 v112, 0, v115
  v_mul_u32_u24 v112, 171, v112
  v_lshrrev_b32 v112, 9, v112
  v_add_u32 v112, v112, v115
  s_mul_i32 s96, s79, 10944
  v_lshl_add_u32 v112, v112, 2, s96
  v_add_u32 v113, 1, v115
  v_mul_u32_u24 v113, 171, v113
  v_lshrrev_b32 v113, 9, v113
  v_add_u32 v113, v113, v115
  s_mul_i32 s96, s79, 10944
  v_lshl_add_u32 v113, v113, 2, s96
  v_add_u32 v114, 2, v115
  v_mul_u32_u24 v114, 171, v114
  v_lshrrev_b32 v114, 9, v114
  v_add_u32 v114, v114, v115
  s_mul_i32 s96, s79, 10944
  v_lshl_add_u32 v114, v114, 2, s96
  s_waitcnt lgkmcnt(7)
  v_mfma_f32_16x16x32_bf16 v[44:47], v[108:111], v[48:51], 0
  ds_read_b128 v[52:55], v229 offset:512
  ds_read_b128 v[108:111], v228 offset:64
  s_waitcnt lgkmcnt(8)
  v_mfma_f32_16x16x32_bf16 v[40:43], v[104:107], v[48:51], 0
  ds_read_b128 v[56:59], v229 offset:1024
  s_waitcnt lgkmcnt(8)
  v_mfma_f32_16x16x32_bf16 v[36:39], v[100:103], v[48:51], 0
  ds_read_b128 v[60:63], v229 offset:1536
  s_waitcnt lgkmcnt(8)
  v_mfma_f32_16x16x32_bf16 v[32:35], v[96:99], v[48:51], 0
  ds_read_b128 v[64:67], v229 offset:2048
  s_waitcnt lgkmcnt(8)
  v_mfma_f32_16x16x32_bf16 v[28:31], v[92:95], v[48:51], 0
  ds_read_b128 v[68:71], v229 offset:2560
  s_waitcnt lgkmcnt(8)
  v_mfma_f32_16x16x32_bf16 v[24:27], v[88:91], v[48:51], 0
  ds_read_b128 v[72:75], v229 offset:3072
  s_waitcnt lgkmcnt(8)
  v_mfma_f32_16x16x32_bf16 v[20:23], v[84:87], v[48:51], 0
  ds_read_b128 v[76:79], v229 offset:3584
  s_waitcnt lgkmcnt(8)
  v_mfma_f32_16x16x32_bf16 v[16:19], v[80:83], v[48:51], 0
  ds_read_b128 v[48:51], v229 offset:64
  s_waitcnt lgkmcnt(8)
  v_mfma_f32_16x16x32_bf16 v[44:47], v[104:107], v[52:55], v[44:47]
  ds_read_b128 v[104:107], v228 offset:576
  v_mfma_f32_16x16x32_bf16 v[40:43], v[100:103], v[52:55], v[40:43]
  v_mfma_f32_16x16x32_bf16 v[36:39], v[96:99], v[52:55], v[36:39]
  v_mfma_f32_16x16x32_bf16 v[32:35], v[92:95], v[52:55], v[32:35]
  v_mfma_f32_16x16x32_bf16 v[28:31], v[88:91], v[52:55], v[28:31]
  v_mfma_f32_16x16x32_bf16 v[24:27], v[84:87], v[52:55], v[24:27]
  v_mfma_f32_16x16x32_bf16 v[20:23], v[80:83], v[52:55], v[20:23]
  ds_read_b128 v[52:55], v229 offset:576
  s_waitcnt lgkmcnt(8)
  v_mfma_f32_16x16x32_bf16 v[44:47], v[100:103], v[56:59], v[44:47]
  ds_read_b128 v[100:103], v228 offset:1088
  v_mfma_f32_16x16x32_bf16 v[40:43], v[96:99], v[56:59], v[40:43]
  v_mfma_f32_16x16x32_bf16 v[36:39], v[92:95], v[56:59], v[36:39]
  v_mfma_f32_16x16x32_bf16 v[32:35], v[88:91], v[56:59], v[32:35]
  v_mfma_f32_16x16x32_bf16 v[28:31], v[84:87], v[56:59], v[28:31]
  v_mfma_f32_16x16x32_bf16 v[24:27], v[80:83], v[56:59], v[24:27]
  ds_read_b128 v[56:59], v229 offset:1088
  s_waitcnt lgkmcnt(9)
  v_mfma_f32_16x16x32_bf16 v[44:47], v[96:99], v[60:63], v[44:47]
  ds_read_b128 v[96:99], v228 offset:1600
  v_mfma_f32_16x16x32_bf16 v[40:43], v[92:95], v[60:63], v[40:43]
  v_mfma_f32_16x16x32_bf16 v[36:39], v[88:91], v[60:63], v[36:39]
  v_mfma_f32_16x16x32_bf16 v[32:35], v[84:87], v[60:63], v[32:35]
  v_mfma_f32_16x16x32_bf16 v[28:31], v[80:83], v[60:63], v[28:31]
  ds_read_b128 v[60:63], v229 offset:1600
  s_waitcnt lgkmcnt(10)
  v_mfma_f32_16x16x32_bf16 v[44:47], v[92:95], v[64:67], v[44:47]
  ds_read_b128 v[92:95], v228 offset:2112
  v_mfma_f32_16x16x32_bf16 v[40:43], v[88:91], v[64:67], v[40:43]
  v_mfma_f32_16x16x32_bf16 v[36:39], v[84:87], v[64:67], v[36:39]
  v_mfma_f32_16x16x32_bf16 v[32:35], v[80:83], v[64:67], v[32:35]
  ds_read_b128 v[64:67], v229 offset:2112
  s_waitcnt lgkmcnt(11)
  v_mfma_f32_16x16x32_bf16 v[44:47], v[88:91], v[68:71], v[44:47]
  ds_read_b128 v[88:91], v228 offset:2624
  v_mfma_f32_16x16x32_bf16 v[40:43], v[84:87], v[68:71], v[40:43]
  v_mfma_f32_16x16x32_bf16 v[36:39], v[80:83], v[68:71], v[36:39]
  ds_read_b128 v[68:71], v229 offset:2624
  s_waitcnt lgkmcnt(12)
  v_mfma_f32_16x16x32_bf16 v[44:47], v[84:87], v[72:75], v[44:47]
  ds_read_b128 v[84:87], v228 offset:3136
  v_mfma_f32_16x16x32_bf16 v[40:43], v[80:83], v[72:75], v[40:43]
  ds_read_b128 v[72:75], v229 offset:3136
  s_waitcnt lgkmcnt(13)
  v_mfma_f32_16x16x32_bf16 v[44:47], v[80:83], v[76:79], v[44:47]
  ds_read_b128 v[80:83], v228 offset:3648
  ds_read_b128 v[76:79], v229 offset:3648
  s_waitcnt lgkmcnt(14)
  v_mfma_f32_16x16x32_bf16 v[44:47], v[108:111], v[48:51], v[44:47]
  ds_read_b128 v[108:111], v228 offset:128
  s_waitcnt lgkmcnt(14)
  v_mfma_f32_16x16x32_bf16 v[40:43], v[104:107], v[48:51], v[40:43]
  s_waitcnt lgkmcnt(12)
  v_mfma_f32_16x16x32_bf16 v[36:39], v[100:103], v[48:51], v[36:39]
  s_waitcnt lgkmcnt(10)
  v_mfma_f32_16x16x32_bf16 v[32:35], v[96:99], v[48:51], v[32:35]
  s_waitcnt lgkmcnt(8)
  v_mfma_f32_16x16x32_bf16 v[28:31], v[92:95], v[48:51], v[28:31]
  s_waitcnt lgkmcnt(6)
  v_mfma_f32_16x16x32_bf16 v[24:27], v[88:91], v[48:51], v[24:27]
  s_waitcnt lgkmcnt(4)
  v_mfma_f32_16x16x32_bf16 v[20:23], v[84:87], v[48:51], v[20:23]
  s_waitcnt lgkmcnt(2)
  v_mfma_f32_16x16x32_bf16 v[16:19], v[80:83], v[48:51], v[16:19]
  ds_read_b128 v[48:51], v229 offset:128
  v_mfma_f32_16x16x32_bf16 v[44:47], v[104:107], v[52:55], v[44:47]
  ds_read_b128 v[104:107], v228 offset:640
  v_mfma_f32_16x16x32_bf16 v[40:43], v[100:103], v[52:55], v[40:43]
  v_mfma_f32_16x16x32_bf16 v[36:39], v[96:99], v[52:55], v[36:39]
  v_mfma_f32_16x16x32_bf16 v[32:35], v[92:95], v[52:55], v[32:35]
  v_mfma_f32_16x16x32_bf16 v[28:31], v[88:91], v[52:55], v[28:31]
  v_mfma_f32_16x16x32_bf16 v[24:27], v[84:87], v[52:55], v[24:27]
  v_mfma_f32_16x16x32_bf16 v[20:23], v[80:83], v[52:55], v[20:23]
  ds_read_b128 v[52:55], v229 offset:640
  v_mfma_f32_16x16x32_bf16 v[44:47], v[100:103], v[56:59], v[44:47]
  ds_read_b128 v[100:103], v228 offset:1152
  v_mfma_f32_16x16x32_bf16 v[40:43], v[96:99], v[56:59], v[40:43]
  v_mfma_f32_16x16x32_bf16 v[36:39], v[92:95], v[56:59], v[36:39]
  v_mfma_f32_16x16x32_bf16 v[32:35], v[88:91], v[56:59], v[32:35]
  v_mfma_f32_16x16x32_bf16 v[28:31], v[84:87], v[56:59], v[28:31]
  v_mfma_f32_16x16x32_bf16 v[24:27], v[80:83], v[56:59], v[24:27]
  ds_read_b128 v[56:59], v229 offset:1152
  v_mfma_f32_16x16x32_bf16 v[44:47], v[96:99], v[60:63], v[44:47]
  ds_read_b128 v[96:99], v228 offset:1664
  v_mfma_f32_16x16x32_bf16 v[40:43], v[92:95], v[60:63], v[40:43]
  v_mfma_f32_16x16x32_bf16 v[36:39], v[88:91], v[60:63], v[36:39]
  v_mfma_f32_16x16x32_bf16 v[32:35], v[84:87], v[60:63], v[32:35]
  v_mfma_f32_16x16x32_bf16 v[28:31], v[80:83], v[60:63], v[28:31]
  ds_read_b128 v[60:63], v229 offset:1664
  v_mfma_f32_16x16x32_bf16 v[44:47], v[92:95], v[64:67], v[44:47]
  ds_read_b128 v[92:95], v228 offset:2176
  v_mfma_f32_16x16x32_bf16 v[40:43], v[88:91], v[64:67], v[40:43]
  v_mfma_f32_16x16x32_bf16 v[36:39], v[84:87], v[64:67], v[36:39]
  v_mfma_f32_16x16x32_bf16 v[32:35], v[80:83], v[64:67], v[32:35]
  ds_read_b128 v[64:67], v229 offset:2176
  v_mfma_f32_16x16x32_bf16 v[44:47], v[88:91], v[68:71], v[44:47]
  ds_read_b128 v[88:91], v228 offset:2688
  v_mfma_f32_16x16x32_bf16 v[40:43], v[84:87], v[68:71], v[40:43]
  v_mfma_f32_16x16x32_bf16 v[36:39], v[80:83], v[68:71], v[36:39]
  ds_read_b128 v[68:71], v229 offset:2688
  v_mfma_f32_16x16x32_bf16 v[44:47], v[84:87], v[72:75], v[44:47]
  ds_read_b128 v[84:87], v228 offset:3200
  v_mfma_f32_16x16x32_bf16 v[40:43], v[80:83], v[72:75], v[40:43]
  ds_read_b128 v[72:75], v229 offset:3200
  s_waitcnt lgkmcnt(14)
  v_mfma_f32_16x16x32_bf16 v[44:47], v[80:83], v[76:79], v[44:47]
  ds_read_b128 v[80:83], v228 offset:3712
  ds_read_b128 v[76:79], v229 offset:3712
  s_waitcnt lgkmcnt(14)
  v_mfma_f32_16x16x32_bf16 v[44:47], v[108:111], v[48:51], v[44:47]
  ds_read_b128 v[108:111], v228 offset:192
  s_waitcnt lgkmcnt(14)
  v_mfma_f32_16x16x32_bf16 v[40:43], v[104:107], v[48:51], v[40:43]
  s_waitcnt lgkmcnt(12)
  v_mfma_f32_16x16x32_bf16 v[36:39], v[100:103], v[48:51], v[36:39]
  s_waitcnt lgkmcnt(10)
  v_mfma_f32_16x16x32_bf16 v[32:35], v[96:99], v[48:51], v[32:35]
  s_waitcnt lgkmcnt(8)
  v_mfma_f32_16x16x32_bf16 v[28:31], v[92:95], v[48:51], v[28:31]
  s_waitcnt lgkmcnt(6)
  v_mfma_f32_16x16x32_bf16 v[24:27], v[88:91], v[48:51], v[24:27]
  s_waitcnt lgkmcnt(4)
  v_mfma_f32_16x16x32_bf16 v[20:23], v[84:87], v[48:51], v[20:23]
  s_waitcnt lgkmcnt(2)
  v_mfma_f32_16x16x32_bf16 v[16:19], v[80:83], v[48:51], v[16:19]
  ds_read_b128 v[48:51], v229 offset:192
  v_mfma_f32_16x16x32_bf16 v[44:47], v[104:107], v[52:55], v[44:47]
  ds_read_b128 v[104:107], v228 offset:704
  v_mfma_f32_16x16x32_bf16 v[40:43], v[100:103], v[52:55], v[40:43]
  v_mfma_f32_16x16x32_bf16 v[36:39], v[96:99], v[52:55], v[36:39]
  v_mfma_f32_16x16x32_bf16 v[32:35], v[92:95], v[52:55], v[32:35]
  v_mfma_f32_16x16x32_bf16 v[28:31], v[88:91], v[52:55], v[28:31]
  v_mfma_f32_16x16x32_bf16 v[24:27], v[84:87], v[52:55], v[24:27]
  v_mfma_f32_16x16x32_bf16 v[20:23], v[80:83], v[52:55], v[20:23]
  ds_read_b128 v[52:55], v229 offset:704
  v_mfma_f32_16x16x32_bf16 v[44:47], v[100:103], v[56:59], v[44:47]
  ds_read_b128 v[100:103], v228 offset:1216
  v_mfma_f32_16x16x32_bf16 v[40:43], v[96:99], v[56:59], v[40:43]
  v_mfma_f32_16x16x32_bf16 v[36:39], v[92:95], v[56:59], v[36:39]
  v_mfma_f32_16x16x32_bf16 v[32:35], v[88:91], v[56:59], v[32:35]
  v_mfma_f32_16x16x32_bf16 v[28:31], v[84:87], v[56:59], v[28:31]
  v_mfma_f32_16x16x32_bf16 v[24:27], v[80:83], v[56:59], v[24:27]
  ds_read_b128 v[56:59], v229 offset:1216
  v_mfma_f32_16x16x32_bf16 v[44:47], v[96:99], v[60:63], v[44:47]
  ds_read_b128 v[96:99], v228 offset:1728
  v_mfma_f32_16x16x32_bf16 v[40:43], v[92:95], v[60:63], v[40:43]
  v_mfma_f32_16x16x32_bf16 v[36:39], v[88:91], v[60:63], v[36:39]
  v_mfma_f32_16x16x32_bf16 v[32:35], v[84:87], v[60:63], v[32:35]
  v_mfma_f32_16x16x32_bf16 v[28:31], v[80:83], v[60:63], v[28:31]
  ds_read_b128 v[60:63], v229 offset:1728
  v_mfma_f32_16x16x32_bf16 v[44:47], v[92:95], v[64:67], v[44:47]
  ds_read_b128 v[92:95], v228 offset:2240
  v_mfma_f32_16x16x32_bf16 v[40:43], v[88:91], v[64:67], v[40:43]
  v_mfma_f32_16x16x32_bf16 v[36:39], v[84:87], v[64:67], v[36:39]
  v_mfma_f32_16x16x32_bf16 v[32:35], v[80:83], v[64:67], v[32:35]
  ds_read_b128 v[64:67], v229 offset:2240
  v_mfma_f32_16x16x32_bf16 v[44:47], v[88:91], v[68:71], v[44:47]
  ds_read_b128 v[88:91], v228 offset:2752
  v_mfma_f32_16x16x32_bf16 v[40:43], v[84:87], v[68:71], v[40:43]
  v_mfma_f32_16x16x32_bf16 v[36:39], v[80:83], v[68:71], v[36:39]
  ds_read_b128 v[68:71], v229 offset:2752
  v_mfma_f32_16x16x32_bf16 v[44:47], v[84:87], v[72:75], v[44:47]
  ds_read_b128 v[84:87], v228 offset:3264
  v_mfma_f32_16x16x32_bf16 v[40:43], v[80:83], v[72:75], v[40:43]
  ds_read_b128 v[72:75], v229 offset:3264
  s_waitcnt lgkmcnt(14)
  v_mfma_f32_16x16x32_bf16 v[44:47], v[80:83], v[76:79], v[44:47]
  ds_read_b128 v[80:83], v228 offset:3776
  ds_read_b128 v[76:79], v229 offset:3776
  s_waitcnt lgkmcnt(14)
  v_mfma_f32_16x16x32_bf16 v[44:47], v[108:111], v[48:51], v[44:47]
  s_waitcnt lgkmcnt(13)
  v_mfma_f32_16x16x32_bf16 v[40:43], v[104:107], v[48:51], v[40:43]
  s_waitcnt lgkmcnt(11)
  v_mfma_f32_16x16x32_bf16 v[36:39], v[100:103], v[48:51], v[36:39]
  s_waitcnt lgkmcnt(9)
  v_mfma_f32_16x16x32_bf16 v[32:35], v[96:99], v[48:51], v[32:35]
  s_waitcnt lgkmcnt(7)
  v_mfma_f32_16x16x32_bf16 v[28:31], v[92:95], v[48:51], v[28:31]
  s_waitcnt lgkmcnt(5)
  v_mfma_f32_16x16x32_bf16 v[24:27], v[88:91], v[48:51], v[24:27]
  s_waitcnt lgkmcnt(3)
  v_mfma_f32_16x16x32_bf16 v[20:23], v[84:87], v[48:51], v[20:23]
  s_waitcnt lgkmcnt(1)
  v_mfma_f32_16x16x32_bf16 v[16:19], v[80:83], v[48:51], v[16:19]
  v_mfma_f32_16x16x32_bf16 v[44:47], v[104:107], v[52:55], v[44:47]
  v_mfma_f32_16x16x32_bf16 v[40:43], v[100:103], v[52:55], v[40:43]
  v_mfma_f32_16x16x32_bf16 v[36:39], v[96:99], v[52:55], v[36:39]
  v_mfma_f32_16x16x32_bf16 v[32:35], v[92:95], v[52:55], v[32:35]
  v_mfma_f32_16x16x32_bf16 v[28:31], v[88:91], v[52:55], v[28:31]
  v_mfma_f32_16x16x32_bf16 v[24:27], v[84:87], v[52:55], v[24:27]
  v_mfma_f32_16x16x32_bf16 v[20:23], v[80:83], v[52:55], v[20:23]
  v_mfma_f32_16x16x32_bf16 v[44:47], v[100:103], v[56:59], v[44:47]
  v_mfma_f32_16x16x32_bf16 v[40:43], v[96:99], v[56:59], v[40:43]
  v_mfma_f32_16x16x32_bf16 v[36:39], v[92:95], v[56:59], v[36:39]
  v_mfma_f32_16x16x32_bf16 v[32:35], v[88:91], v[56:59], v[32:35]
  v_mfma_f32_16x16x32_bf16 v[28:31], v[84:87], v[56:59], v[28:31]
  v_mfma_f32_16x16x32_bf16 v[24:27], v[80:83], v[56:59], v[24:27]
  ds_write_b32 v112, v16 offset:20480
  ds_write_b32 v113, v17 offset:20484
  ds_write_b32 v114, v18 offset:20648
  ds_write_b32 v112, v19 offset:20656
  v_mfma_f32_16x16x32_bf16 v[44:47], v[96:99], v[60:63], v[44:47]
  v_mfma_f32_16x16x32_bf16 v[40:43], v[92:95], v[60:63], v[40:43]
  v_mfma_f32_16x16x32_bf16 v[36:39], v[88:91], v[60:63], v[36:39]
  v_mfma_f32_16x16x32_bf16 v[32:35], v[84:87], v[60:63], v[32:35]
  v_mfma_f32_16x16x32_bf16 v[28:31], v[80:83], v[60:63], v[28:31]
  ds_write_b32 v113, v20 offset:21844
  ds_write_b32 v114, v21 offset:21848
  ds_write_b32 v112, v22 offset:22016
  ds_write_b32 v113, v23 offset:22020
  v_mfma_f32_16x16x32_bf16 v[44:47], v[92:95], v[64:67], v[44:47]
  v_mfma_f32_16x16x32_bf16 v[40:43], v[88:91], v[64:67], v[40:43]
  v_mfma_f32_16x16x32_bf16 v[36:39], v[84:87], v[64:67], v[36:39]
  v_mfma_f32_16x16x32_bf16 v[32:35], v[80:83], v[64:67], v[32:35]
  ds_write_b32 v114, v24 offset:23208
  ds_write_b32 v112, v25 offset:23216
  ds_write_b32 v113, v26 offset:23380
  ds_write_b32 v114, v27 offset:23384
  v_mfma_f32_16x16x32_bf16 v[44:47], v[88:91], v[68:71], v[44:47]
  v_mfma_f32_16x16x32_bf16 v[40:43], v[84:87], v[68:71], v[40:43]
  v_mfma_f32_16x16x32_bf16 v[36:39], v[80:83], v[68:71], v[36:39]
  ds_write_b32 v112, v28 offset:24576
  ds_write_b32 v113, v29 offset:24580
  ds_write_b32 v114, v30 offset:24744
  ds_write_b32 v112, v31 offset:24752
  v_mfma_f32_16x16x32_bf16 v[44:47], v[84:87], v[72:75], v[44:47]
  v_mfma_f32_16x16x32_bf16 v[40:43], v[80:83], v[72:75], v[40:43]
  ds_write_b32 v113, v32 offset:25940
  ds_write_b32 v114, v33 offset:25944
  ds_write_b32 v112, v34 offset:26112
  ds_write_b32 v113, v35 offset:26116
  s_waitcnt lgkmcnt(15)
  v_mfma_f32_16x16x32_bf16 v[44:47], v[80:83], v[76:79], v[44:47]
  ds_write_b32 v114, v36 offset:27304
  ds_write_b32 v112, v37 offset:27312
  ds_write_b32 v113, v38 offset:27476
  ds_write_b32 v114, v39 offset:27480
  ds_write_b32 v112, v40 offset:28672
  ds_write_b32 v113, v41 offset:28676
  ds_write_b32 v114, v42 offset:28840
  ds_write_b32 v112, v43 offset:28848
  ds_write_b32 v113, v44 offset:30036
  ds_write_b32 v114, v45 offset:30040
  ds_write_b32 v112, v46 offset:30208
  ds_write_b32 v113, v47 offset:30212
  s_waitcnt lgkmcnt(0)
  s_barrier
  v_lshlrev_b32 v16, 4, v0
  v_mul_u32_u24 v17, 6, v0
  v_sub_u32 v17, 4090, v17
  v_and_b32 v17, -4, v17
  v_and_b32 v19, 1, v0
  v_sub_u32 v19, 1, v19
  v_mul_u32_u24 v19, 4640, v19
  v_add_u32 v17, v17, v19
  ds_read_b32 v52, v17 offset:16
  ds_read_b32 v53, v17 offset:20
  ds_read_b32 v54, v17 offset:9296
  ds_read_b32 v55, v17 offset:9300
  ds_read_b128 v[36:39], v16 offset:20480
  ds_read_b128 v[40:43], v16 offset:31424
  ds_read_b128 v[44:47], v16 offset:42368
  ds_read_b128 v[48:51], v16 offset:53312
  v_and_b32 v255, 0xffff0000, v254
  v_lshlrev_b32 v254, 16, v254
  s_mul_i32 s94, s82, 11264
  s_add_u32 s94, s94, 19660800
  v_add_u32 v18, s94, v16
  v_mov_b32 v71, v2
  v_subrev_u32 v17, 1536, v17
  ds_read_b32 v56, v17 offset:16
  ds_read_b32 v57, v17 offset:20
  ds_read_b32 v58, v17 offset:9296
  ds_read_b32 v59, v17 offset:9300
  ds_read_b128 v[20:23], v16 offset:24576
  ds_read_b128 v[24:27], v16 offset:35520
  ds_read_b128 v[28:31], v16 offset:46464
  ds_read_b128 v[32:35], v16 offset:57408
  s_waitcnt lgkmcnt(14)
  v_lshlrev_b32 v60, 16, v53
  v_and_b32 v61, 0xffff0000, v52
  v_lshlrev_b32 v62, 16, v52
  v_mul_f32 v60, v60, v254
  v_mul_f32 v61, v61, v254
  v_mul_f32 v62, v62, v254
  s_waitcnt lgkmcnt(12)
  v_lshlrev_b32 v63, 16, v55
  v_and_b32 v64, 0xffff0000, v54
  v_lshlrev_b32 v65, 16, v54
  v_mul_f32 v63, v63, v255
  v_mul_f32 v64, v64, v255
  v_mul_f32 v65, v65, v255
  s_waitcnt lgkmcnt(10)
  v_add_f32 v36, v36, v40
  v_add_f32 v37, v37, v41
  v_add_f32 v38, v38, v42
  v_cvt_pk_bf16_f32 v60, v36, v60
  v_cvt_pk_bf16_f32 v61, v37, v61
  v_cvt_pk_bf16_f32 v62, v38, v62
  s_waitcnt lgkmcnt(8)
  v_add_f32 v44, v44, v48
  v_add_f32 v45, v45, v49
  v_add_f32 v46, v46, v50
  v_cvt_pk_bf16_f32 v63, v44, v63
  v_cvt_pk_bf16_f32 v64, v45, v64
  v_cvt_pk_bf16_f32 v65, v46, v65
  v_lshlrev_b32 v19, 16, v60
  v_and_b32 v60, 0xffff0000, v60
  v_add_f32 v60, v60, v19
  v_lshlrev_b32 v19, 16, v61
  v_and_b32 v61, 0xffff0000, v61
  v_add_f32 v61, v61, v19
  v_lshlrev_b32 v19, 16, v62
  v_and_b32 v62, 0xffff0000, v62
  v_add_f32 v62, v62, v19
  v_lshlrev_b32 v19, 16, v63
  v_and_b32 v63, 0xffff0000, v63
  v_add_f32 v63, v63, v19
  v_lshlrev_b32 v19, 16, v64
  v_and_b32 v64, 0xffff0000, v64
  v_add_f32 v64, v64, v19
  v_lshlrev_b32 v19, 16, v65
  v_and_b32 v65, 0xffff0000, v65
  v_add_f32 v65, v65, v19
  v_cvt_pk_bf16_f32 v68, v60, v63
  v_cvt_pk_bf16_f32 v69, v61, v64
  v_cvt_pk_bf16_f32 v70, v62, v65
  buffer_store_dwordx4 v[68:71], v18, s[44:47], 0 offen sc1
  v_add_u32 v18, 4096, v18
  s_waitcnt lgkmcnt(6)
  v_lshlrev_b32 v60, 16, v57
  v_and_b32 v61, 0xffff0000, v56
  v_lshlrev_b32 v62, 16, v56
  v_mul_f32 v60, v60, v254
  v_mul_f32 v61, v61, v254
  v_mul_f32 v62, v62, v254
  s_waitcnt lgkmcnt(4)
  v_lshlrev_b32 v63, 16, v59
  v_and_b32 v64, 0xffff0000, v58
  v_lshlrev_b32 v65, 16, v58
  v_mul_f32 v63, v63, v255
  v_mul_f32 v64, v64, v255
  v_mul_f32 v65, v65, v255
  s_waitcnt lgkmcnt(2)
  v_add_f32 v20, v20, v24
  v_add_f32 v21, v21, v25
  v_add_f32 v22, v22, v26
  v_cvt_pk_bf16_f32 v60, v20, v60
  v_cvt_pk_bf16_f32 v61, v21, v61
  v_cvt_pk_bf16_f32 v62, v22, v62
  s_waitcnt lgkmcnt(0)
  v_add_f32 v28, v28, v32
  v_add_f32 v29, v29, v33
  v_add_f32 v30, v30, v34
  v_cvt_pk_bf16_f32 v63, v28, v63
  v_cvt_pk_bf16_f32 v64, v29, v64
  v_cvt_pk_bf16_f32 v65, v30, v65
  v_subrev_u32 v17, 1536, v17
  v_max_i32 v17, 0, v17
  ds_read_b32 v52, v17 offset:16
  ds_read_b32 v53, v17 offset:20
  ds_read_b32 v54, v17 offset:9296
  ds_read_b32 v55, v17 offset:9300
  ds_read_b128 v[20:23], v16 offset:28672
  ds_read_b128 v[24:27], v16 offset:39616
  ds_read_b128 v[28:31], v16 offset:50560
  ds_read_b128 v[32:35], v16 offset:61504
  v_lshlrev_b32 v19, 16, v60
  v_and_b32 v60, 0xffff0000, v60
  v_add_f32 v60, v60, v19
  v_lshlrev_b32 v19, 16, v61
  v_and_b32 v61, 0xffff0000, v61
  v_add_f32 v61, v61, v19
  v_lshlrev_b32 v19, 16, v62
  v_and_b32 v62, 0xffff0000, v62
  v_add_f32 v62, v62, v19
  v_lshlrev_b32 v19, 16, v63
  v_and_b32 v63, 0xffff0000, v63
  v_add_f32 v63, v63, v19
  v_lshlrev_b32 v19, 16, v64
  v_and_b32 v64, 0xffff0000, v64
  v_add_f32 v64, v64, v19
  v_lshlrev_b32 v19, 16, v65
  v_and_b32 v65, 0xffff0000, v65
  v_add_f32 v65, v65, v19
  v_cvt_pk_bf16_f32 v68, v60, v63
  v_cvt_pk_bf16_f32 v69, v61, v64
  v_cvt_pk_bf16_f32 v70, v62, v65
  buffer_store_dwordx4 v[68:71], v18, s[44:47], 0 offen sc1
  v_add_u32 v18, 4096, v18
  v_cmp_gt_u32 vcc, 192, v0
  s_nop 1
  v_cndmask_b32 v18, v7, v18, vcc
  s_waitcnt lgkmcnt(6)
  v_lshlrev_b32 v60, 16, v53
  v_and_b32 v61, 0xffff0000, v52
  v_lshlrev_b32 v62, 16, v52
  v_mul_f32 v60, v60, v254
  v_mul_f32 v61, v61, v254
  v_mul_f32 v62, v62, v254
  s_waitcnt lgkmcnt(4)
  v_lshlrev_b32 v63, 16, v55
  v_and_b32 v64, 0xffff0000, v54
  v_lshlrev_b32 v65, 16, v54
  v_mul_f32 v63, v63, v255
  v_mul_f32 v64, v64, v255
  v_mul_f32 v65, v65, v255
  s_waitcnt lgkmcnt(2)
  v_add_f32 v20, v20, v24
  v_add_f32 v21, v21, v25
  v_add_f32 v22, v22, v26
  v_cvt_pk_bf16_f32 v60, v20, v60
  v_cvt_pk_bf16_f32 v61, v21, v61
  v_cvt_pk_bf16_f32 v62, v22, v62
  s_waitcnt lgkmcnt(0)
  v_add_f32 v28, v28, v32
  v_add_f32 v29, v29, v33
  v_add_f32 v30, v30, v34
  v_cvt_pk_bf16_f32 v63, v28, v63
  v_cvt_pk_bf16_f32 v64, v29, v64
  v_cvt_pk_bf16_f32 v65, v30, v65
  v_lshlrev_b32 v19, 16, v60
  v_and_b32 v60, 0xffff0000, v60
  v_add_f32 v60, v60, v19
  v_lshlrev_b32 v19, 16, v61
  v_and_b32 v61, 0xffff0000, v61
  v_add_f32 v61, v61, v19
  v_lshlrev_b32 v19, 16, v62
  v_and_b32 v62, 0xffff0000, v62
  v_add_f32 v62, v62, v19
  v_lshlrev_b32 v19, 16, v63
  v_and_b32 v63, 0xffff0000, v63
  v_add_f32 v63, v63, v19
  v_lshlrev_b32 v19, 16, v64
  v_and_b32 v64, 0xffff0000, v64
  v_add_f32 v64, v64, v19
  v_lshlrev_b32 v19, 16, v65
  v_and_b32 v65, 0xffff0000, v65
  v_add_f32 v65, v65, v19
  v_cvt_pk_bf16_f32 v68, v60, v63
  v_cvt_pk_bf16_f32 v69, v61, v64
  v_cvt_pk_bf16_f32 v70, v62, v65
  buffer_store_dwordx4 v[68:71], v18, s[44:47], 0 offen sc1
  s_nop 1
  s_add_u32 s82, s82, 58
  s_cmp_lt_u32 s82, 288
  s_cbranch_scc1 L_auxconv2
  s_branch L_fin
  s_waitcnt vmcnt(0) lgkmcnt(0)
  s_nop 7
  s_nop 3
L_poll_1:
  s_mov_b32 s93, 1736704
  buffer_store_dwordx4 v[120:123], v65, s[44:47], s93 offen sc1
  s_nop 1
  s_mov_b32 s83, 300000
L_pollr_3:
  s_mov_b32 s93, 655360
  buffer_load_dwordx4 v[76:79], v66, s[44:47], s93 offen sc1
  s_mov_b32 s93, 659456
  buffer_load_dwordx4 v[80:83], v66, s[44:47], s93 offen sc1
  s_mov_b32 s93, 663552
  buffer_load_dwordx4 v[84:87], v66, s[44:47], s93 offen sc1
  s_mov_b32 s93, 667648
  buffer_load_dwordx4 v[88:91], v66, s[44:47], s93 offen sc1
  s_mov_b32 s93, 671744
  buffer_load_dwordx4 v[92:95], v66, s[44:47], s93 offen sc1
  s_mov_b32 s93, 675840
  buffer_load_dwordx4 v[96:99], v66, s[44:47], s93 offen sc1
  s_waitcnt vmcnt(0)
  v_mov_b32 v127, 0
  v_sub_u32 v128, v79, v67
  v_lshrrev_b32 v128, 4, v128
  v_or_b32 v127, v127, v128
  v_bitop3_b32 v127, v127, v77, v67 bitop3:0xf6
  v_sub_u32 v128, v83, v67
  v_lshrrev_b32 v128, 4, v128
  v_or_b32 v127, v127, v128
  v_bitop3_b32 v127, v127, v81, v67 bitop3:0xf6
  v_sub_u32 v128, v87, v67
  v_lshrrev_b32 v128, 4, v128
  v_or_b32 v127, v127, v128
  v_bitop3_b32 v127, v127, v85, v67 bitop3:0xf6
  v_sub_u32 v128, v91, v67
  v_lshrrev_b32 v128, 4, v128
  v_or_b32 v127, v127, v128
  v_bitop3_b32 v127, v127, v89, v67 bitop3:0xf6
  v_sub_u32 v128, v95, v67
  v_lshrrev_b32 v128, 4, v128
  v_or_b32 v127, v127, v128
  v_bitop3_b32 v127, v127, v93, v67 bitop3:0xf6
  v_sub_u32 v128, v99, v67
  v_lshrrev_b32 v128, 4, v128
  v_or_b32 v127, v127, v128
  v_bitop3_b32 v127, v127, v97, v67 bitop3:0xf6
  v_cmp_ne_u32 vcc, 0, v127
  s_cmp_eq_u64 vcc, 0
  s_cbranch_scc1 L_polld_4
  s_mov_b32 s93, 1736704
  buffer_load_dwordx4 v[76:79], v66, s[44:47], s93 offen sc1
  s_mov_b32 s93, 1740800
  buffer_load_dwordx4 v[80:83], v66, s[44:47], s93 offen sc1
  s_mov_b32 s93, 1744896
  buffer_load_dwordx4 v[84:87], v66, s[44:47], s93 offen sc1
  s_mov_b32 s93, 1748992
  buffer_load_dwordx4 v[88:91], v66, s[44:47], s93 offen sc1
  s_mov_b32 s93, 1753088
  buffer_load_dwordx4 v[92:95], v66, s[44:47], s93 offen sc1
  s_mov_b32 s93, 1757184
  buffer_load_dwordx4 v[96:99], v66, s[44:47], s93 offen sc1
  s_waitcnt vmcnt(0)
  v_mov_b32 v127, 0
  v_sub_u32 v128, v79, v67
  v_lshrrev_b32 v128, 4, v128
  v_or_b32 v127, v127, v128
  v_bitop3_b32 v127, v127, v77, v67 bitop3:0xf6
  v_sub_u32 v128, v83, v67
  v_lshrrev_b32 v128, 4, v128
  v_or_b32 v127, v127, v128
  v_bitop3_b32 v127, v127, v81, v67 bitop3:0xf6
  v_sub_u32 v128, v87, v67
  v_lshrrev_b32 v128, 4, v128
  v_or_b32 v127, v127, v128
  v_bitop3_b32 v127, v127, v85, v67 bitop3:0xf6
  v_sub_u32 v128, v91, v67
  v_lshrrev_b32 v128, 4, v128
  v_or_b32 v127, v127, v128
  v_bitop3_b32 v127, v127, v89, v67 bitop3:0xf6
  v_sub_u32 v128, v95, v67
  v_lshrrev_b32 v128, 4, v128
  v_or_b32 v127, v127, v128
  v_bitop3_b32 v127, v127, v93, v67 bitop3:0xf6
  v_sub_u32 v128, v99, v67
  v_lshrrev_b32 v128, 4, v128
  v_or_b32 v127, v127, v128
  v_bitop3_b32 v127, v127, v97, v67 bitop3:0xf6
  v_cmp_ne_u32 vcc, 0, v127
  s_sub_u32 s83, s83, 1
  s_cselect_b64 vcc, 0, vcc
  s_cmp_lg_u64 vcc, 0
  s_cbranch_scc1 L_pollr_3
L_polld_4:
  v_cmp_ne_u32 vcc, v79, v14
  s_cmp_eq_u64 vcc, 0
  s_cselect_b32 s78, 1, 0
  s_branch L_pollc_2
L_poll_5:
  s_sleep 6
  buffer_load_dword v157, v159, s[44:47], 0 offen sc1
  s_waitcnt vmcnt(0)
  s_branch L_pollc_6
L_poll_7:
  buffer_load_dwordx4 v[12:15], v160, s[44:47], 0 offen sc1
  buffer_load_dwordx4 v[16:19], v161, s[44:47], 0 offen sc1
  buffer_load_dwordx4 v[20:23], v162, s[44:47], 0 offen sc1
  buffer_load_dwordx4 v[24:27], v163, s[44:47], 0 offen sc1
  buffer_load_dwordx4 v[28:31], v164, s[44:47], 0 offen sc1
  buffer_load_dwordx4 v[32:35], v165, s[44:47], 0 offen sc1
  s_waitcnt vmcnt(0)
  s_branch L_pollc_8
L_slow_9:
  s_nop 1
  s_add_u32 s94, s95, 7077888
  buffer_store_dwordx4 v[12:15], v4, s[44:47], s94 offen sc1
  s_add_u32 s94, s95, 7114752
  buffer_store_dwordx4 v[16:19], v4, s[44:47], s94 offen sc1
  s_add_u32 s94, s95, 7151616
  buffer_store_dwordx4 v[20:23], v4, s[44:47], s94 offen sc1
  s_add_u32 s94, s95, 7188480
  buffer_store_dwordx4 v[24:27], v4, s[44:47], s94 offen sc1
  s_add_u32 s94, s95, 7225344
  buffer_store_dwordx4 v[28:31], v4, s[44:47], s94 offen sc1
  s_add_u32 s94, s95, 7262208
  buffer_store_dwordx4 v[32:35], v4, s[44:47], s94 offen sc1
  s_branch L_back_10
L_slow_11:
  s_nop 1
  s_mov_b64 exec, 1
  buffer_store_dword v2, v10, s[44:47], s5 offen sc1
  s_mov_b64 exec, -1
  s_branch L_back_12
L_poll_13:
  s_sleep 6
  buffer_load_dwordx4 v[188:191], v206, s[44:47], 0 offen offset:0 sc1
  buffer_load_dwordx4 v[192:195], v206, s[44:47], 0 offen offset:1024 sc1
  buffer_load_dwordx4 v[196:199], v207, s[44:47], 0 offen offset:2048 sc1
  buffer_load_dword v200, v206, s[44:47], 0 offen offset:16 sc1
  buffer_load_dword v201, v206, s[44:47], 0 offen offset:1040 sc1
  buffer_load_dword v202, v204, s[44:47], 0 offen offset:2064 sc1
  s_waitcnt vmcnt(0)
  s_branch L_pollc_14
L_poll_15:
  buffer_load_dword v14, v13, s[44:47], 0 offen sc1
  s_waitcnt vmcnt(0)
  s_branch L_pollc_16
L_slow_17:
  s_nop 1
  s_mov_b32 s93, 655360
  s_mov_b32 exec_lo, 0xff00ff
  s_mov_b32 exec_hi, 0xff00ff
  buffer_store_dwordx4 v[152:155], v65, s[44:47], s93 offen sc1
  s_mov_b64 exec, -1
  s_nop 0
  s_branch L_back_18
L_poll_19:
  s_sleep 4
  s_mov_b32 s94, 0
  buffer_load_dwordx4 v[196:199], v75, s[44:47], s94 offen sc1
  s_mov_b32 s94, 90112
  buffer_load_dwordx4 v[168:171], v75, s[44:47], s94 offen sc1
  s_mov_b32 s94, 180224
  buffer_load_dwordx4 v[192:195], v75, s[44:47], s94 offen sc1
  s_mov_b32 s94, 270336
  buffer_load_dwordx4 v[172:175], v75, s[44:47], s94 offen sc1
  s_waitcnt vmcnt(0)
  s_branch L_pollc_20
L_slow_21:
  s_nop 1
  s_mov_b32 s93, 655360
  s_mov_b32 exec_lo, 0xff00ff00
  s_mov_b32 exec_hi, 0xff00ff00
  buffer_store_dwordx4 v[152:155], v65, s[44:47], s93 offen sc1
  s_mov_b64 exec, -1
  s_nop 0
  s_branch L_back_22
L_poll_23:
  s_mov_b32 s93, 655360
  buffer_load_dwordx4 v[136:139], v66, s[44:47], s93 offen sc1
  s_mov_b32 s93, 659456
  buffer_load_dwordx4 v[140:143], v66, s[44:47], s93 offen sc1
  s_mov_b32 s93, 663552
  buffer_load_dwordx4 v[144:147], v66, s[44:47], s93 offen sc1
  s_waitcnt vmcnt(0)
  s_branch L_pollc_24
L_slow_25:
  s_nop 1
  s_add_u32 s93, s8, 0
  s_add_u32 s94, s93, 4096
  buffer_store_dwordx2 v[168:169], v74, s[44:47], s93 offen offset:0 sc1
  buffer_store_dwordx2 v[170:171], v74, s[44:47], s93 offen offset:2048 sc1
  buffer_store_dwordx2 v[172:173], v74, s[44:47], s94 offen offset:0 sc1
  s_branch L_back_26
L_slow_27:
  s_nop 1
  s_mov_b64 exec, 1
  buffer_store_dword v2, v10, s[44:47], s9 offen sc1
  s_mov_b64 exec, -1
  s_branch L_back_28
L_poll_29:
  s_mov_b32 s93, 667648
  buffer_load_dwordx4 v[156:159], v66, s[44:47], s93 offen sc1
  s_mov_b32 s93, 671744
  buffer_load_dwordx4 v[160:163], v66, s[44:47], s93 offen sc1
  s_mov_b32 s93, 675840
  buffer_load_dwordx4 v[164:167], v66, s[44:47], s93 offen sc1
  s_waitcnt vmcnt(0)
  s_branch L_pollc_30
L_slow_31:
  s_nop 1
  s_add_u32 s93, s8, 55296
  s_add_u32 s94, s93, 4096
  buffer_store_dwordx2 v[136:137], v74, s[44:47], s93 offen offset:0 sc1
  buffer_store_dwordx2 v[138:139], v74, s[44:47], s93 offen offset:2048 sc1
  buffer_store_dwordx2 v[140:141], v74, s[44:47], s94 offen offset:0 sc1
  s_branch L_back_32
L_slow_33:
  s_nop 1
  s_mov_b32 s93, 1196032
  buffer_store_dwordx4 v[136:139], v65, s[44:47], s93 offen sc1
  s_nop 1
  s_branch L_back_34
L_slow_35:
  s_nop 1
  s_mov_b64 exec, 1
  buffer_store_dword v2, v10, s[44:47], s11 offen sc1
  s_mov_b64 exec, -1
  s_branch L_back_36
L_poll_37:
  buffer_load_dword v14, v12, s[44:47], 0 offen sc1
  s_waitcnt vmcnt(0)
  s_branch L_pollc_38
L_poll_39:
  buffer_load_dword v15, v12, s[44:47], s12 offen sc1
  s_waitcnt vmcnt(0)
  s_branch L_pollc_40
L_poll_41:
  s_mov_b32 s93, 1196032
  buffer_load_dwordx4 v[124:127], v66, s[44:47], s93 offen sc1
  s_mov_b32 s93, 1200128
  buffer_load_dwordx4 v[128:131], v66, s[44:47], s93 offen sc1
  s_mov_b32 s93, 1204224
  buffer_load_dwordx4 v[132:135], v66, s[44:47], s93 offen sc1
  s_mov_b32 s93, 1208320
  buffer_load_dwordx4 v[136:139], v66, s[44:47], s93 offen sc1
  s_mov_b32 s93, 1212416
  buffer_load_dwordx4 v[140:143], v66, s[44:47], s93 offen sc1
  s_mov_b32 s93, 1216512
  buffer_load_dwordx4 v[144:147], v66, s[44:47], s93 offen sc1
  s_waitcnt vmcnt(0)
  s_branch L_pollc_42
L_slow_43:
  s_nop 1
  s_lshl2_add_u32 s93, s77, s10
  s_add_u32 s93, s93, 160
  s_mov_b64 exec, 1
  buffer_store_dword v2, v10, s[44:47], s93 offen sc1
  s_mov_b64 exec, -1
  s_branch L_back_44
L_poll_45:
  buffer_load_dword v13, v12, s[44:47], 0 offen sc1
  s_waitcnt vmcnt(0)
  s_branch L_pollc_46
L_poll_47:
  buffer_load_dwordx4 v[124:127], v148, s[44:47], 0 offen sc1
  buffer_load_dwordx4 v[128:131], v149, s[44:47], 0 offen sc1
  buffer_load_dwordx4 v[132:135], v150, s[44:47], 0 offen sc1
  buffer_load_dwordx4 v[136:139], v151, s[44:47], 0 offen sc1
  buffer_load_dwordx4 v[140:143], v152, s[44:47], 0 offen sc1
  buffer_load_dwordx4 v[144:147], v153, s[44:47], 0 offen sc1
  s_waitcnt vmcnt(0)
  s_branch L_pollc_48
L_slow_49:
  s_nop 1
  s_add_u32 s94, s95, 7077888
  buffer_store_dwordx4 v[124:127], v4, s[44:47], s94 offen sc1
  s_add_u32 s94, s95, 7114752
  buffer_store_dwordx4 v[128:131], v4, s[44:47], s94 offen sc1
  s_add_u32 s94, s95, 7151616
  buffer_store_dwordx4 v[132:135], v4, s[44:47], s94 offen sc1
  s_branch L_back_50
L_slow_51:
  s_nop 1
  s_add_u32 s94, s95, 7188480
  buffer_store_dwordx4 v[136:139], v4, s[44:47], s94 offen sc1
  s_add_u32 s94, s95, 7225344
  buffer_store_dwordx4 v[140:143], v4, s[44:47], s94 offen sc1
  s_add_u32 s94, s95, 7262208
  buffer_store_dwordx4 v[144:147], v4, s[44:47], s94 offen sc1
  s_branch L_back_52
L_slow_53:
  s_nop 1
  s_mov_b64 exec, 1
  buffer_store_dword v2, v10, s[44:47], s93 offen sc1
  s_mov_b64 exec, -1
  s_branch L_back_54
L_slow_55:
  s_nop 1
  s_mov_b64 exec, 1
  buffer_store_dword v2, v10, s[44:47], s5 offen sc1
  s_mov_b64 exec, -1
  s_branch L_back_56
L_poll_57:
  buffer_load_dword v14, v12, s[44:47], s12 offen sc1
  s_waitcnt vmcnt(0)
  s_branch L_pollc_58
L_poll_59:
  buffer_load_dword v13, v12, s[44:47], 0 offen sc1
  s_waitcnt vmcnt(0)
  s_branch L_pollc_60
L_slow_61:
  s_nop 1
  s_mov_b32 s93, 655360
  s_mov_b32 exec_lo, 0xff00ff
  s_mov_b32 exec_hi, 0xff00ff
  buffer_store_dwordx4 v[152:155], v65, s[44:47], s93 offen sc1
  s_mov_b64 exec, -1
  s_nop 0
  s_branch L_back_62
L_slow_63:
  s_nop 1
  s_mov_b32 s93, 655360
  s_mov_b32 exec_lo, 0xff00ff00
  s_mov_b32 exec_hi, 0xff00ff00
  buffer_store_dwordx4 v[152:155], v65, s[44:47], s93 offen sc1
  s_mov_b64 exec, -1
  s_nop 0
  s_branch L_back_64
L_poll_65:
  s_mov_b32 s93, 655360
  buffer_load_dwordx4 v[136:139], v66, s[44:47], s93 offen sc1
  s_mov_b32 s93, 659456
  buffer_load_dwordx4 v[140:143], v66, s[44:47], s93 offen sc1
  s_mov_b32 s93, 663552
  buffer_load_dwordx4 v[144:147], v66, s[44:47], s93 offen sc1
  s_waitcnt vmcnt(0)
  s_branch L_pollc_66
L_poll_67:
  s_mov_b32 s93, 667648
  buffer_load_dwordx4 v[124:127], v66, s[44:47], s93 offen sc1
  s_mov_b32 s93, 671744
  buffer_load_dwordx4 v[128:131], v66, s[44:47], s93 offen sc1
  s_mov_b32 s93, 675840
  buffer_load_dwordx4 v[132:135], v66, s[44:47], s93 offen sc1
  s_waitcnt vmcnt(0)
  s_branch L_pollc_68
L_fin:
L_end:
  s_endpgm
.section .rodata,"a"
.p2align 6
.amdhsa_kernel interleave_layers__ssm_conv_s5__ssm_conv_h3__prompt_kernel
  .amdhsa_next_free_vgpr 512
  .amdhsa_next_free_sgpr 102
  .amdhsa_accum_offset 256
  .amdhsa_group_segment_fixed_size 0
  .amdhsa_kernarg_size 144
  .amdhsa_user_sgpr_count 2
  .amdhsa_user_sgpr_kernarg_segment_ptr 1
  .amdhsa_system_sgpr_workgroup_id_x 1
.end_amdhsa_kernel
```
